```python
import torch

def _softmax(x, axis=-1):
    return torch.softmax(x, dim=axis)
def _gelu(x):
    return torch.nn.functional.gelu(x, approximate="tanh")
def _silu(x):
    return torch.nn.functional.silu(x)
def _sigmoid(x):
    return torch.sigmoid(x)
def _layernorm(x, axis=-1, eps=1e-5):
    m = x.mean(dim=axis, keepdim=True)
    v = x.var(dim=axis, keepdim=True, unbiased=False)
    return (x - m) / torch.sqrt(v + eps)
def _scatter_add(tgt, idx, src, axis=0):
    return tgt.clone().index_add_(axis, idx, src)
def _segment_sum(src, seg, n):
    out = torch.zeros((n,) + src.shape[1:], dtype=src.dtype)
    return out.index_add_(0, seg, src)
def _pad(x, pw):
    flat = tuple(v for pair in reversed(pw) for v in pair)
    return torch.nn.functional.pad(x, flat)

kernel_name = 'interleave_layers__ssm_conv_s4d__linear_attn_block__prompt'

def setup_inputs():

    _w = (lambda a: (lambda t: t.to(torch.bfloat16) if t.is_floating_point() else t)(torch.as_tensor(a)))
    def _A_setup():
        Bsz, L, D, N = 1, 2048, 512, 128
        return {
            "u": _w((lambda *s: torch.randn(*s, dtype=torch.bfloat16) * 0.05)(Bsz, L, D)),
            "log_A_real": _w((lambda *s: torch.randn(*s, dtype=torch.bfloat16) * 1.6)(D, N) * 0.5),
            "A_imag": _w((lambda *s: torch.randn(*s, dtype=torch.bfloat16) * 0.05)(D, N) * 3.14),
            "C_real": _w((lambda *s: torch.randn(*s, dtype=torch.bfloat16) * 0.05)(D, N) / N ** 0.5),
            "C_imag": _w((lambda *s: torch.randn(*s, dtype=torch.bfloat16) * 0.05)(D, N) / N ** 0.5),
            "log_dt": _w((lambda *s: torch.randn(*s, dtype=torch.bfloat16) * 0.05)(D) * 0.5 - 4.0),
            "D_skip": _w((lambda *s: torch.randn(*s, dtype=torch.bfloat16) * 0.05)(D)),
        }
    _A_in = _A_setup()

    def _B_setup():
        B, S, D = 1, 2048, 512
        return {
            "x": _w((lambda *s: torch.randn(*s, dtype=torch.bfloat16) * 0.05)(B, S, D)),
            "wqkv": _w((lambda *s: torch.randn(*s, dtype=torch.bfloat16) * 0.05)(D, 3 * D)),
            "wo": _w((lambda *s: torch.randn(*s, dtype=torch.bfloat16) * 0.05)(D, D)),
        }
    _B_in = _B_setup()

    return {
        "A_u": _A_in["u"],
        "A_log_A_real": _A_in["log_A_real"],
        "A_A_imag": _A_in["A_imag"],
        "A_C_real": _A_in["C_real"],
        "A_C_imag": _A_in["C_imag"],
        "A_log_dt": _A_in["log_dt"],
        "A_D_skip": _A_in["D_skip"],
        "B_x": _B_in["x"],
        "B_wqkv": _B_in["wqkv"],
        "B_wo": _B_in["wo"],
    }

def reference(A_u, A_log_A_real, A_A_imag, A_C_real, A_C_imag, A_log_dt, A_D_skip, B_x, B_wqkv, B_wo):
    def _A_ref(u, log_A_real, A_imag, C_real, C_imag, log_dt, D_skip):
        L = u.shape[1]
        dt = torch.exp(log_dt)
        A = -torch.exp(log_A_real) + 1j * A_imag
        C = (C_real + 1j * C_imag) * dt[:, None]
        pos = (lambda x, dt: x.to(dt))(torch.arange(L), log_dt.dtype)
        P = torch.exp((A * dt[:, None])[:, :, None] * pos[None, None, :])
        K = 2.0 * torch.einsum("dn,dnl->dl", C, P).real
        L2 = 2 * L
        u_t = (lambda x, *d: x.permute(*d))(u, 0, 2, 1)
        Kf = (lambda x, *a, **k: torch.fft.rfft(x.float(), *a, **k))(K, L2)
        Uf = (lambda x, *a, **k: torch.fft.rfft(x.float(), *a, **k))(u_t, L2)
        y = (lambda x, *a, **k: torch.fft.irfft(x, *a, **k).to(torch.bfloat16))(Uf * Kf[None, :, :], L2)[:, :, :L]
        y = (lambda x, *d: x.permute(*d))(y, 0, 2, 1)
        return y + u * D_skip[None, None, :]

    def _B_ref(x, wqkv, wo):
        B, S, D = x.shape
        H = 32; Dh = D // H
        qkv = (lambda x, *d: x.permute(*d))((x @ wqkv).reshape(B, S, 3, H, Dh), 2, 0, 3, 1, 4)
        q, k, v = qkv[0], qkv[1], qkv[2]
        phi = lambda t: torch.where(t > 0, t + 1, torch.exp(t)) + 1e-6
        pq, pk = phi(q), phi(k)
        kv = torch.einsum("bhsd,bhse->bhde", pk, v)
        z = torch.einsum("bhsd->bhd", pk)
        num = torch.einsum("bhqd,bhde->bhqe", pq, kv)
        den = torch.einsum("bhqd,bhd->bhq", pq, z)[..., None] + 1e-6
        o = num / den
        return (lambda x, *d: x.permute(*d))(o, 0, 2, 1, 3).reshape(B, S, D) @ wo

    x = A_u
    x = x + _A_ref(_layernorm(x, axis=-1), A_log_A_real, A_A_imag, A_C_real, A_C_imag, A_log_dt, A_D_skip)
    x = x + _B_ref(_layernorm(x, axis=-1), B_wqkv, B_wo)
    x = x + _A_ref(_layernorm(x, axis=-1), A_log_A_real, A_A_imag, A_C_real, A_C_imag, A_log_dt, A_D_skip)
    x = x + _B_ref(_layernorm(x, axis=-1), B_wqkv, B_wo)
    return x
```

```asm
; @launch grid=(256,1,1) block=(256,1,1) lds=163840
.amdgcn_target "amdgcn-amd-amdhsa--gfx950"
.text
.globl interleave_layers__ssm_conv_s4d__linear_attn_block__prompt_kernel
.p2align 8
.type interleave_layers__ssm_conv_s4d__linear_attn_block__prompt_kernel,@function
interleave_layers__ssm_conv_s4d__linear_attn_block__prompt_kernel:
  s_getpc_b64 s[78:79]
L_pc:
  s_cmp_ge_u32 s2, 256
  s_cbranch_scc1 L_end
  s_load_dwordx16 s[8:23], s[0:1], 0
  s_load_dwordx8 s[24:31], s[0:1], 64
  s_load_dwordx2 s[32:33], s[0:1], 96
  s_memrealtime s[82:83]
  v_lshlrev_b32 v10, 7, v0
  v_min_u32 v11, L_tab_end - L_pc - 4, v10
  global_load_dword v38, v11, s[78:79]
  v_add_u32 v10, 0x8000, v10
  v_min_u32 v10, L_tab_end - L_pc - 4, v10
  global_load_dword v39, v10, s[78:79]
  v_lshrrev_b32 v1, 6, v0
  s_and_b32 s45, s2, 7
  s_lshr_b32 s46, s2, 3
  v_readfirstlane_b32 s44, v1
  s_lshl_b32 s47, s45, 5
  s_add_u32 s47, s47, s46
  v_and_b32 v1, 63, v0
  s_lshl_b32 s54, s47, 9
  v_lshl_add_u32 v10, v0, 1, s54
  s_lshl_b32 s54, s47, 2
  v_lshrrev_b32 v12, 7, v0
  v_lshl_add_u32 v11, v12, 1, s54
  s_lshl_b32 s54, s2, 13
  v_lshl_add_u32 v13, v0, 5, s54
  s_mul_i32 s6, s2, 5462
  s_lshr_b32 s6, s6, 16
  s_mul_i32 s7, s6, 12
  s_sub_u32 s7, s2, s7
  s_sub_u32 s55, s2, 192
  s_lshr_b32 s54, s55, 1
  s_and_b32 s55, s55, 1
  s_cmp_ge_u32 s2, 192
  s_cselect_b32 s6, s54, s6
  s_cselect_b32 s7, s55, s7
  s_cselect_b32 s56, 4, 5
  s_cselect_b32 s57, 2, 3
  s_cselect_b32 s58, 10, 0
  s_movk_i32 s59, 3072
  s_cselect_b32 s59, 1024, s59
  s_cselect_b32 s60, 9, 8
  s_cselect_b32 s61, 5, 4
  s_lshl_b32 s54, s6, s56
  s_lshl_b32 s55, s44, s57
  s_add_u32 s54, s54, s55
  s_mul_i32 s54, s54, s59
  s_lshl_b32 s55, s7, s60
  s_add_u32 s4, s54, s55
  v_lshrrev_b32 v14, s61, v1
  v_mul_lo_u32 v14, s59, v14
  s_lshl_b32 s55, 1, s61
  s_sub_u32 s55, s55, 1
  v_and_b32 v15, s55, v1
  v_lshl_add_u32 v14, v15, 4, v14
  s_lshl_b32 s55, 64, 0
  s_lshr_b32 s55, 64, s61
  s_mul_i32 s5, s55, s59
  s_lshl_b32 s57, s44, 11
  s_add_u32 s57, s57, 134144
  s_cmp_ge_u32 s2, 192
  s_waitcnt lgkmcnt(0)
  v_min_u32 v16, 11, v1
  v_lshlrev_b32 v16, 21, v16
  global_load_dword v19, v16, s[32:33]
  s_cmp_ge_u32 s2, 192
  global_load_ushort v32, v10, s[10:11]
  global_load_ushort v33, v10, s[12:13]
  global_load_ushort v36, v11, s[18:19]
  global_load_dwordx4 v[24:27], v13, s[8:9]
  global_load_dwordx4 v[28:31], v13, s[8:9] offset:16
  global_load_ushort v34, v10, s[14:15]
  global_load_ushort v35, v10, s[16:17]
  global_load_ushort v37, v11, s[20:21]
  s_cselect_b32 s40, s26, s24
  s_cselect_b32 s41, s27, s25
  s_mov_b32 s54, 1572864
  s_cselect_b32 s42, 524288, s54
  s_and_b32 s41, s41, 0xffff
  s_mov_b32 s43, 0x20000
  v_mov_b32 v23, 4
  s_or_b32 s54, s2, s44
  s_cmp_lg_u32 s54, 0
  s_cbranch_scc1 L_nw_1
  s_or_b32 s54, s82, 1
  v_mov_b32 v58, s54
  s_mov_b64 exec, 1
  global_store_dword v23, v58, s[30:31] sc1
  s_mov_b64 exec, -1
  s_waitcnt vmcnt(63)
L_nw_1:
  s_mov_b32 m0, s57
  s_nop 0
  buffer_load_dwordx4 v14, s[40:43], s4 offen lds
  s_add_u32 s4, s4, s5
  s_add_u32 m0, s57, 1024
  s_nop 0
  buffer_load_dwordx4 v14, s[40:43], s4 offen lds
  s_and_b32 s54, s46, 3
  s_lshl_b32 s48, s45, 2
  s_add_u32 s48, s48, s54
  s_lshr_b32 s49, s46, 2
  s_and_b32 s54, s49, 1
  s_lshl_b32 s50, s48, 1
  s_add_u32 s50, s50, s54
  s_lshr_b32 s51, s49, 1
  s_mov_b32 s64, 0x3fb8aa3b
  s_mov_b32 s65, s64
  s_mov_b32 s66, 0x358637bd
  s_mov_b32 s67, s66
  s_mov_b32 s80, 0x3b000000
  s_mov_b32 s81, s80
  s_mov_b32 s76, 0xffff0000
  s_mov_b32 s52, 100000
  s_mov_b32 s36, s32
  s_and_b32 s37, s33, 0xffff
  s_mov_b32 s38, 0x1620000
  s_mov_b32 s39, 0x20000
  s_add_u32 s54, s78, L_idx - L_pc
  s_addc_u32 s55, s79, 0
  v_and_b32 v10, 127, v0
  v_lshlrev_b32 v10, 4, v10
  global_load_dwordx4 v[40:43], v10, s[54:55]
  global_load_dwordx4 v[44:47], v10, s[54:55] offset:16
  global_load_dwordx4 v[48:51], v10, s[54:55] offset:2048
  global_load_dwordx4 v[52:55], v10, s[54:55] offset:2064
  s_waitcnt vmcnt(6)
  v_lshlrev_b32 v10, 5, v0
  v_add_u32 v10, 147456, v10
  ds_write_b128 v10, v[24:27]
  ds_write_b128 v10, v[28:31] offset:16
  v_lshlrev_b32 v64, 16, v24
  v_and_b32 v65, s76, v24
  v_lshlrev_b32 v66, 16, v25
  v_and_b32 v67, s76, v25
  v_lshlrev_b32 v68, 16, v26
  v_and_b32 v69, s76, v26
  v_lshlrev_b32 v70, 16, v27
  v_and_b32 v71, s76, v27
  v_lshlrev_b32 v72, 16, v28
  v_and_b32 v73, s76, v28
  v_lshlrev_b32 v74, 16, v29
  v_and_b32 v75, s76, v29
  v_lshlrev_b32 v76, 16, v30
  v_and_b32 v77, s76, v30
  v_lshlrev_b32 v78, 16, v31
  v_and_b32 v79, s76, v31
  v_pk_add_f32 v[80:81], v[64:65], v[66:67]
  v_pk_add_f32 v[82:83], v[68:69], v[70:71]
  v_pk_add_f32 v[84:85], v[72:73], v[74:75]
  v_pk_add_f32 v[86:87], v[76:77], v[78:79]
  v_pk_mul_f32 v[88:89], v[64:65], v[64:65]
  v_pk_mul_f32 v[90:91], v[66:67], v[66:67]
  v_pk_add_f32 v[80:81], v[80:81], v[82:83]
  v_pk_add_f32 v[84:85], v[84:85], v[86:87]
  v_pk_fma_f32 v[88:89], v[68:69], v[68:69], v[88:89]
  v_pk_fma_f32 v[90:91], v[70:71], v[70:71], v[90:91]
  v_pk_fma_f32 v[88:89], v[72:73], v[72:73], v[88:89]
  v_pk_fma_f32 v[90:91], v[74:75], v[74:75], v[90:91]
  v_pk_fma_f32 v[88:89], v[76:77], v[76:77], v[88:89]
  v_pk_fma_f32 v[90:91], v[78:79], v[78:79], v[90:91]
  v_pk_add_f32 v[80:81], v[80:81], v[84:85]
  v_pk_add_f32 v[88:89], v[88:89], v[90:91]
  v_add_f32 v80, v80, v81
  v_add_f32 v82, v88, v89
  s_nop 0
  v_add_f32_dpp v80, v80, v80 row_ror:8 row_mask:0xf bank_mask:0xf
  v_add_f32_dpp v82, v82, v82 row_ror:8 row_mask:0xf bank_mask:0xf
  s_nop 0
  v_add_f32_dpp v80, v80, v80 row_ror:4 row_mask:0xf bank_mask:0xf
  v_add_f32_dpp v82, v82, v82 row_ror:4 row_mask:0xf bank_mask:0xf
  s_nop 0
  v_add_f32_dpp v80, v80, v80 row_ror:2 row_mask:0xf bank_mask:0xf
  v_add_f32_dpp v82, v82, v82 row_ror:2 row_mask:0xf bank_mask:0xf
  s_nop 0
  v_add_f32_dpp v80, v80, v80 row_ror:1 row_mask:0xf bank_mask:0xf
  v_add_f32_dpp v82, v82, v82 row_ror:1 row_mask:0xf bank_mask:0xf
  s_nop 0
  v_add_f32_dpp v80, v80, v80 row_bcast:15 row_mask:0xa bank_mask:0xf
  v_add_f32_dpp v82, v82, v82 row_bcast:15 row_mask:0xa bank_mask:0xf
  v_mul_f32 v86, s80, v80
  v_mul_f32 v87, s80, v82
  v_fma_f32 v87, -v86, v86, v87
  v_max_f32 v87, 0, v87
  v_cvt_pk_bf16_f32 v86, v86, v87
  v_and_b32 v87, s76, v86
  v_lshlrev_b32 v56, 16, v86
  v_add_f32 v87, 0x3727c5ac, v87
  v_cvt_pk_bf16_f32 v87, v87, v87
  v_lshlrev_b32 v87, 16, v87
  v_sqrt_f32 v87, v87
  s_nop 0
  v_cvt_pk_bf16_f32 v57, v87, v87
  v_lshlrev_b32 v57, 16, v57
  v_lshrrev_b32 v56, 16, v56
  v_and_or_b32 v56, v57, s76, v56
  s_waitcnt vmcnt(4) lgkmcnt(0)
  s_barrier
  v_bfe_u32 v10, v1, 2, 2
  v_lshlrev_b32 v10, 10, v10
  v_lshrrev_b32 v11, 4, v1
  v_lshl_add_u32 v10, v11, 5, v10
  v_and_b32 v11, 3, v1
  v_lshl_add_u32 v10, v11, 3, v10
  s_lshl_b32 s54, s44, 8
  s_add_u32 s54, s54, 147456
  v_add_u32 v10, s54, v10
  ds_read_b64_tr_b16 v[100:101], v10 offset:0
  ds_read_b64_tr_b16 v[102:103], v10 offset:4096
  ds_read_b64_tr_b16 v[104:105], v10 offset:128
  ds_read_b64_tr_b16 v[106:107], v10 offset:4224
  s_mul_i32 s54, s2, 8320
  s_lshl_b32 s55, s44, 11
  s_add_u32 s54, s54, s55
  s_add_u32 s54, s54, 18874368
  v_lshlrev_b32 v11, 4, v1
  s_waitcnt lgkmcnt(0)
  buffer_store_dwordx4 v[100:103], v11, s[36:39], s54 offen sc1
  buffer_store_dwordx4 v[104:107], v11, s[36:39], s54 offen offset:1024 sc1
  v_mov_b32 v17, 4
  global_load_dword v58, v17, s[30:31] sc1
  s_cmp_ge_u32 s2, 192
  s_cbranch_scc1 L_wo2_2
  v_lshrrev_b32 v10, 2, v1
  v_lshlrev_b32 v10, 8, v10
  v_and_b32 v11, 3, v1
  v_lshl_add_u32 v10, v11, 3, v10
  s_lshl_b32 s54, s44, 6
  s_add_u32 s54, s54, 134144
  v_add_u32 v10, s54, v10
  ds_read_b64_tr_b16 v[88:89], v10
  ds_read_b64_tr_b16 v[90:91], v10 offset:4096
  ds_read_b64_tr_b16 v[92:93], v10 offset:32
  ds_read_b64_tr_b16 v[94:95], v10 offset:4128
  s_lshr_b32 s54, s7, 2
  s_add_u32 s54, s54, 2
  s_cmp_ge_u32 s54, 3
  s_cselect_b32 s55, 3, 0
  s_sub_u32 s54, s54, s55
  s_and_b32 s55, s7, 3
  s_lshl_b32 s55, s55, 3
  s_lshl_b32 s56, s44, 1
  s_add_u32 s55, s55, s56
  s_mul_i32 s55, s55, 3
  s_add_u32 s55, s55, s54
  s_lshl_b32 s55, s55, 4
  s_add_u32 s55, s55, s6
  s_lshl_b32 s55, s55, 10
  s_add_u32 s55, s55, 2752512
  s_add_u32 s56, s55, 49152
  s_branch L_wj2_3
L_wo2_2:
  v_lshrrev_b32 v10, 5, v1
  v_lshlrev_b32 v10, 2, v10
  v_bfe_u32 v11, v1, 2, 2
  v_add_u32 v10, v10, v11
  v_lshlrev_b32 v10, 9, v10
  v_and_b32 v11, 1, v1
  v_lshl_add_u32 v10, v11, 5, v10
  v_bfe_u32 v11, v1, 4, 1
  v_lshl_add_u32 v10, v11, 4, v10
  v_bfe_u32 v11, v1, 1, 1
  v_lshl_add_u32 v10, v11, 3, v10
  s_lshl_b32 s54, s44, 7
  s_add_u32 s54, s54, 134144
  v_add_u32 v10, s54, v10
  ds_read_b64_tr_b16 v[88:89], v10
  ds_read_b64_tr_b16 v[90:91], v10 offset:4096
  ds_read_b64_tr_b16 v[92:93], v10 offset:64
  ds_read_b64_tr_b16 v[94:95], v10 offset:4160
  s_lshl_b32 s55, s7, 3
  s_lshl_b32 s56, s44, 1
  s_add_u32 s55, s55, s56
  s_lshl_b32 s55, s55, 5
  s_add_u32 s55, s55, s6
  s_lshl_b32 s55, s55, 10
  s_add_u32 s55, s55, 4325376
  s_add_u32 s56, s55, 32768
L_wj2_3:
  v_lshlrev_b32 v10, 4, v1
  s_waitcnt lgkmcnt(0)
  buffer_store_dwordx4 v[88:91], v10, s[36:39], s55 offen sc1
  buffer_store_dwordx4 v[92:95], v10, s[36:39], s56 offen sc1
  v_lshlrev_b32 v32, 16, v32
  v_lshlrev_b32 v33, 16, v33
  v_lshlrev_b32 v34, 16, v34
  v_lshlrev_b32 v35, 16, v35
  v_lshlrev_b32 v36, 16, v36
  v_lshlrev_b32 v37, 16, v37
  s_nop 0
  v_readfirstlane_b32 s53, v37
  v_mul_f32 v60, s64, v36
  v_mul_f32 v61, s64, v32
  v_exp_f32 v60, v60
  v_exp_f32 v61, v61
  s_nop 0
  v_cvt_pk_bf16_f32 v60, v60, v61
  v_and_b32 v61, s76, v60
  v_lshlrev_b32 v60, 16, v60
  v_mul_f32 v62, -v61, v60
  v_mul_f32 v63, v33, v60
  v_mul_f32 v62, s64, v62
  v_mul_f32 v63, 0.15915494, v63
  v_mov_b32 v64, v62
  v_fract_f32 v65, v63
  v_mul_f32 v66, 4.0, v62
  v_mul_f32 v67, 4.0, v63
  v_mul_f32 v68, 0x41800000, v62
  v_mul_f32 v69, 0x41800000, v63
  v_mul_f32 v70, 0x42800000, v62
  v_mul_f32 v71, 0x42800000, v63
  v_mul_f32 v72, 0x44000000, v62
  v_mul_f32 v73, 0x44000000, v63
  v_exp_f32 v64, v64
  v_exp_f32 v66, v66
  v_fract_f32 v67, v67
  v_exp_f32 v68, v68
  v_fract_f32 v69, v69
  v_exp_f32 v70, v70
  v_fract_f32 v71, v71
  v_exp_f32 v72, v72
  v_fract_f32 v73, v73
  v_cos_f32 v100, v65
  v_sin_f32 v101, v65
  v_cos_f32 v102, v67
  v_sin_f32 v103, v67
  v_cos_f32 v104, v69
  v_sin_f32 v105, v69
  v_cos_f32 v106, v71
  v_sin_f32 v107, v71
  v_cos_f32 v108, v73
  v_sin_f32 v109, v73
  v_pk_mul_f32 v[100:101], v[100:101], v[64:65] op_sel_hi:[1,0]
  v_pk_mul_f32 v[102:103], v[102:103], v[66:67] op_sel_hi:[1,0]
  v_pk_mul_f32 v[104:105], v[104:105], v[68:69] op_sel_hi:[1,0]
  v_pk_mul_f32 v[106:107], v[106:107], v[70:71] op_sel_hi:[1,0]
  v_pk_mul_f32 v[108:109], v[108:109], v[72:73] op_sel_hi:[1,0]
  v_add_f32 v60, v60, v60
  v_mul_f32 v112, v34, v60
  v_mul_f32 v113, v35, v60
  v_pk_mul_f32 v[64:65], v[112:113], v[108:109] op_sel_hi:[1,0]
  v_pk_fma_f32 v[128:129], v[112:113], v[108:109], v[64:65] op_sel:[1,1,0] op_sel_hi:[0,1,1] neg_lo:[0,1,0]
  v_mov_b32 v144, 1.0
  v_mov_b32 v145, 0
  v_mov_b32 v160, 1.0
  v_mov_b32 v161, 0
  v_lshrrev_b32 v96, 7, v0
  v_mul_u32_u24 v96, 57344, v96
  v_and_b32 v97, 127, v0
  v_mul_u32_u24 v97, 224, v97
  v_add_u32 v96, v96, v97
  v_pk_mul_f32 v[64:65], v[112:113], v[104:105] op_sel_hi:[1,0]
  v_pk_mul_f32 v[66:67], v[128:129], v[106:107] op_sel_hi:[1,0]
  v_pk_mul_f32 v[68:69], v[144:145], v[100:101] op_sel_hi:[1,0]
  v_pk_fma_f32 v[114:115], v[112:113], v[104:105], v[64:65] op_sel:[1,1,0] op_sel_hi:[0,1,1] neg_lo:[0,1,0]
  v_pk_fma_f32 v[130:131], v[128:129], v[106:107], v[66:67] op_sel:[1,1,0] op_sel_hi:[0,1,1] neg_lo:[0,1,0]
  v_pk_fma_f32 v[146:147], v[144:145], v[100:101], v[68:69] op_sel:[1,1,0] op_sel_hi:[0,1,1] neg_lo:[0,1,0]
  v_pk_mul_f32 v[64:65], v[114:115], v[104:105] op_sel_hi:[1,0]
  v_pk_mul_f32 v[66:67], v[130:131], v[106:107] op_sel_hi:[1,0]
  v_pk_mul_f32 v[68:69], v[146:147], v[100:101] op_sel_hi:[1,0]
  v_pk_fma_f32 v[116:117], v[114:115], v[104:105], v[64:65] op_sel:[1,1,0] op_sel_hi:[0,1,1] neg_lo:[0,1,0]
  v_pk_fma_f32 v[132:133], v[130:131], v[106:107], v[66:67] op_sel:[1,1,0] op_sel_hi:[0,1,1] neg_lo:[0,1,0]
  v_pk_fma_f32 v[148:149], v[146:147], v[100:101], v[68:69] op_sel:[1,1,0] op_sel_hi:[0,1,1] neg_lo:[0,1,0]
  v_pk_mul_f32 v[64:65], v[116:117], v[104:105] op_sel_hi:[1,0]
  v_pk_mul_f32 v[66:67], v[132:133], v[106:107] op_sel_hi:[1,0]
  v_pk_mul_f32 v[68:69], v[148:149], v[100:101] op_sel_hi:[1,0]
  v_pk_fma_f32 v[118:119], v[116:117], v[104:105], v[64:65] op_sel:[1,1,0] op_sel_hi:[0,1,1] neg_lo:[0,1,0]
  v_pk_fma_f32 v[134:135], v[132:133], v[106:107], v[66:67] op_sel:[1,1,0] op_sel_hi:[0,1,1] neg_lo:[0,1,0]
  v_pk_fma_f32 v[150:151], v[148:149], v[100:101], v[68:69] op_sel:[1,1,0] op_sel_hi:[0,1,1] neg_lo:[0,1,0]
  v_pk_mul_f32 v[64:65], v[118:119], v[104:105] op_sel_hi:[1,0]
  v_pk_mul_f32 v[66:67], v[134:135], v[106:107] op_sel_hi:[1,0]
  v_pk_mul_f32 v[68:69], v[150:151], v[100:101] op_sel_hi:[1,0]
  v_pk_fma_f32 v[120:121], v[118:119], v[104:105], v[64:65] op_sel:[1,1,0] op_sel_hi:[0,1,1] neg_lo:[0,1,0]
  v_pk_fma_f32 v[136:137], v[134:135], v[106:107], v[66:67] op_sel:[1,1,0] op_sel_hi:[0,1,1] neg_lo:[0,1,0]
  v_pk_fma_f32 v[152:153], v[150:151], v[100:101], v[68:69] op_sel:[1,1,0] op_sel_hi:[0,1,1] neg_lo:[0,1,0]
  v_pk_mul_f32 v[64:65], v[120:121], v[104:105] op_sel_hi:[1,0]
  v_pk_mul_f32 v[66:67], v[136:137], v[106:107] op_sel_hi:[1,0]
  v_pk_mul_f32 v[68:69], v[152:153], v[100:101] op_sel_hi:[1,0]
  v_pk_fma_f32 v[122:123], v[120:121], v[104:105], v[64:65] op_sel:[1,1,0] op_sel_hi:[0,1,1] neg_lo:[0,1,0]
  v_pk_fma_f32 v[138:139], v[136:137], v[106:107], v[66:67] op_sel:[1,1,0] op_sel_hi:[0,1,1] neg_lo:[0,1,0]
  v_pk_fma_f32 v[154:155], v[152:153], v[100:101], v[68:69] op_sel:[1,1,0] op_sel_hi:[0,1,1] neg_lo:[0,1,0]
  v_pk_mul_f32 v[64:65], v[122:123], v[104:105] op_sel_hi:[1,0]
  v_pk_mul_f32 v[66:67], v[138:139], v[106:107] op_sel_hi:[1,0]
  v_pk_mul_f32 v[68:69], v[154:155], v[100:101] op_sel_hi:[1,0]
  v_pk_fma_f32 v[124:125], v[122:123], v[104:105], v[64:65] op_sel:[1,1,0] op_sel_hi:[0,1,1] neg_lo:[0,1,0]
  v_pk_fma_f32 v[140:141], v[138:139], v[106:107], v[66:67] op_sel:[1,1,0] op_sel_hi:[0,1,1] neg_lo:[0,1,0]
  v_pk_fma_f32 v[156:157], v[154:155], v[100:101], v[68:69] op_sel:[1,1,0] op_sel_hi:[0,1,1] neg_lo:[0,1,0]
  v_pk_mul_f32 v[64:65], v[124:125], v[104:105] op_sel_hi:[1,0]
  v_pk_mul_f32 v[66:67], v[140:141], v[106:107] op_sel_hi:[1,0]
  v_pk_mul_f32 v[68:69], v[156:157], v[100:101] op_sel_hi:[1,0]
  v_pk_fma_f32 v[126:127], v[124:125], v[104:105], v[64:65] op_sel:[1,1,0] op_sel_hi:[0,1,1] neg_lo:[0,1,0]
  v_pk_fma_f32 v[142:143], v[140:141], v[106:107], v[66:67] op_sel:[1,1,0] op_sel_hi:[0,1,1] neg_lo:[0,1,0]
  v_pk_fma_f32 v[158:159], v[156:157], v[100:101], v[68:69] op_sel:[1,1,0] op_sel_hi:[0,1,1] neg_lo:[0,1,0]
  v_cvt_pk_bf16_f32 v72, v112, v114
  v_cvt_pk_bf16_f32 v76, -v113, -v115
  v_cvt_pk_bf16_f32 v73, v116, v118
  v_cvt_pk_bf16_f32 v77, -v117, -v119
  v_cvt_pk_bf16_f32 v74, v120, v122
  v_cvt_pk_bf16_f32 v78, -v121, -v123
  v_cvt_pk_bf16_f32 v75, v124, v126
  v_cvt_pk_bf16_f32 v79, -v125, -v127
  ds_write_b128 v96, v[72:75] offset:0
  ds_write_b128 v96, v[76:79] offset:28672
  v_cvt_pk_bf16_f32 v80, v128, v130
  v_cvt_pk_bf16_f32 v84, -v129, -v131
  v_cvt_pk_bf16_f32 v81, v132, v134
  v_cvt_pk_bf16_f32 v85, -v133, -v135
  v_cvt_pk_bf16_f32 v82, v136, v138
  v_cvt_pk_bf16_f32 v86, -v137, -v139
  v_cvt_pk_bf16_f32 v83, v140, v142
  v_cvt_pk_bf16_f32 v87, -v141, -v143
  ds_write_b128 v96, v[80:83] offset:64
  ds_write_b128 v96, v[84:87] offset:28736
  v_cvt_pk_bf16_f32 v88, v144, v146
  v_cvt_pk_bf16_f32 v92, v145, v147
  v_cvt_pk_bf16_f32 v89, v148, v150
  v_cvt_pk_bf16_f32 v93, v149, v151
  v_cvt_pk_bf16_f32 v90, v152, v154
  v_cvt_pk_bf16_f32 v94, v153, v155
  v_cvt_pk_bf16_f32 v91, v156, v158
  v_cvt_pk_bf16_f32 v95, v157, v159
  ds_write_b128 v96, v[88:91] offset:128
  ds_write_b128 v96, v[92:95] offset:28800
  v_pk_mul_f32 v[64:65], v[126:127], v[104:105] op_sel_hi:[1,0]
  v_pk_mul_f32 v[66:67], v[142:143], v[106:107] op_sel_hi:[1,0]
  v_pk_mul_f32 v[68:69], v[158:159], v[100:101] op_sel_hi:[1,0]
  v_pk_fma_f32 v[112:113], v[126:127], v[104:105], v[64:65] op_sel:[1,1,0] op_sel_hi:[0,1,1] neg_lo:[0,1,0]
  v_pk_fma_f32 v[128:129], v[142:143], v[106:107], v[66:67] op_sel:[1,1,0] op_sel_hi:[0,1,1] neg_lo:[0,1,0]
  v_pk_fma_f32 v[144:145], v[158:159], v[100:101], v[68:69] op_sel:[1,1,0] op_sel_hi:[0,1,1] neg_lo:[0,1,0]
  v_pk_mul_f32 v[70:71], v[160:161], v[102:103] op_sel_hi:[1,0]
  v_pk_fma_f32 v[162:163], v[160:161], v[102:103], v[70:71] op_sel:[1,1,0] op_sel_hi:[0,1,1] neg_lo:[0,1,0]
  v_pk_mul_f32 v[70:71], v[162:163], v[102:103] op_sel_hi:[1,0]
  v_pk_fma_f32 v[164:165], v[162:163], v[102:103], v[70:71] op_sel:[1,1,0] op_sel_hi:[0,1,1] neg_lo:[0,1,0]
  v_pk_mul_f32 v[70:71], v[164:165], v[102:103] op_sel_hi:[1,0]
  v_pk_fma_f32 v[166:167], v[164:165], v[102:103], v[70:71] op_sel:[1,1,0] op_sel_hi:[0,1,1] neg_lo:[0,1,0]
  v_pk_mul_f32 v[70:71], v[166:167], v[102:103] op_sel_hi:[1,0]
  v_pk_fma_f32 v[168:169], v[166:167], v[102:103], v[70:71] op_sel:[1,1,0] op_sel_hi:[0,1,1] neg_lo:[0,1,0]
  v_pk_mul_f32 v[70:71], v[168:169], v[102:103] op_sel_hi:[1,0]
  v_pk_fma_f32 v[170:171], v[168:169], v[102:103], v[70:71] op_sel:[1,1,0] op_sel_hi:[0,1,1] neg_lo:[0,1,0]
  v_pk_mul_f32 v[70:71], v[170:171], v[102:103] op_sel_hi:[1,0]
  v_pk_fma_f32 v[172:173], v[170:171], v[102:103], v[70:71] op_sel:[1,1,0] op_sel_hi:[0,1,1] neg_lo:[0,1,0]
  v_pk_mul_f32 v[70:71], v[172:173], v[102:103] op_sel_hi:[1,0]
  v_pk_fma_f32 v[174:175], v[172:173], v[102:103], v[70:71] op_sel:[1,1,0] op_sel_hi:[0,1,1] neg_lo:[0,1,0]
  v_cvt_pk_bf16_f32 v72, v160, v162
  v_cvt_pk_bf16_f32 v76, v161, v163
  v_cvt_pk_bf16_f32 v73, v164, v166
  v_cvt_pk_bf16_f32 v77, v165, v167
  v_cvt_pk_bf16_f32 v74, v168, v170
  v_cvt_pk_bf16_f32 v78, v169, v171
  v_cvt_pk_bf16_f32 v75, v172, v174
  v_cvt_pk_bf16_f32 v79, v173, v175
  ds_write_b128 v96, v[72:75] offset:160
  ds_write_b128 v96, v[76:79] offset:28832
  v_pk_mul_f32 v[70:71], v[174:175], v[102:103] op_sel_hi:[1,0]
  v_pk_fma_f32 v[160:161], v[174:175], v[102:103], v[70:71] op_sel:[1,1,0] op_sel_hi:[0,1,1] neg_lo:[0,1,0]
  s_waitcnt vmcnt(2)
  s_branch L_n0_6
L_nr_4:
  global_load_dword v58, v17, s[30:31] sc1
  s_waitcnt vmcnt(0)
L_n0_6:
  v_cmp_eq_u32 vcc, 0, v58
  s_cbranch_vccz L_ng_5
  s_sleep 1
  s_sub_u32 s52, s52, 1
  s_cbranch_scc0 L_nr_4
  s_mov_b32 s52, 0
L_ng_5:
  v_readfirstlane_b32 s35, v58
  s_nop 1
  v_mov_b32 v57, s35
  s_lshl_b32 s54, s2, 4
  s_lshl_b32 s55, s44, 12
  s_add_u32 s54, s54, s55
  s_add_u32 s54, s54, 0
  v_lshrrev_b32 v10, 5, v1
  v_lshl_add_u32 v10, v10, 3, s54
  s_mov_b32 s56, 0x00010000
  s_mov_b32 s57, 0x00010000
  s_mov_b64 exec, s[56:57]
  buffer_store_dwordx2 v[56:57], v10, s[36:39], 0 offen sc1
  s_mov_b64 exec, -1
  v_mov_b32 v20, -1
  v_mov_b32 v21, -1
  v_mov_b32 v22, -1
  v_mov_b32 v23, -1
  s_lshr_b32 s3, s44, 1
  s_lshl_b32 s61, s47, 1
  s_add_u32 s3, s3, s61
  s_mul_i32 s3, s3, 4224
  s_and_b32 s61, s44, 1
  s_lshl_b32 s61, s61, 11
  s_add_u32 s3, s3, s61
  s_add_u32 s3, s3, 4849664
  v_lshlrev_b32 v10, 4, v1
  buffer_store_dwordx4 v[20:23], v10, s[36:39], s3 offen sc1
  buffer_store_dwordx4 v[20:23], v10, s[36:39], s3 offen offset:1024 sc1
  v_pk_mul_f32 v[64:65], v[112:113], v[104:105] op_sel_hi:[1,0]
  v_pk_mul_f32 v[66:67], v[128:129], v[106:107] op_sel_hi:[1,0]
  v_pk_mul_f32 v[68:69], v[144:145], v[100:101] op_sel_hi:[1,0]
  v_pk_fma_f32 v[114:115], v[112:113], v[104:105], v[64:65] op_sel:[1,1,0] op_sel_hi:[0,1,1] neg_lo:[0,1,0]
  v_pk_fma_f32 v[130:131], v[128:129], v[106:107], v[66:67] op_sel:[1,1,0] op_sel_hi:[0,1,1] neg_lo:[0,1,0]
  v_pk_fma_f32 v[146:147], v[144:145], v[100:101], v[68:69] op_sel:[1,1,0] op_sel_hi:[0,1,1] neg_lo:[0,1,0]
  v_pk_mul_f32 v[64:65], v[114:115], v[104:105] op_sel_hi:[1,0]
  v_pk_mul_f32 v[66:67], v[130:131], v[106:107] op_sel_hi:[1,0]
  v_pk_mul_f32 v[68:69], v[146:147], v[100:101] op_sel_hi:[1,0]
  v_pk_fma_f32 v[116:117], v[114:115], v[104:105], v[64:65] op_sel:[1,1,0] op_sel_hi:[0,1,1] neg_lo:[0,1,0]
  v_pk_fma_f32 v[132:133], v[130:131], v[106:107], v[66:67] op_sel:[1,1,0] op_sel_hi:[0,1,1] neg_lo:[0,1,0]
  v_pk_fma_f32 v[148:149], v[146:147], v[100:101], v[68:69] op_sel:[1,1,0] op_sel_hi:[0,1,1] neg_lo:[0,1,0]
  v_pk_mul_f32 v[64:65], v[116:117], v[104:105] op_sel_hi:[1,0]
  v_pk_mul_f32 v[66:67], v[132:133], v[106:107] op_sel_hi:[1,0]
  v_pk_mul_f32 v[68:69], v[148:149], v[100:101] op_sel_hi:[1,0]
  v_pk_fma_f32 v[118:119], v[116:117], v[104:105], v[64:65] op_sel:[1,1,0] op_sel_hi:[0,1,1] neg_lo:[0,1,0]
  v_pk_fma_f32 v[134:135], v[132:133], v[106:107], v[66:67] op_sel:[1,1,0] op_sel_hi:[0,1,1] neg_lo:[0,1,0]
  v_pk_fma_f32 v[150:151], v[148:149], v[100:101], v[68:69] op_sel:[1,1,0] op_sel_hi:[0,1,1] neg_lo:[0,1,0]
  v_pk_mul_f32 v[64:65], v[118:119], v[104:105] op_sel_hi:[1,0]
  v_pk_mul_f32 v[66:67], v[134:135], v[106:107] op_sel_hi:[1,0]
  v_pk_mul_f32 v[68:69], v[150:151], v[100:101] op_sel_hi:[1,0]
  v_pk_fma_f32 v[120:121], v[118:119], v[104:105], v[64:65] op_sel:[1,1,0] op_sel_hi:[0,1,1] neg_lo:[0,1,0]
  v_pk_fma_f32 v[136:137], v[134:135], v[106:107], v[66:67] op_sel:[1,1,0] op_sel_hi:[0,1,1] neg_lo:[0,1,0]
  v_pk_fma_f32 v[152:153], v[150:151], v[100:101], v[68:69] op_sel:[1,1,0] op_sel_hi:[0,1,1] neg_lo:[0,1,0]
  v_pk_mul_f32 v[64:65], v[120:121], v[104:105] op_sel_hi:[1,0]
  v_pk_mul_f32 v[66:67], v[136:137], v[106:107] op_sel_hi:[1,0]
  v_pk_mul_f32 v[68:69], v[152:153], v[100:101] op_sel_hi:[1,0]
  v_pk_fma_f32 v[122:123], v[120:121], v[104:105], v[64:65] op_sel:[1,1,0] op_sel_hi:[0,1,1] neg_lo:[0,1,0]
  v_pk_fma_f32 v[138:139], v[136:137], v[106:107], v[66:67] op_sel:[1,1,0] op_sel_hi:[0,1,1] neg_lo:[0,1,0]
  v_pk_fma_f32 v[154:155], v[152:153], v[100:101], v[68:69] op_sel:[1,1,0] op_sel_hi:[0,1,1] neg_lo:[0,1,0]
  v_pk_mul_f32 v[64:65], v[122:123], v[104:105] op_sel_hi:[1,0]
  v_pk_mul_f32 v[66:67], v[138:139], v[106:107] op_sel_hi:[1,0]
  v_pk_mul_f32 v[68:69], v[154:155], v[100:101] op_sel_hi:[1,0]
  v_pk_fma_f32 v[124:125], v[122:123], v[104:105], v[64:65] op_sel:[1,1,0] op_sel_hi:[0,1,1] neg_lo:[0,1,0]
  v_pk_fma_f32 v[140:141], v[138:139], v[106:107], v[66:67] op_sel:[1,1,0] op_sel_hi:[0,1,1] neg_lo:[0,1,0]
  v_pk_fma_f32 v[156:157], v[154:155], v[100:101], v[68:69] op_sel:[1,1,0] op_sel_hi:[0,1,1] neg_lo:[0,1,0]
  v_pk_mul_f32 v[64:65], v[124:125], v[104:105] op_sel_hi:[1,0]
  v_pk_mul_f32 v[66:67], v[140:141], v[106:107] op_sel_hi:[1,0]
  v_pk_mul_f32 v[68:69], v[156:157], v[100:101] op_sel_hi:[1,0]
  v_pk_fma_f32 v[126:127], v[124:125], v[104:105], v[64:65] op_sel:[1,1,0] op_sel_hi:[0,1,1] neg_lo:[0,1,0]
  v_pk_fma_f32 v[142:143], v[140:141], v[106:107], v[66:67] op_sel:[1,1,0] op_sel_hi:[0,1,1] neg_lo:[0,1,0]
  v_pk_fma_f32 v[158:159], v[156:157], v[100:101], v[68:69] op_sel:[1,1,0] op_sel_hi:[0,1,1] neg_lo:[0,1,0]
  v_cvt_pk_bf16_f32 v72, v112, v114
  v_cvt_pk_bf16_f32 v76, -v113, -v115
  v_cvt_pk_bf16_f32 v73, v116, v118
  v_cvt_pk_bf16_f32 v77, -v117, -v119
  v_cvt_pk_bf16_f32 v74, v120, v122
  v_cvt_pk_bf16_f32 v78, -v121, -v123
  v_cvt_pk_bf16_f32 v75, v124, v126
  v_cvt_pk_bf16_f32 v79, -v125, -v127
  ds_write_b128 v96, v[72:75] offset:16
  ds_write_b128 v96, v[76:79] offset:28688
  v_cvt_pk_bf16_f32 v80, v128, v130
  v_cvt_pk_bf16_f32 v84, -v129, -v131
  v_cvt_pk_bf16_f32 v81, v132, v134
  v_cvt_pk_bf16_f32 v85, -v133, -v135
  v_cvt_pk_bf16_f32 v82, v136, v138
  v_cvt_pk_bf16_f32 v86, -v137, -v139
  v_cvt_pk_bf16_f32 v83, v140, v142
  v_cvt_pk_bf16_f32 v87, -v141, -v143
  ds_write_b128 v96, v[80:83] offset:80
  ds_write_b128 v96, v[84:87] offset:28752
  v_cvt_pk_bf16_f32 v88, v144, v146
  v_cvt_pk_bf16_f32 v92, v145, v147
  v_cvt_pk_bf16_f32 v89, v148, v150
  v_cvt_pk_bf16_f32 v93, v149, v151
  v_cvt_pk_bf16_f32 v90, v152, v154
  v_cvt_pk_bf16_f32 v94, v153, v155
  v_cvt_pk_bf16_f32 v91, v156, v158
  v_cvt_pk_bf16_f32 v95, v157, v159
  ds_write_b128 v96, v[88:91] offset:144
  ds_write_b128 v96, v[92:95] offset:28816
  v_pk_mul_f32 v[64:65], v[126:127], v[104:105] op_sel_hi:[1,0]
  v_pk_mul_f32 v[66:67], v[142:143], v[106:107] op_sel_hi:[1,0]
  v_pk_fma_f32 v[112:113], v[126:127], v[104:105], v[64:65] op_sel:[1,1,0] op_sel_hi:[0,1,1] neg_lo:[0,1,0]
  v_pk_fma_f32 v[128:129], v[142:143], v[106:107], v[66:67] op_sel:[1,1,0] op_sel_hi:[0,1,1] neg_lo:[0,1,0]
  v_pk_mul_f32 v[70:71], v[160:161], v[102:103] op_sel_hi:[1,0]
  v_pk_fma_f32 v[162:163], v[160:161], v[102:103], v[70:71] op_sel:[1,1,0] op_sel_hi:[0,1,1] neg_lo:[0,1,0]
  v_pk_mul_f32 v[70:71], v[162:163], v[102:103] op_sel_hi:[1,0]
  v_pk_fma_f32 v[164:165], v[162:163], v[102:103], v[70:71] op_sel:[1,1,0] op_sel_hi:[0,1,1] neg_lo:[0,1,0]
  v_pk_mul_f32 v[70:71], v[164:165], v[102:103] op_sel_hi:[1,0]
  v_pk_fma_f32 v[166:167], v[164:165], v[102:103], v[70:71] op_sel:[1,1,0] op_sel_hi:[0,1,1] neg_lo:[0,1,0]
  v_pk_mul_f32 v[70:71], v[166:167], v[102:103] op_sel_hi:[1,0]
  v_pk_fma_f32 v[168:169], v[166:167], v[102:103], v[70:71] op_sel:[1,1,0] op_sel_hi:[0,1,1] neg_lo:[0,1,0]
  v_pk_mul_f32 v[70:71], v[168:169], v[102:103] op_sel_hi:[1,0]
  v_pk_fma_f32 v[170:171], v[168:169], v[102:103], v[70:71] op_sel:[1,1,0] op_sel_hi:[0,1,1] neg_lo:[0,1,0]
  v_pk_mul_f32 v[70:71], v[170:171], v[102:103] op_sel_hi:[1,0]
  v_pk_fma_f32 v[172:173], v[170:171], v[102:103], v[70:71] op_sel:[1,1,0] op_sel_hi:[0,1,1] neg_lo:[0,1,0]
  v_pk_mul_f32 v[70:71], v[172:173], v[102:103] op_sel_hi:[1,0]
  v_pk_fma_f32 v[174:175], v[172:173], v[102:103], v[70:71] op_sel:[1,1,0] op_sel_hi:[0,1,1] neg_lo:[0,1,0]
  v_cvt_pk_bf16_f32 v72, v160, v162
  v_cvt_pk_bf16_f32 v76, v161, v163
  v_cvt_pk_bf16_f32 v73, v164, v166
  v_cvt_pk_bf16_f32 v77, v165, v167
  v_cvt_pk_bf16_f32 v74, v168, v170
  v_cvt_pk_bf16_f32 v78, v169, v171
  v_cvt_pk_bf16_f32 v75, v172, v174
  v_cvt_pk_bf16_f32 v79, v173, v175
  ds_write_b128 v96, v[72:75] offset:176
  ds_write_b128 v96, v[76:79] offset:28848
  s_waitcnt vmcnt(0) lgkmcnt(0)
  s_barrier
  s_cmp_lg_u32 s44, 0
  s_cbranch_scc1 L_arr_7
  s_and_b32 s54, s2, 15
  s_lshl_b32 s54, s54, 4
  v_mov_b32 v10, s54
  v_mov_b32 v11, 1
  s_mov_b64 exec, 1
  global_atomic_add v10, v11, s[30:31]
  s_mov_b64 exec, -1
L_arr_7:
  v_mov_b32 v20, -1
  v_mov_b32 v21, -1
  v_mov_b32 v22, -1
  v_mov_b32 v23, -1
  s_lshl_b32 s40, s49, 2
  s_add_u32 s40, s40, s44
  s_mul_i32 s40, s40, 65792
  s_lshl_b32 s61, s48, 11
  s_add_u32 s40, s40, s61
  s_add_u32 s40, s40, 11534336
  s_lshl_b32 s41, s49, 5
  s_add_u32 s41, s41, s48
  s_lshl_b32 s41, s41, 2
  s_add_u32 s41, s41, s44
  s_mul_i32 s41, s41, 1152
  s_add_u32 s41, s41, 262144
  s_lshr_b32 s42, s48, 3
  s_lshl_b32 s61, s49, 2
  s_add_u32 s42, s42, s61
  s_mul_i32 s42, s42, 640
  s_add_u32 s42, s42, 17825792
  v_lshlrev_b32 v58, 4, v1
  v_lshlrev_b32 v59, 2, v1
  buffer_store_dwordx4 v[20:23], v58, s[36:39], s41 offen sc1
  v_pk_mul_f32 v[64:65], v[112:113], v[104:105] op_sel_hi:[1,0]
  v_pk_mul_f32 v[66:67], v[128:129], v[106:107] op_sel_hi:[1,0]
  v_pk_fma_f32 v[114:115], v[112:113], v[104:105], v[64:65] op_sel:[1,1,0] op_sel_hi:[0,1,1] neg_lo:[0,1,0]
  v_pk_fma_f32 v[130:131], v[128:129], v[106:107], v[66:67] op_sel:[1,1,0] op_sel_hi:[0,1,1] neg_lo:[0,1,0]
  v_pk_mul_f32 v[64:65], v[114:115], v[104:105] op_sel_hi:[1,0]
  v_pk_mul_f32 v[66:67], v[130:131], v[106:107] op_sel_hi:[1,0]
  v_pk_fma_f32 v[116:117], v[114:115], v[104:105], v[64:65] op_sel:[1,1,0] op_sel_hi:[0,1,1] neg_lo:[0,1,0]
  v_pk_fma_f32 v[132:133], v[130:131], v[106:107], v[66:67] op_sel:[1,1,0] op_sel_hi:[0,1,1] neg_lo:[0,1,0]
  v_pk_mul_f32 v[64:65], v[116:117], v[104:105] op_sel_hi:[1,0]
  v_pk_mul_f32 v[66:67], v[132:133], v[106:107] op_sel_hi:[1,0]
  v_pk_fma_f32 v[118:119], v[116:117], v[104:105], v[64:65] op_sel:[1,1,0] op_sel_hi:[0,1,1] neg_lo:[0,1,0]
  v_pk_fma_f32 v[134:135], v[132:133], v[106:107], v[66:67] op_sel:[1,1,0] op_sel_hi:[0,1,1] neg_lo:[0,1,0]
  v_pk_mul_f32 v[64:65], v[118:119], v[104:105] op_sel_hi:[1,0]
  v_pk_mul_f32 v[66:67], v[134:135], v[106:107] op_sel_hi:[1,0]
  v_pk_fma_f32 v[120:121], v[118:119], v[104:105], v[64:65] op_sel:[1,1,0] op_sel_hi:[0,1,1] neg_lo:[0,1,0]
  v_pk_fma_f32 v[136:137], v[134:135], v[106:107], v[66:67] op_sel:[1,1,0] op_sel_hi:[0,1,1] neg_lo:[0,1,0]
  v_pk_mul_f32 v[64:65], v[120:121], v[104:105] op_sel_hi:[1,0]
  v_pk_mul_f32 v[66:67], v[136:137], v[106:107] op_sel_hi:[1,0]
  v_pk_fma_f32 v[122:123], v[120:121], v[104:105], v[64:65] op_sel:[1,1,0] op_sel_hi:[0,1,1] neg_lo:[0,1,0]
  v_pk_fma_f32 v[138:139], v[136:137], v[106:107], v[66:67] op_sel:[1,1,0] op_sel_hi:[0,1,1] neg_lo:[0,1,0]
  v_pk_mul_f32 v[64:65], v[122:123], v[104:105] op_sel_hi:[1,0]
  v_pk_mul_f32 v[66:67], v[138:139], v[106:107] op_sel_hi:[1,0]
  v_pk_fma_f32 v[124:125], v[122:123], v[104:105], v[64:65] op_sel:[1,1,0] op_sel_hi:[0,1,1] neg_lo:[0,1,0]
  v_pk_fma_f32 v[140:141], v[138:139], v[106:107], v[66:67] op_sel:[1,1,0] op_sel_hi:[0,1,1] neg_lo:[0,1,0]
  v_pk_mul_f32 v[64:65], v[124:125], v[104:105] op_sel_hi:[1,0]
  v_pk_mul_f32 v[66:67], v[140:141], v[106:107] op_sel_hi:[1,0]
  v_pk_fma_f32 v[126:127], v[124:125], v[104:105], v[64:65] op_sel:[1,1,0] op_sel_hi:[0,1,1] neg_lo:[0,1,0]
  v_pk_fma_f32 v[142:143], v[140:141], v[106:107], v[66:67] op_sel:[1,1,0] op_sel_hi:[0,1,1] neg_lo:[0,1,0]
  v_cvt_pk_bf16_f32 v72, v112, v114
  v_cvt_pk_bf16_f32 v76, -v113, -v115
  v_cvt_pk_bf16_f32 v73, v116, v118
  v_cvt_pk_bf16_f32 v77, -v117, -v119
  v_cvt_pk_bf16_f32 v74, v120, v122
  v_cvt_pk_bf16_f32 v78, -v121, -v123
  v_cvt_pk_bf16_f32 v75, v124, v126
  v_cvt_pk_bf16_f32 v79, -v125, -v127
  ds_write_b128 v96, v[72:75] offset:32
  ds_write_b128 v96, v[76:79] offset:28704
  v_cvt_pk_bf16_f32 v80, v128, v130
  v_cvt_pk_bf16_f32 v84, -v129, -v131
  v_cvt_pk_bf16_f32 v81, v132, v134
  v_cvt_pk_bf16_f32 v85, -v133, -v135
  v_cvt_pk_bf16_f32 v82, v136, v138
  v_cvt_pk_bf16_f32 v86, -v137, -v139
  v_cvt_pk_bf16_f32 v83, v140, v142
  v_cvt_pk_bf16_f32 v87, -v141, -v143
  ds_write_b128 v96, v[80:83] offset:96
  ds_write_b128 v96, v[84:87] offset:28768
  v_pk_mul_f32 v[64:65], v[126:127], v[104:105] op_sel_hi:[1,0]
  v_pk_mul_f32 v[66:67], v[142:143], v[106:107] op_sel_hi:[1,0]
  v_pk_fma_f32 v[112:113], v[126:127], v[104:105], v[64:65] op_sel:[1,1,0] op_sel_hi:[0,1,1] neg_lo:[0,1,0]
  v_pk_fma_f32 v[128:129], v[142:143], v[106:107], v[66:67] op_sel:[1,1,0] op_sel_hi:[0,1,1] neg_lo:[0,1,0]
  s_mov_b32 s62, -1
  s_mov_b32 s63, 0
  s_mov_b64 exec, s[62:63]
  buffer_store_dword v20, v59, s[36:39], s41 offen offset:1024 sc1
  s_mov_b64 exec, -1
  v_pk_mul_f32 v[64:65], v[112:113], v[104:105] op_sel_hi:[1,0]
  v_pk_fma_f32 v[114:115], v[112:113], v[104:105], v[64:65] op_sel:[1,1,0] op_sel_hi:[0,1,1] neg_lo:[0,1,0]
  v_pk_mul_f32 v[64:65], v[114:115], v[104:105] op_sel_hi:[1,0]
  v_pk_fma_f32 v[116:117], v[114:115], v[104:105], v[64:65] op_sel:[1,1,0] op_sel_hi:[0,1,1] neg_lo:[0,1,0]
  v_pk_mul_f32 v[64:65], v[116:117], v[104:105] op_sel_hi:[1,0]
  v_pk_fma_f32 v[118:119], v[116:117], v[104:105], v[64:65] op_sel:[1,1,0] op_sel_hi:[0,1,1] neg_lo:[0,1,0]
  v_pk_mul_f32 v[64:65], v[118:119], v[104:105] op_sel_hi:[1,0]
  v_pk_fma_f32 v[120:121], v[118:119], v[104:105], v[64:65] op_sel:[1,1,0] op_sel_hi:[0,1,1] neg_lo:[0,1,0]
  v_pk_mul_f32 v[64:65], v[120:121], v[104:105] op_sel_hi:[1,0]
  v_pk_fma_f32 v[122:123], v[120:121], v[104:105], v[64:65] op_sel:[1,1,0] op_sel_hi:[0,1,1] neg_lo:[0,1,0]
  v_pk_mul_f32 v[64:65], v[122:123], v[104:105] op_sel_hi:[1,0]
  v_pk_fma_f32 v[124:125], v[122:123], v[104:105], v[64:65] op_sel:[1,1,0] op_sel_hi:[0,1,1] neg_lo:[0,1,0]
  v_pk_mul_f32 v[64:65], v[124:125], v[104:105] op_sel_hi:[1,0]
  v_pk_fma_f32 v[126:127], v[124:125], v[104:105], v[64:65] op_sel:[1,1,0] op_sel_hi:[0,1,1] neg_lo:[0,1,0]
  v_cvt_pk_bf16_f32 v72, v112, v114
  v_cvt_pk_bf16_f32 v76, -v113, -v115
  v_cvt_pk_bf16_f32 v73, v116, v118
  v_cvt_pk_bf16_f32 v77, -v117, -v119
  v_cvt_pk_bf16_f32 v74, v120, v122
  v_cvt_pk_bf16_f32 v78, -v121, -v123
  v_cvt_pk_bf16_f32 v75, v124, v126
  v_cvt_pk_bf16_f32 v79, -v125, -v127
  ds_write_b128 v96, v[72:75] offset:48
  ds_write_b128 v96, v[76:79] offset:28720
  v_cvt_pk_bf16_f32 v80, v128, v128
  v_cvt_pk_bf16_f32 v84, -v129, -v129
  v_cvt_pk_bf16_f32 v81, v128, v128
  v_cvt_pk_bf16_f32 v85, -v129, -v129
  v_cvt_pk_bf16_f32 v82, v128, v128
  v_cvt_pk_bf16_f32 v86, -v129, -v129
  v_cvt_pk_bf16_f32 v83, v128, v128
  v_cvt_pk_bf16_f32 v87, -v129, -v129
  ds_write_b128 v96, v[80:83] offset:112
  ds_write_b128 v96, v[84:87] offset:28784
  buffer_store_dwordx4 v[20:23], v58, s[36:39], s40 offen sc1
  v_lshlrev_b32 v63, 4, v0
  s_movk_i32 s54, 0
  buffer_load_dwordx4 v[24:27], v63, s[36:39], s54 offen sc1
  s_movk_i32 s54, 4096
  buffer_load_dwordx4 v[28:31], v63, s[36:39], s54 offen sc1
  s_movk_i32 s54, 8192
  buffer_load_dwordx4 v[32:35], v63, s[36:39], s54 offen sc1
  s_movk_i32 s54, 12288
  buffer_load_dwordx4 v[36:39], v63, s[36:39], s54 offen sc1
  s_waitcnt lgkmcnt(0)
  s_barrier
  s_lshr_b32 s54, s44, 1
  s_and_b32 s55, s44, 1
  s_mul_i32 s56, s54, 57344
  s_lshl_b32 s57, s55, 5
  s_add_u32 s57, s57, 128
  s_add_u32 s57, s57, s56
  s_lshl_b32 s58, s55, 6
  s_add_u32 s58, s58, s56
  v_lshrrev_b32 v10, 2, v1
  v_mul_u32_u24 v10, 224, v10
  v_and_b32 v11, 3, v1
  v_lshl_add_u32 v10, v11, 3, v10
  v_add_u32 v11, s57, v10
  v_add_u32 v12, s58, v10
  ds_read_b64_tr_b16 v[64:65], v11 offset:0
  ds_read_b64_tr_b16 v[66:67], v11 offset:3584
  ds_read_b64_tr_b16 v[96:97], v12 offset:0
  ds_read_b64_tr_b16 v[98:99], v12 offset:3584
  ds_read_b64_tr_b16 v[128:129], v12 offset:32
  ds_read_b64_tr_b16 v[130:131], v12 offset:3616
  ds_read_b64_tr_b16 v[68:69], v11 offset:7168
  ds_read_b64_tr_b16 v[70:71], v11 offset:10752
  ds_read_b64_tr_b16 v[100:101], v12 offset:7168
  ds_read_b64_tr_b16 v[102:103], v12 offset:10752
  ds_read_b64_tr_b16 v[132:133], v12 offset:7200
  ds_read_b64_tr_b16 v[134:135], v12 offset:10784
  ds_read_b64_tr_b16 v[72:73], v11 offset:14336
  ds_read_b64_tr_b16 v[74:75], v11 offset:17920
  ds_read_b64_tr_b16 v[104:105], v12 offset:14336
  ds_read_b64_tr_b16 v[106:107], v12 offset:17920
  ds_read_b64_tr_b16 v[136:137], v12 offset:14368
  ds_read_b64_tr_b16 v[138:139], v12 offset:17952
  ds_read_b64_tr_b16 v[76:77], v11 offset:21504
  ds_read_b64_tr_b16 v[78:79], v11 offset:25088
  ds_read_b64_tr_b16 v[108:109], v12 offset:21504
  ds_read_b64_tr_b16 v[110:111], v12 offset:25088
  ds_read_b64_tr_b16 v[140:141], v12 offset:21536
  ds_read_b64_tr_b16 v[142:143], v12 offset:25120
  ds_read_b64_tr_b16 v[80:81], v11 offset:28672
  ds_read_b64_tr_b16 v[82:83], v11 offset:32256
  ds_read_b64_tr_b16 v[112:113], v12 offset:28672
  ds_read_b64_tr_b16 v[114:115], v12 offset:32256
  ds_read_b64_tr_b16 v[144:145], v12 offset:28704
  ds_read_b64_tr_b16 v[146:147], v12 offset:32288
  ds_read_b64_tr_b16 v[84:85], v11 offset:35840
  ds_read_b64_tr_b16 v[86:87], v11 offset:39424
  ds_read_b64_tr_b16 v[116:117], v12 offset:35840
  ds_read_b64_tr_b16 v[118:119], v12 offset:39424
  ds_read_b64_tr_b16 v[148:149], v12 offset:35872
  ds_read_b64_tr_b16 v[150:151], v12 offset:39456
  ds_read_b64_tr_b16 v[88:89], v11 offset:43008
  ds_read_b64_tr_b16 v[90:91], v11 offset:46592
  ds_read_b64_tr_b16 v[120:121], v12 offset:43008
  ds_read_b64_tr_b16 v[122:123], v12 offset:46592
  ds_read_b64_tr_b16 v[152:153], v12 offset:43040
  ds_read_b64_tr_b16 v[154:155], v12 offset:46624
  ds_read_b64_tr_b16 v[92:93], v11 offset:50176
  ds_read_b64_tr_b16 v[94:95], v11 offset:53760
  ds_read_b64_tr_b16 v[124:125], v12 offset:50176
  ds_read_b64_tr_b16 v[126:127], v12 offset:53760
  ds_read_b64_tr_b16 v[156:157], v12 offset:50208
  ds_read_b64_tr_b16 v[158:159], v12 offset:53792
  v_lshrrev_b32 v13, 7, v0
  v_mul_u32_u24 v14, 2080, v13
  v_add_u32 v14, 142336, v14
  v_mul_u32_u24 v15, 16640, v13
  v_and_b32 v13, 127, v0
  v_lshl_add_u32 v15, v13, 4, v15
  buffer_store_dwordx4 v[20:23], v58, s[36:39], s40 offen offset:1024 sc1
  s_waitcnt lgkmcnt(15)
  v_mfma_f32_16x16x32_bf16 v[160:163], v[64:67], v[96:99], 0
  v_mfma_f32_16x16x32_bf16 v[164:167], v[64:67], v[128:131], 0
  s_waitcnt lgkmcnt(15)
  v_mfma_f32_16x16x32_bf16 v[160:163], v[68:71], v[100:103], v[160:163]
  v_mfma_f32_16x16x32_bf16 v[164:167], v[68:71], v[132:135], v[164:167]
  s_waitcnt lgkmcnt(15)
  v_mfma_f32_16x16x32_bf16 v[160:163], v[72:75], v[104:107], v[160:163]
  v_mfma_f32_16x16x32_bf16 v[164:167], v[72:75], v[136:139], v[164:167]
  s_waitcnt lgkmcnt(15)
  v_mfma_f32_16x16x32_bf16 v[160:163], v[76:79], v[108:111], v[160:163]
  v_mfma_f32_16x16x32_bf16 v[164:167], v[76:79], v[140:143], v[164:167]
  s_waitcnt lgkmcnt(15)
  v_mfma_f32_16x16x32_bf16 v[160:163], v[80:83], v[112:115], v[160:163]
  v_mfma_f32_16x16x32_bf16 v[164:167], v[80:83], v[144:147], v[164:167]
  s_waitcnt lgkmcnt(12)
  v_mfma_f32_16x16x32_bf16 v[160:163], v[84:87], v[116:119], v[160:163]
  v_mfma_f32_16x16x32_bf16 v[164:167], v[84:87], v[148:151], v[164:167]
  s_waitcnt lgkmcnt(6)
  v_mfma_f32_16x16x32_bf16 v[160:163], v[88:91], v[120:123], v[160:163]
  v_mfma_f32_16x16x32_bf16 v[164:167], v[88:91], v[152:155], v[164:167]
  s_waitcnt lgkmcnt(0)
  v_mfma_f32_16x16x32_bf16 v[160:163], v[92:95], v[124:127], v[160:163]
  v_mfma_f32_16x16x32_bf16 v[164:167], v[92:95], v[156:159], v[164:167]
  s_mul_i32 s56, s54, 2080
  s_lshl_b32 s57, s55, 10
  s_add_u32 s56, s56, s57
  s_add_u32 s56, s56, 142336
  v_and_b32 v10, 15, v1
  v_lshlrev_b32 v10, 5, v10
  v_lshrrev_b32 v11, 4, v1
  v_lshl_add_u32 v10, v11, 3, v10
  v_add_u32 v10, s56, v10
  s_mul_i32 s56, s54, 2080
  s_add_u32 s56, s56, 144384
  v_mov_b32 v11, s56
  v_mov_b32 v12, 0
  ds_write_b32 v11, v12
  s_cmp_lg_u32 s44, 2
  s_cbranch_scc1 L_ff_8
  s_and_b32 s61, s48, 7
  s_lshl_b32 s62, s61, 6
  v_lshrrev_b32 v58, 3, v1
  v_mul_u32_u24 v58, 20608, v58
  v_and_b32 v59, 7, v1
  v_lshl_add_u32 v58, v59, 3, v58
  v_add_u32 v59, s62, v58
  buffer_store_dwordx2 v[20:21], v59, s[36:39], s42 offen sc1
  s_cmp_lg_u32 s61, 0
  s_cbranch_scc1 L_ff_8
  s_mov_b32 s62, 0x0f0f0f0f
  s_mov_b32 s63, 0x0f0f0f0f
  s_mov_b64 exec, s[62:63]
  buffer_store_dwordx2 v[20:21], v58, s[36:39], s42 offen offset:512 sc1
  s_mov_b64 exec, -1
L_ff_8:
  v_add_u32_sdwa v96, v14, v40 dst_sel:DWORD dst_unused:UNUSED_PAD src0_sel:DWORD src1_sel:WORD_0
  v_add_u32_sdwa v97, v14, v40 dst_sel:DWORD dst_unused:UNUSED_PAD src0_sel:DWORD src1_sel:WORD_1
  v_add_u32_sdwa v98, v14, v41 dst_sel:DWORD dst_unused:UNUSED_PAD src0_sel:DWORD src1_sel:WORD_0
  v_add_u32_sdwa v99, v14, v41 dst_sel:DWORD dst_unused:UNUSED_PAD src0_sel:DWORD src1_sel:WORD_1
  v_add_u32_sdwa v100, v14, v42 dst_sel:DWORD dst_unused:UNUSED_PAD src0_sel:DWORD src1_sel:WORD_0
  v_add_u32_sdwa v101, v14, v42 dst_sel:DWORD dst_unused:UNUSED_PAD src0_sel:DWORD src1_sel:WORD_1
  v_add_u32_sdwa v102, v14, v43 dst_sel:DWORD dst_unused:UNUSED_PAD src0_sel:DWORD src1_sel:WORD_0
  v_add_u32_sdwa v103, v14, v43 dst_sel:DWORD dst_unused:UNUSED_PAD src0_sel:DWORD src1_sel:WORD_1
  v_add_u32_sdwa v104, v14, v44 dst_sel:DWORD dst_unused:UNUSED_PAD src0_sel:DWORD src1_sel:WORD_0
  v_add_u32_sdwa v105, v14, v44 dst_sel:DWORD dst_unused:UNUSED_PAD src0_sel:DWORD src1_sel:WORD_1
  v_add_u32_sdwa v106, v14, v45 dst_sel:DWORD dst_unused:UNUSED_PAD src0_sel:DWORD src1_sel:WORD_0
  v_add_u32_sdwa v107, v14, v45 dst_sel:DWORD dst_unused:UNUSED_PAD src0_sel:DWORD src1_sel:WORD_1
  v_add_u32_sdwa v112, v14, v48 dst_sel:DWORD dst_unused:UNUSED_PAD src0_sel:DWORD src1_sel:WORD_0
  v_add_u32_sdwa v113, v14, v48 dst_sel:DWORD dst_unused:UNUSED_PAD src0_sel:DWORD src1_sel:WORD_1
  v_add_u32_sdwa v114, v14, v49 dst_sel:DWORD dst_unused:UNUSED_PAD src0_sel:DWORD src1_sel:WORD_0
  v_add_u32_sdwa v115, v14, v49 dst_sel:DWORD dst_unused:UNUSED_PAD src0_sel:DWORD src1_sel:WORD_1
  v_add_u32_sdwa v116, v14, v50 dst_sel:DWORD dst_unused:UNUSED_PAD src0_sel:DWORD src1_sel:WORD_0
  v_add_u32_sdwa v117, v14, v50 dst_sel:DWORD dst_unused:UNUSED_PAD src0_sel:DWORD src1_sel:WORD_1
  v_add_u32_sdwa v118, v14, v51 dst_sel:DWORD dst_unused:UNUSED_PAD src0_sel:DWORD src1_sel:WORD_0
  v_add_u32_sdwa v119, v14, v51 dst_sel:DWORD dst_unused:UNUSED_PAD src0_sel:DWORD src1_sel:WORD_1
  v_add_u32_sdwa v120, v14, v52 dst_sel:DWORD dst_unused:UNUSED_PAD src0_sel:DWORD src1_sel:WORD_0
  v_add_u32_sdwa v121, v14, v52 dst_sel:DWORD dst_unused:UNUSED_PAD src0_sel:DWORD src1_sel:WORD_1
  v_add_u32_sdwa v122, v14, v53 dst_sel:DWORD dst_unused:UNUSED_PAD src0_sel:DWORD src1_sel:WORD_0
  v_add_u32_sdwa v123, v14, v53 dst_sel:DWORD dst_unused:UNUSED_PAD src0_sel:DWORD src1_sel:WORD_1
  v_cvt_pk_bf16_f32 v168, v160, v161
  v_cvt_pk_bf16_f32 v169, v162, v163
  ds_write_b64 v10, v[168:169] offset:0
  v_cvt_pk_bf16_f32 v170, v164, v165
  v_cvt_pk_bf16_f32 v171, v166, v167
  ds_write_b64 v10, v[170:171] offset:512
  s_waitcnt lgkmcnt(0)
  s_barrier
  s_waitcnt vmcnt(1)
  s_branch L_s1c_11
L_s1r_9:
  v_lshlrev_b32 v63, 4, v0
  s_movk_i32 s54, 0
  buffer_load_dwordx4 v[24:27], v63, s[36:39], s54 offen sc1
  s_movk_i32 s54, 4096
  buffer_load_dwordx4 v[28:31], v63, s[36:39], s54 offen sc1
  s_movk_i32 s54, 8192
  buffer_load_dwordx4 v[32:35], v63, s[36:39], s54 offen sc1
  s_movk_i32 s54, 12288
  buffer_load_dwordx4 v[36:39], v63, s[36:39], s54 offen sc1
  s_waitcnt vmcnt(0)
L_s1c_11:
  v_xor_b32 v160, s35, v25
  v_xor_b32 v161, s35, v27
  v_xor_b32 v162, s35, v29
  v_xor_b32 v163, s35, v31
  v_xor_b32 v164, s35, v33
  v_xor_b32 v165, s35, v35
  v_xor_b32 v166, s35, v37
  v_xor_b32 v167, s35, v39
  v_or3_b32 v160, v160, v161, v162
  v_or3_b32 v163, v163, v164, v165
  v_or3_b32 v160, v160, v166, v167
  v_or_b32 v160, v160, v163
  v_cmp_ne_u32 vcc, 0, v160
  s_cbranch_vccz L_s1k_10
  s_sleep 1
  s_sub_u32 s52, s52, 1
  s_cbranch_scc0 L_s1r_9
  s_mov_b32 s52, 0
L_s1k_10:
  v_mul_u32_u24 v10, 8320, v0
  s_lshl_b32 s54, s47, 5
  s_add_u32 s54, s54, 18874368
  buffer_load_dwordx4 v[40:43], v10, s[36:39], s54 offen sc1
  buffer_load_dwordx4 v[44:47], v10, s[36:39], s54 offen offset:16 sc1
  ds_read_u16 v96, v96
  ds_read_u16 v97, v97
  ds_read_u16 v98, v98
  ds_read_u16 v99, v99
  ds_read_u16 v100, v100
  ds_read_u16 v101, v101
  ds_read_u16 v102, v102
  ds_read_u16 v103, v103
  ds_read_u16 v104, v104
  ds_read_u16 v105, v105
  ds_read_u16 v106, v106
  ds_read_u16 v107, v107
  ds_read_u16 v112, v112
  ds_read_u16 v113, v113
  ds_read_u16 v114, v114
  ds_read_u16 v115, v115
  ds_read_u16 v116, v116
  ds_read_u16 v117, v117
  ds_read_u16 v118, v118
  ds_read_u16 v119, v119
  ds_read_u16 v120, v120
  ds_read_u16 v121, v121
  ds_read_u16 v122, v122
  ds_read_u16 v123, v123
  s_waitcnt lgkmcnt(12)
  v_lshl_or_b32 v64, v97, 16, v96
  v_lshl_or_b32 v65, v99, 16, v98
  v_lshl_or_b32 v66, v101, 16, v100
  v_lshl_or_b32 v67, v103, 16, v102
  v_lshl_or_b32 v68, v105, 16, v104
  v_lshl_or_b32 v69, v107, 16, v106
  v_mov_b32 v72, v65
  v_mov_b32 v73, v66
  v_mov_b32 v74, v67
  v_mov_b32 v75, v68
  v_alignbit_b32 v80, v65, v64, 16
  v_alignbit_b32 v81, v66, v65, 16
  v_alignbit_b32 v82, v67, v66, 16
  v_alignbit_b32 v83, v68, v67, 16
  v_alignbit_b32 v88, v66, v65, 16
  v_alignbit_b32 v89, v67, v66, 16
  v_alignbit_b32 v90, v68, v67, 16
  v_alignbit_b32 v91, v69, v68, 16
  ds_write_b128 v15, v[64:67] offset:0
  ds_write_b128 v15, v[80:83] offset:4160
  ds_write_b128 v15, v[72:75] offset:8320
  ds_write_b128 v15, v[88:91] offset:12480
  s_waitcnt lgkmcnt(4)
  v_lshl_or_b32 v128, v113, 16, v112
  v_lshl_or_b32 v129, v115, 16, v114
  v_lshl_or_b32 v130, v117, 16, v116
  v_lshl_or_b32 v131, v119, 16, v118
  v_lshl_or_b32 v132, v121, 16, v120
  v_lshl_or_b32 v133, v123, 16, v122
  v_mov_b32 v136, v129
  v_mov_b32 v137, v130
  v_mov_b32 v138, v131
  v_mov_b32 v139, v132
  v_alignbit_b32 v144, v129, v128, 16
  v_alignbit_b32 v145, v130, v129, 16
  v_alignbit_b32 v146, v131, v130, 16
  v_alignbit_b32 v147, v132, v131, 16
  v_alignbit_b32 v152, v130, v129, 16
  v_alignbit_b32 v153, v131, v130, 16
  v_alignbit_b32 v154, v132, v131, 16
  v_alignbit_b32 v155, v133, v132, 16
  ds_write_b128 v15, v[128:131] offset:2048
  ds_write_b128 v15, v[144:147] offset:6208
  ds_write_b128 v15, v[136:139] offset:10368
  ds_write_b128 v15, v[152:155] offset:14528
  s_cmp_lg_u32 s44, 0
  s_cbranch_scc1 L_zk_12
  v_lshrrev_b32 v10, 2, v1
  v_mul_u32_u24 v10, 4160, v10
  v_and_b32 v11, 3, v1
  v_lshl_add_u32 v10, v11, 4, v10
  v_add_u32 v10, 4096, v10
  v_mov_b32 v160, 0
  v_mov_b32 v161, 0
  v_mov_b32 v162, 0
  v_mov_b32 v163, 0
  s_mov_b32 s56, -1
  s_mov_b32 s57, 0
  s_mov_b64 exec, s[56:57]
  ds_write_b128 v10, v[160:163]
  s_mov_b64 exec, -1
L_zk_12:
  s_waitcnt lgkmcnt(0)
  s_barrier
  s_lshr_b32 s4, s44, 1
  s_and_b32 s5, s44, 1
  v_and_b32 v10, 3, v1
  v_sub_u32 v10, 3, v10
  v_mul_u32_u24 v12, 4160, v10
  v_bfe_u32 v10, v1, 5, 1
  v_lshlrev_b32 v13, 5, v10
  v_sub_u32 v12, v12, v13
  v_bfe_u32 v11, v1, 4, 1
  v_lshl_add_u32 v12, v11, 4, v12
  v_bfe_u32 v10, v1, 2, 2
  v_lshlrev_b32 v10, 3, v10
  v_sub_u32 v12, v12, v10
  s_mul_i32 s56, s4, 16640
  s_lshl_b32 s57, s5, 8
  s_sub_u32 s56, s56, s57
  s_add_u32 s56, s56, 312
  v_and_b32 v10, 15, v1
  v_lshlrev_b32 v14, 5, v10
  v_sub_u32 v14, v14, v13
  v_lshl_add_u32 v14, v11, 4, v14
  s_mul_i32 s58, s4, 4608
  s_sub_u32 s58, s58, s57
  s_add_u32 s58, s58, 66880
  v_add_u32 v16, s56, v12
  v_add_u32 v17, s58, v14
  v_and_b32 v56, 15, v1
  v_lshlrev_b32 v56, 5, v56
  v_lshrrev_b32 v13, 4, v1
  v_lshl_add_u32 v56, v13, 3, v56
  s_lshl_b32 s56, s5, 11
  v_add_u32 v56, s56, v56
  s_mul_i32 s57, s4, 4608
  s_add_u32 s57, s57, 67072
  v_add_u32 v57, s57, v56
  s_lshl_b32 s57, s4, 12
  s_add_u32 s57, s57, 75776
  v_add_u32 v58, s57, v56
  s_lshl_b32 s56, s44, 12
  s_add_u32 s56, s56, 83968
  v_lshl_add_u32 v59, v1, 4, s56
  s_xor_b32 s56, s44, 1
  s_lshl_b32 s56, s56, 12
  s_add_u32 s56, s56, 83968
  v_lshl_add_u32 v60, v1, 4, s56
  s_lshl_b32 s6, s47, 1
  s_add_u32 s6, s6, s4
  s_mul_i32 s6, s6, 4224
  s_add_u32 s6, s6, 4849664
  v_lshlrev_b32 v10, 4, v0
  v_add_u32 v61, 67072, v10
  v_add_u32 v62, 75776, v10
  v_lshlrev_b32 v63, 4, v0
  s_cmp_lg_u32 s44, 1
  s_cbranch_scc1 L_zp_13
  v_lshrrev_b32 v11, 5, v1
  v_mul_u32_u24 v11, 4608, v11
  v_and_b32 v12, 31, v1
  v_lshl_add_u32 v11, v12, 4, v11
  v_add_u32 v11, 66560, v11
  v_mov_b32 v12, 0
  v_mov_b32 v13, 0
  v_mov_b32 v14, 0
  v_mov_b32 v15, 0
  ds_write_b128 v11, v[12:15]
L_zp_13:
  v_lshlrev_b32 v18, 4, v1
  s_lshl_b32 s34, s49, 2
  s_add_u32 s34, s34, s44
  s_mul_i32 s34, s34, 49152
  s_add_u32 s34, s34, 2752512
  v_and_b32 v20, 15, v0
  v_lshlrev_b32 v20, 4, v20
  global_load_dword v21, v20, s[30:31] sc1
  v_and_b32 v25, s76, v24
  v_lshlrev_b32 v24, 16, v24
  v_and_b32 v27, s76, v26
  v_lshlrev_b32 v26, 16, v26
  v_and_b32 v29, s76, v28
  v_lshlrev_b32 v28, 16, v28
  v_and_b32 v31, s76, v30
  v_lshlrev_b32 v30, 16, v30
  v_and_b32 v33, s76, v32
  v_lshlrev_b32 v32, 16, v32
  v_and_b32 v35, s76, v34
  v_lshlrev_b32 v34, 16, v34
  v_and_b32 v37, s76, v36
  v_lshlrev_b32 v36, 16, v36
  v_and_b32 v39, s76, v38
  v_lshlrev_b32 v38, 16, v38
  v_rcp_f32 v25, v25
  v_rcp_f32 v27, v27
  v_rcp_f32 v29, v29
  v_rcp_f32 v31, v31
  v_rcp_f32 v33, v33
  v_rcp_f32 v35, v35
  v_rcp_f32 v37, v37
  v_rcp_f32 v39, v39
  s_waitcnt vmcnt(1)
  v_lshlrev_b32 v64, 16, v40
  v_lshlrev_b32 v65, 16, v44
  v_and_b32 v66, s76, v40
  v_and_b32 v67, s76, v44
  v_lshlrev_b32 v68, 16, v41
  v_lshlrev_b32 v69, 16, v45
  v_and_b32 v70, s76, v41
  v_and_b32 v71, s76, v45
  v_lshlrev_b32 v72, 16, v42
  v_lshlrev_b32 v73, 16, v46
  v_and_b32 v74, s76, v42
  v_and_b32 v75, s76, v46
  v_lshlrev_b32 v76, 16, v43
  v_lshlrev_b32 v77, 16, v47
  v_and_b32 v78, s76, v43
  v_and_b32 v79, s76, v47
  ds_write_b128 v62, v[40:43]
  ds_write_b128 v62, v[44:47] offset:4096
  v_pk_add_f32 v[64:65], v[64:65], v[24:25] op_sel_hi:[1,0] neg_lo:[0,1] neg_hi:[0,1]
  v_pk_add_f32 v[66:67], v[66:67], v[26:27] op_sel_hi:[1,0] neg_lo:[0,1] neg_hi:[0,1]
  v_pk_add_f32 v[68:69], v[68:69], v[28:29] op_sel_hi:[1,0] neg_lo:[0,1] neg_hi:[0,1]
  v_pk_add_f32 v[70:71], v[70:71], v[30:31] op_sel_hi:[1,0] neg_lo:[0,1] neg_hi:[0,1]
  v_pk_add_f32 v[72:73], v[72:73], v[32:33] op_sel_hi:[1,0] neg_lo:[0,1] neg_hi:[0,1]
  v_pk_add_f32 v[74:75], v[74:75], v[34:35] op_sel_hi:[1,0] neg_lo:[0,1] neg_hi:[0,1]
  v_pk_add_f32 v[76:77], v[76:77], v[36:37] op_sel_hi:[1,0] neg_lo:[0,1] neg_hi:[0,1]
  v_pk_add_f32 v[78:79], v[78:79], v[38:39] op_sel_hi:[1,0] neg_lo:[0,1] neg_hi:[0,1]
  v_cvt_pk_bf16_f32 v80, v64, v65
  v_cvt_pk_bf16_f32 v81, v66, v67
  v_cvt_pk_bf16_f32 v82, v68, v69
  v_cvt_pk_bf16_f32 v83, v70, v71
  v_cvt_pk_bf16_f32 v84, v72, v73
  v_cvt_pk_bf16_f32 v85, v74, v75
  v_cvt_pk_bf16_f32 v86, v76, v77
  v_cvt_pk_bf16_f32 v87, v78, v79
  v_lshlrev_b32 v64, 16, v80
  v_and_b32 v65, s76, v80
  v_lshlrev_b32 v66, 16, v81
  v_and_b32 v67, s76, v81
  v_lshlrev_b32 v68, 16, v82
  v_and_b32 v69, s76, v82
  v_lshlrev_b32 v70, 16, v83
  v_and_b32 v71, s76, v83
  v_lshlrev_b32 v72, 16, v84
  v_and_b32 v73, s76, v84
  v_lshlrev_b32 v74, 16, v85
  v_and_b32 v75, s76, v85
  v_lshlrev_b32 v76, 16, v86
  v_and_b32 v77, s76, v86
  v_lshlrev_b32 v78, 16, v87
  v_and_b32 v79, s76, v87
  v_pk_mul_f32 v[64:65], v[64:65], v[24:25] op_sel:[0,1] op_sel_hi:[1,1]
  v_pk_mul_f32 v[66:67], v[66:67], v[26:27] op_sel:[0,1] op_sel_hi:[1,1]
  v_pk_mul_f32 v[68:69], v[68:69], v[28:29] op_sel:[0,1] op_sel_hi:[1,1]
  v_pk_mul_f32 v[70:71], v[70:71], v[30:31] op_sel:[0,1] op_sel_hi:[1,1]
  v_pk_mul_f32 v[72:73], v[72:73], v[32:33] op_sel:[0,1] op_sel_hi:[1,1]
  v_pk_mul_f32 v[74:75], v[74:75], v[34:35] op_sel:[0,1] op_sel_hi:[1,1]
  v_pk_mul_f32 v[76:77], v[76:77], v[36:37] op_sel:[0,1] op_sel_hi:[1,1]
  v_pk_mul_f32 v[78:79], v[78:79], v[38:39] op_sel:[0,1] op_sel_hi:[1,1]
  v_cvt_pk_bf16_f32 v48, v64, v66
  v_cvt_pk_bf16_f32 v49, v68, v70
  v_cvt_pk_bf16_f32 v50, v72, v74
  v_cvt_pk_bf16_f32 v51, v76, v78
  ds_write_b128 v61, v[48:51] offset:0
  v_cvt_pk_bf16_f32 v52, v65, v67
  v_cvt_pk_bf16_f32 v53, v69, v71
  v_cvt_pk_bf16_f32 v54, v73, v75
  v_cvt_pk_bf16_f32 v55, v77, v79
  ds_write_b128 v61, v[52:55] offset:4608
  s_waitcnt lgkmcnt(0)
  s_barrier
  s_waitcnt vmcnt(0)
  s_branch L_b1c_16
L_b1r_14:
  global_load_dword v21, v20, s[30:31] sc1
  s_waitcnt vmcnt(0)
L_b1c_16:
  v_cmp_gt_u32 vcc, 16, v21
  s_cbranch_vccz L_b1k_15
  s_sleep 1
  s_sub_u32 s52, s52, 1
  s_cbranch_scc0 L_b1r_14
  s_mov_b32 s52, 0
L_b1k_15:
  ds_read_b128 v[96:99], v17 offset:192
  ds_read_b64 v[64:65], v16 offset:3776
  ds_read_b64 v[66:67], v16 offset:3784
  ds_read_b128 v[100:103], v17 offset:704
  ds_read_b64 v[68:69], v16 offset:3264
  ds_read_b64 v[70:71], v16 offset:3272
  ds_read_b128 v[104:107], v17 offset:1216
  ds_read_b64 v[72:73], v16 offset:2752
  ds_read_b64 v[74:75], v16 offset:2760
  ds_read_b128 v[108:111], v17 offset:1728
  ds_read_b64 v[76:77], v16 offset:2240
  ds_read_b64 v[78:79], v16 offset:2248
  ds_read_b128 v[112:115], v17 offset:2240
  ds_read_b64 v[80:81], v16 offset:1728
  ds_read_b64 v[82:83], v16 offset:1736
  ds_read_b128 v[116:119], v17 offset:2752
  ds_read_b64 v[84:85], v16 offset:1216
  ds_read_b64 v[86:87], v16 offset:1224
  ds_read_b128 v[120:123], v17 offset:3264
  ds_read_b64 v[88:89], v16 offset:704
  ds_read_b64 v[90:91], v16 offset:712
  ds_read_b128 v[124:127], v17 offset:3776
  ds_read_b64 v[92:93], v16 offset:192
  ds_read_b64 v[94:95], v16 offset:200
  s_mov_b32 s58, s53
  s_mov_b32 s59, s53
  s_waitcnt lgkmcnt(15)
  v_mfma_f32_16x16x32_bf16 v[24:27], v[64:67], v[96:99], 0
  s_waitcnt lgkmcnt(15)
  v_mfma_f32_16x16x32_bf16 v[28:31], v[64:67], v[100:103], 0
  v_mfma_f32_16x16x32_bf16 v[28:31], v[68:71], v[96:99], v[28:31]
  s_waitcnt lgkmcnt(15)
  v_mfma_f32_16x16x32_bf16 v[32:35], v[64:67], v[104:107], 0
  buffer_load_dwordx4 a[0:3], v18, s[36:39], s34 offen offset:0 sc1
  v_mfma_f32_16x16x32_bf16 v[32:35], v[68:71], v[100:103], v[32:35]
  v_mfma_f32_16x16x32_bf16 v[32:35], v[72:75], v[96:99], v[32:35]
  s_waitcnt lgkmcnt(12)
  v_mfma_f32_16x16x32_bf16 v[36:39], v[64:67], v[108:111], 0
  ds_read_b128 v[160:163], v17 offset:128
  v_mfma_f32_16x16x32_bf16 v[36:39], v[68:71], v[104:107], v[36:39]
  ds_read_b64 v[128:129], v16 offset:3712
  buffer_load_dwordx4 a[4:7], v18, s[36:39], s34 offen offset:1024 sc1
  v_mfma_f32_16x16x32_bf16 v[36:39], v[72:75], v[100:103], v[36:39]
  ds_read_b64 v[130:131], v16 offset:3720
  v_mfma_f32_16x16x32_bf16 v[36:39], v[76:79], v[96:99], v[36:39]
  ds_read_b128 v[164:167], v17 offset:640
  s_waitcnt lgkmcnt(13)
  v_mfma_f32_16x16x32_bf16 v[40:43], v[64:67], v[112:115], 0
  ds_read_b64 v[132:133], v16 offset:3200
  v_mfma_f32_16x16x32_bf16 v[40:43], v[68:71], v[108:111], v[40:43]
  ds_read_b64 v[134:135], v16 offset:3208
  buffer_load_dwordx4 a[8:11], v18, s[36:39], s34 offen offset:2048 sc1
  v_mfma_f32_16x16x32_bf16 v[40:43], v[72:75], v[104:107], v[40:43]
  ds_read_b128 v[168:171], v17 offset:1152
  v_mfma_f32_16x16x32_bf16 v[40:43], v[76:79], v[100:103], v[40:43]
  ds_read_b64 v[136:137], v16 offset:2688
  v_mfma_f32_16x16x32_bf16 v[40:43], v[80:83], v[96:99], v[40:43]
  ds_read_b64 v[138:139], v16 offset:2696
  s_waitcnt lgkmcnt(15)
  v_mfma_f32_16x16x32_bf16 v[44:47], v[64:67], v[116:119], 0
  ds_read_b128 v[172:175], v17 offset:1664
  buffer_load_dwordx4 a[12:15], v18, s[36:39], s34 offen offset:3072 sc1
  s_add_u32 s34, s34, 4096
  v_mfma_f32_16x16x32_bf16 v[44:47], v[68:71], v[112:115], v[44:47]
  ds_read_b64 v[140:141], v16 offset:2176
  v_mfma_f32_16x16x32_bf16 v[44:47], v[72:75], v[108:111], v[44:47]
  ds_read_b64 v[142:143], v16 offset:2184
  v_mfma_f32_16x16x32_bf16 v[44:47], v[76:79], v[104:107], v[44:47]
  ds_read_b128 v[176:179], v17 offset:2176
  v_mfma_f32_16x16x32_bf16 v[44:47], v[80:83], v[100:103], v[44:47]
  ds_read_b64 v[144:145], v16 offset:1664
  buffer_load_dwordx4 a[16:19], v18, s[36:39], s34 offen offset:0 sc1
  v_mfma_f32_16x16x32_bf16 v[44:47], v[84:87], v[96:99], v[44:47]
  ds_read_b64 v[146:147], v16 offset:1672
  s_waitcnt lgkmcnt(15)
  v_mfma_f32_16x16x32_bf16 v[48:51], v[64:67], v[120:123], 0
  ds_read_b128 v[180:183], v17 offset:2688
  v_mfma_f32_16x16x32_bf16 v[48:51], v[68:71], v[116:119], v[48:51]
  ds_read_b64 v[148:149], v16 offset:1152
  v_mfma_f32_16x16x32_bf16 v[48:51], v[72:75], v[112:115], v[48:51]
  ds_read_b64 v[150:151], v16 offset:1160
  buffer_load_dwordx4 a[20:23], v18, s[36:39], s34 offen offset:1024 sc1
  v_mfma_f32_16x16x32_bf16 v[48:51], v[76:79], v[108:111], v[48:51]
  ds_read_b128 v[184:187], v17 offset:3200
  v_mfma_f32_16x16x32_bf16 v[48:51], v[80:83], v[104:107], v[48:51]
  ds_read_b64 v[152:153], v16 offset:640
  v_mfma_f32_16x16x32_bf16 v[48:51], v[84:87], v[100:103], v[48:51]
  ds_read_b64 v[154:155], v16 offset:648
  v_mfma_f32_16x16x32_bf16 v[48:51], v[88:91], v[96:99], v[48:51]
  ds_read_b128 v[188:191], v17 offset:3712
  buffer_load_dwordx4 a[24:27], v18, s[36:39], s34 offen offset:2048 sc1
  s_waitcnt lgkmcnt(15)
  v_mfma_f32_16x16x32_bf16 v[52:55], v[64:67], v[124:127], 0
  ds_read_b64 v[156:157], v16 offset:128
  v_mfma_f32_16x16x32_bf16 v[52:55], v[68:71], v[120:123], v[52:55]
  ds_read_b64 v[158:159], v16 offset:136
  v_mfma_f32_16x16x32_bf16 v[52:55], v[72:75], v[116:119], v[52:55]
  v_mfma_f32_16x16x32_bf16 v[52:55], v[76:79], v[112:115], v[52:55]
  buffer_load_dwordx4 a[28:31], v18, s[36:39], s34 offen offset:3072 sc1
  s_add_u32 s34, s34, 4096
  v_mfma_f32_16x16x32_bf16 v[52:55], v[80:83], v[108:111], v[52:55]
  v_mfma_f32_16x16x32_bf16 v[52:55], v[84:87], v[104:107], v[52:55]
  v_mfma_f32_16x16x32_bf16 v[52:55], v[88:91], v[100:103], v[52:55]
  v_mfma_f32_16x16x32_bf16 v[52:55], v[92:95], v[96:99], v[52:55]
  buffer_load_dwordx4 a[32:35], v18, s[36:39], s34 offen offset:0 sc1
  s_waitcnt lgkmcnt(0)
  v_mfma_f32_16x16x32_bf16 v[24:27], v[128:131], v[160:163], v[24:27]
  ds_read_b128 v[96:99], v17 offset:64
  v_mfma_f32_16x16x32_bf16 v[28:31], v[128:131], v[164:167], v[28:31]
  ds_read_b64 v[64:65], v16 offset:3648
  v_mfma_f32_16x16x32_bf16 v[28:31], v[132:135], v[160:163], v[28:31]
  ds_read_b64 v[66:67], v16 offset:3656
  v_mfma_f32_16x16x32_bf16 v[32:35], v[128:131], v[168:171], v[32:35]
  ds_read_b128 v[100:103], v17 offset:576
  buffer_load_dwordx4 a[36:39], v18, s[36:39], s34 offen offset:1024 sc1
  v_mfma_f32_16x16x32_bf16 v[32:35], v[132:135], v[164:167], v[32:35]
  ds_read_b64 v[68:69], v16 offset:3136
  v_mfma_f32_16x16x32_bf16 v[32:35], v[136:139], v[160:163], v[32:35]
  ds_read_b64 v[70:71], v16 offset:3144
  v_mfma_f32_16x16x32_bf16 v[36:39], v[128:131], v[172:175], v[36:39]
  ds_read_b128 v[104:107], v17 offset:1088
  v_mfma_f32_16x16x32_bf16 v[36:39], v[132:135], v[168:171], v[36:39]
  ds_read_b64 v[72:73], v16 offset:2624
  buffer_load_dwordx4 a[40:43], v18, s[36:39], s34 offen offset:2048 sc1
  v_mfma_f32_16x16x32_bf16 v[36:39], v[136:139], v[164:167], v[36:39]
  ds_read_b64 v[74:75], v16 offset:2632
  v_mfma_f32_16x16x32_bf16 v[36:39], v[140:143], v[160:163], v[36:39]
  ds_read_b128 v[108:111], v17 offset:1600
  v_mfma_f32_16x16x32_bf16 v[40:43], v[128:131], v[176:179], v[40:43]
  ds_read_b64 v[76:77], v16 offset:2112
  v_mfma_f32_16x16x32_bf16 v[40:43], v[132:135], v[172:175], v[40:43]
  ds_read_b64 v[78:79], v16 offset:2120
  buffer_load_dwordx4 a[44:47], v18, s[36:39], s34 offen offset:3072 sc1
  s_add_u32 s34, s34, 4096
  v_mfma_f32_16x16x32_bf16 v[40:43], v[136:139], v[168:171], v[40:43]
  ds_read_b128 v[112:115], v17 offset:2112
  v_mfma_f32_16x16x32_bf16 v[40:43], v[140:143], v[164:167], v[40:43]
  ds_read_b64 v[80:81], v16 offset:1600
  v_mfma_f32_16x16x32_bf16 v[40:43], v[144:147], v[160:163], v[40:43]
  ds_read_b64 v[82:83], v16 offset:1608
  v_mfma_f32_16x16x32_bf16 v[44:47], v[128:131], v[180:183], v[44:47]
  ds_read_b128 v[116:119], v17 offset:2624
  buffer_load_dwordx4 a[48:51], v18, s[36:39], s34 offen offset:0 sc1
  v_mfma_f32_16x16x32_bf16 v[44:47], v[132:135], v[176:179], v[44:47]
  ds_read_b64 v[84:85], v16 offset:1088
  v_mfma_f32_16x16x32_bf16 v[44:47], v[136:139], v[172:175], v[44:47]
  ds_read_b64 v[86:87], v16 offset:1096
  v_mfma_f32_16x16x32_bf16 v[44:47], v[140:143], v[168:171], v[44:47]
  ds_read_b128 v[120:123], v17 offset:3136
  v_mfma_f32_16x16x32_bf16 v[44:47], v[144:147], v[164:167], v[44:47]
  ds_read_b64 v[88:89], v16 offset:576
  buffer_load_dwordx4 a[52:55], v18, s[36:39], s34 offen offset:1024 sc1
  v_mfma_f32_16x16x32_bf16 v[44:47], v[148:151], v[160:163], v[44:47]
  ds_read_b64 v[90:91], v16 offset:584
  v_mfma_f32_16x16x32_bf16 v[48:51], v[128:131], v[184:187], v[48:51]
  ds_read_b128 v[124:127], v17 offset:3648
  v_mfma_f32_16x16x32_bf16 v[48:51], v[132:135], v[180:183], v[48:51]
  ds_read_b64 v[92:93], v16 offset:64
  v_mfma_f32_16x16x32_bf16 v[48:51], v[136:139], v[176:179], v[48:51]
  ds_read_b64 v[94:95], v16 offset:72
  buffer_load_dwordx4 a[56:59], v18, s[36:39], s34 offen offset:2048 sc1
  v_mfma_f32_16x16x32_bf16 v[48:51], v[140:143], v[172:175], v[48:51]
  v_mfma_f32_16x16x32_bf16 v[48:51], v[144:147], v[168:171], v[48:51]
  v_mfma_f32_16x16x32_bf16 v[48:51], v[148:151], v[164:167], v[48:51]
  v_mfma_f32_16x16x32_bf16 v[48:51], v[152:155], v[160:163], v[48:51]
  buffer_load_dwordx4 a[60:63], v18, s[36:39], s34 offen offset:3072 sc1
  s_add_u32 s34, s34, 4096
  v_mfma_f32_16x16x32_bf16 v[52:55], v[128:131], v[188:191], v[52:55]
  v_mfma_f32_16x16x32_bf16 v[52:55], v[132:135], v[184:187], v[52:55]
  v_mfma_f32_16x16x32_bf16 v[52:55], v[136:139], v[180:183], v[52:55]
  v_mfma_f32_16x16x32_bf16 v[52:55], v[140:143], v[176:179], v[52:55]
  buffer_load_dwordx4 a[64:67], v18, s[36:39], s34 offen offset:0 sc1
  v_mfma_f32_16x16x32_bf16 v[52:55], v[144:147], v[172:175], v[52:55]
  v_mfma_f32_16x16x32_bf16 v[52:55], v[148:151], v[168:171], v[52:55]
  v_mfma_f32_16x16x32_bf16 v[52:55], v[152:155], v[164:167], v[52:55]
  v_mfma_f32_16x16x32_bf16 v[52:55], v[156:159], v[160:163], v[52:55]
  buffer_load_dwordx4 a[68:71], v18, s[36:39], s34 offen offset:1024 sc1
  s_waitcnt lgkmcnt(0)
  v_mfma_f32_16x16x32_bf16 v[24:27], v[64:67], v[96:99], v[24:27]
  ds_read_b128 v[160:163], v17 offset:0
  v_mfma_f32_16x16x32_bf16 v[28:31], v[64:67], v[100:103], v[28:31]
  ds_read_b64 v[128:129], v16 offset:3584
  v_mfma_f32_16x16x32_bf16 v[28:31], v[68:71], v[96:99], v[28:31]
  ds_read_b64 v[130:131], v16 offset:3592
  v_mfma_f32_16x16x32_bf16 v[32:35], v[64:67], v[104:107], v[32:35]
  ds_read_b128 v[164:167], v17 offset:512
  buffer_load_dwordx4 a[72:75], v18, s[36:39], s34 offen offset:2048 sc1
  v_mfma_f32_16x16x32_bf16 v[32:35], v[68:71], v[100:103], v[32:35]
  ds_read_b64 v[132:133], v16 offset:3072
  v_mfma_f32_16x16x32_bf16 v[32:35], v[72:75], v[96:99], v[32:35]
  ds_read_b64 v[134:135], v16 offset:3080
  v_mfma_f32_16x16x32_bf16 v[36:39], v[64:67], v[108:111], v[36:39]
  ds_read_b128 v[168:171], v17 offset:1024
  v_mfma_f32_16x16x32_bf16 v[36:39], v[68:71], v[104:107], v[36:39]
  ds_read_b64 v[136:137], v16 offset:2560
  buffer_load_dwordx4 a[76:79], v18, s[36:39], s34 offen offset:3072 sc1
  s_add_u32 s34, s34, 4096
  v_mfma_f32_16x16x32_bf16 v[36:39], v[72:75], v[100:103], v[36:39]
  ds_read_b64 v[138:139], v16 offset:2568
  v_mfma_f32_16x16x32_bf16 v[36:39], v[76:79], v[96:99], v[36:39]
  ds_read_b128 v[172:175], v17 offset:1536
  v_mfma_f32_16x16x32_bf16 v[40:43], v[64:67], v[112:115], v[40:43]
  ds_read_b64 v[140:141], v16 offset:2048
  v_mfma_f32_16x16x32_bf16 v[40:43], v[68:71], v[108:111], v[40:43]
  ds_read_b64 v[142:143], v16 offset:2056
  buffer_load_dwordx4 a[80:83], v18, s[36:39], s34 offen offset:0 sc1
  v_mfma_f32_16x16x32_bf16 v[40:43], v[72:75], v[104:107], v[40:43]
  ds_read_b128 v[176:179], v17 offset:2048
  v_mfma_f32_16x16x32_bf16 v[40:43], v[76:79], v[100:103], v[40:43]
  ds_read_b64 v[144:145], v16 offset:1536
  v_mfma_f32_16x16x32_bf16 v[40:43], v[80:83], v[96:99], v[40:43]
  ds_read_b64 v[146:147], v16 offset:1544
  v_mfma_f32_16x16x32_bf16 v[44:47], v[64:67], v[116:119], v[44:47]
  ds_read_b128 v[180:183], v17 offset:2560
  buffer_load_dwordx4 a[84:87], v18, s[36:39], s34 offen offset:1024 sc1
  v_mfma_f32_16x16x32_bf16 v[44:47], v[68:71], v[112:115], v[44:47]
  ds_read_b64 v[148:149], v16 offset:1024
  v_mfma_f32_16x16x32_bf16 v[44:47], v[72:75], v[108:111], v[44:47]
  ds_read_b64 v[150:151], v16 offset:1032
  v_mfma_f32_16x16x32_bf16 v[44:47], v[76:79], v[104:107], v[44:47]
  ds_read_b128 v[184:187], v17 offset:3072
  v_mfma_f32_16x16x32_bf16 v[44:47], v[80:83], v[100:103], v[44:47]
  ds_read_b64 v[152:153], v16 offset:512
  buffer_load_dwordx4 a[88:91], v18, s[36:39], s34 offen offset:2048 sc1
  v_mfma_f32_16x16x32_bf16 v[44:47], v[84:87], v[96:99], v[44:47]
  ds_read_b64 v[154:155], v16 offset:520
  v_mfma_f32_16x16x32_bf16 v[48:51], v[64:67], v[120:123], v[48:51]
  ds_read_b128 v[188:191], v17 offset:3584
  v_mfma_f32_16x16x32_bf16 v[48:51], v[68:71], v[116:119], v[48:51]
  ds_read_b64 v[156:157], v16 offset:0
  v_mfma_f32_16x16x32_bf16 v[48:51], v[72:75], v[112:115], v[48:51]
  ds_read_b64 v[158:159], v16 offset:8
  buffer_load_dwordx4 a[92:95], v18, s[36:39], s34 offen offset:3072 sc1
  s_add_u32 s34, s34, 4096
  v_mfma_f32_16x16x32_bf16 v[48:51], v[76:79], v[108:111], v[48:51]
  v_mfma_f32_16x16x32_bf16 v[48:51], v[80:83], v[104:107], v[48:51]
  v_mfma_f32_16x16x32_bf16 v[48:51], v[84:87], v[100:103], v[48:51]
  v_mfma_f32_16x16x32_bf16 v[48:51], v[88:91], v[96:99], v[48:51]
  buffer_load_dwordx4 a[96:99], v18, s[36:39], s34 offen offset:0 sc1
  v_mfma_f32_16x16x32_bf16 v[52:55], v[64:67], v[124:127], v[52:55]
  v_mfma_f32_16x16x32_bf16 v[52:55], v[68:71], v[120:123], v[52:55]
  v_mfma_f32_16x16x32_bf16 v[52:55], v[72:75], v[116:119], v[52:55]
  v_mfma_f32_16x16x32_bf16 v[52:55], v[76:79], v[112:115], v[52:55]
  buffer_load_dwordx4 a[100:103], v18, s[36:39], s34 offen offset:1024 sc1
  v_mfma_f32_16x16x32_bf16 v[52:55], v[80:83], v[108:111], v[52:55]
  v_mfma_f32_16x16x32_bf16 v[52:55], v[84:87], v[104:107], v[52:55]
  v_mfma_f32_16x16x32_bf16 v[52:55], v[88:91], v[100:103], v[52:55]
  v_mfma_f32_16x16x32_bf16 v[52:55], v[92:95], v[96:99], v[52:55]
  buffer_load_dwordx4 a[104:107], v18, s[36:39], s34 offen offset:2048 sc1
  s_waitcnt lgkmcnt(0)
  v_mfma_f32_16x16x32_bf16 v[24:27], v[128:131], v[160:163], v[24:27]
  ds_read_b64 v[64:65], v57 offset:0
  v_mfma_f32_16x16x32_bf16 v[28:31], v[128:131], v[164:167], v[28:31]
  ds_read_b64 v[72:73], v58 offset:0
  v_mfma_f32_16x16x32_bf16 v[28:31], v[132:135], v[160:163], v[28:31]
  ds_read_b64 v[66:67], v57 offset:512
  v_mfma_f32_16x16x32_bf16 v[32:35], v[128:131], v[168:171], v[32:35]
  ds_read_b64 v[74:75], v58 offset:512
  buffer_load_dwordx4 a[108:111], v18, s[36:39], s34 offen offset:3072 sc1
  s_add_u32 s34, s34, 4096
  v_mfma_f32_16x16x32_bf16 v[32:35], v[132:135], v[164:167], v[32:35]
  ds_read_b64 v[68:69], v57 offset:1024
  v_mfma_f32_16x16x32_bf16 v[32:35], v[136:139], v[160:163], v[32:35]
  ds_read_b64 v[76:77], v58 offset:1024
  v_mfma_f32_16x16x32_bf16 v[36:39], v[128:131], v[172:175], v[36:39]
  ds_read_b64 v[70:71], v57 offset:1536
  v_mfma_f32_16x16x32_bf16 v[36:39], v[132:135], v[168:171], v[36:39]
  ds_read_b64 v[78:79], v58 offset:1536
  buffer_load_dwordx4 a[112:115], v18, s[36:39], s34 offen offset:0 sc1
  v_mfma_f32_16x16x32_bf16 v[36:39], v[136:139], v[164:167], v[36:39]
  v_mfma_f32_16x16x32_bf16 v[36:39], v[140:143], v[160:163], v[36:39]
  v_mfma_f32_16x16x32_bf16 v[40:43], v[128:131], v[176:179], v[40:43]
  v_mfma_f32_16x16x32_bf16 v[40:43], v[132:135], v[172:175], v[40:43]
  buffer_load_dwordx4 a[116:119], v18, s[36:39], s34 offen offset:1024 sc1
  v_mfma_f32_16x16x32_bf16 v[40:43], v[136:139], v[168:171], v[40:43]
  s_waitcnt lgkmcnt(0)
  v_lshlrev_b32 v96, 16, v64
  v_mfma_f32_16x16x32_bf16 v[40:43], v[140:143], v[164:167], v[40:43]
  v_and_b32 v97, s76, v64
  v_lshlrev_b32 v112, 16, v72
  v_mfma_f32_16x16x32_bf16 v[40:43], v[144:147], v[160:163], v[40:43]
  v_and_b32 v113, s76, v72
  v_lshlrev_b32 v98, 16, v65
  v_mfma_f32_16x16x32_bf16 v[44:47], v[128:131], v[180:183], v[44:47]
  v_and_b32 v99, s76, v65
  v_lshlrev_b32 v114, 16, v73
  buffer_load_dwordx4 a[120:123], v18, s[36:39], s34 offen offset:2048 sc1
  v_mfma_f32_16x16x32_bf16 v[44:47], v[132:135], v[176:179], v[44:47]
  v_and_b32 v115, s76, v73
  v_lshlrev_b32 v100, 16, v66
  v_mfma_f32_16x16x32_bf16 v[44:47], v[136:139], v[172:175], v[44:47]
  v_and_b32 v101, s76, v66
  v_lshlrev_b32 v116, 16, v74
  v_mfma_f32_16x16x32_bf16 v[44:47], v[140:143], v[168:171], v[44:47]
  v_and_b32 v117, s76, v74
  v_lshlrev_b32 v102, 16, v67
  v_mfma_f32_16x16x32_bf16 v[44:47], v[144:147], v[164:167], v[44:47]
  v_and_b32 v103, s76, v67
  v_lshlrev_b32 v118, 16, v75
  buffer_load_dwordx4 a[124:127], v18, s[36:39], s34 offen offset:3072 sc1
  s_add_u32 s34, s34, 4096
  v_mfma_f32_16x16x32_bf16 v[44:47], v[148:151], v[160:163], v[44:47]
  v_and_b32 v119, s76, v75
  v_lshlrev_b32 v104, 16, v68
  v_mfma_f32_16x16x32_bf16 v[48:51], v[128:131], v[184:187], v[48:51]
  v_and_b32 v105, s76, v68
  v_lshlrev_b32 v120, 16, v76
  v_mfma_f32_16x16x32_bf16 v[48:51], v[132:135], v[180:183], v[48:51]
  v_and_b32 v121, s76, v76
  v_lshlrev_b32 v106, 16, v69
  v_mfma_f32_16x16x32_bf16 v[48:51], v[136:139], v[176:179], v[48:51]
  v_and_b32 v107, s76, v69
  v_lshlrev_b32 v122, 16, v77
  buffer_load_dwordx4 a[128:131], v18, s[36:39], s34 offen offset:0 sc1
  v_mfma_f32_16x16x32_bf16 v[48:51], v[140:143], v[172:175], v[48:51]
  v_and_b32 v123, s76, v77
  v_lshlrev_b32 v108, 16, v70
  v_mfma_f32_16x16x32_bf16 v[48:51], v[144:147], v[168:171], v[48:51]
  v_and_b32 v109, s76, v70
  v_lshlrev_b32 v124, 16, v78
  v_mfma_f32_16x16x32_bf16 v[48:51], v[148:151], v[164:167], v[48:51]
  v_and_b32 v125, s76, v78
  v_lshlrev_b32 v110, 16, v71
  v_mfma_f32_16x16x32_bf16 v[48:51], v[152:155], v[160:163], v[48:51]
  v_and_b32 v111, s76, v71
  v_lshlrev_b32 v126, 16, v79
  buffer_load_dwordx4 a[132:135], v18, s[36:39], s34 offen offset:1024 sc1
  v_mfma_f32_16x16x32_bf16 v[52:55], v[128:131], v[188:191], v[52:55]
  v_and_b32 v127, s76, v79
  v_pk_fma_f32 v[96:97], v[96:97], s[58:59], v[112:113]
  v_mfma_f32_16x16x32_bf16 v[52:55], v[132:135], v[184:187], v[52:55]
  v_pk_fma_f32 v[98:99], v[98:99], s[58:59], v[114:115]
  v_pk_fma_f32 v[100:101], v[100:101], s[58:59], v[116:117]
  v_mfma_f32_16x16x32_bf16 v[52:55], v[136:139], v[180:183], v[52:55]
  v_pk_fma_f32 v[102:103], v[102:103], s[58:59], v[118:119]
  v_pk_fma_f32 v[104:105], v[104:105], s[58:59], v[120:121]
  v_mfma_f32_16x16x32_bf16 v[52:55], v[140:143], v[176:179], v[52:55]
  v_pk_fma_f32 v[106:107], v[106:107], s[58:59], v[122:123]
  v_pk_fma_f32 v[108:109], v[108:109], s[58:59], v[124:125]
  buffer_load_dwordx4 a[136:139], v18, s[36:39], s34 offen offset:2048 sc1
  v_mfma_f32_16x16x32_bf16 v[52:55], v[144:147], v[172:175], v[52:55]
  v_pk_fma_f32 v[110:111], v[110:111], s[58:59], v[126:127]
  v_mfma_f32_16x16x32_bf16 v[52:55], v[148:151], v[168:171], v[52:55]
  v_mfma_f32_16x16x32_bf16 v[52:55], v[152:155], v[164:167], v[52:55]
  v_mfma_f32_16x16x32_bf16 v[52:55], v[156:159], v[160:163], v[52:55]
  buffer_load_dwordx4 a[140:143], v18, s[36:39], s34 offen offset:3072 sc1
  s_add_u32 s34, s34, 4096
  s_cmp_eq_u32 s5, 1
  s_cbranch_scc1 L_p1_17
  s_nop 3
  ds_write_b128 v59, v[40:43] offset:0
  ds_write_b128 v59, v[44:47] offset:1024
  ds_write_b128 v59, v[48:51] offset:2048
  ds_write_b128 v59, v[52:55] offset:3072
  s_branch L_pj_18
L_p1_17:
  ds_write_b128 v59, v[24:27] offset:0
  ds_write_b128 v59, v[28:31] offset:1024
  ds_write_b128 v59, v[32:35] offset:2048
  ds_write_b128 v59, v[36:39] offset:3072
  s_nop 3
  v_mov_b64 v[24:25], v[40:41]
  v_mov_b64 v[26:27], v[42:43]
  v_mov_b64 v[28:29], v[44:45]
  v_mov_b64 v[30:31], v[46:47]
  v_mov_b64 v[32:33], v[48:49]
  v_mov_b64 v[34:35], v[50:51]
  v_mov_b64 v[36:37], v[52:53]
  v_mov_b64 v[38:39], v[54:55]
L_pj_18:
  v_pk_add_f32 v[96:97], v[96:97], v[24:25]
  v_pk_add_f32 v[98:99], v[98:99], v[26:27]
  v_pk_add_f32 v[100:101], v[100:101], v[28:29]
  v_pk_add_f32 v[102:103], v[102:103], v[30:31]
  v_pk_add_f32 v[104:105], v[104:105], v[32:33]
  v_pk_add_f32 v[106:107], v[106:107], v[34:35]
  v_pk_add_f32 v[108:109], v[108:109], v[36:37]
  v_pk_add_f32 v[110:111], v[110:111], v[38:39]
  s_waitcnt lgkmcnt(0)
  s_barrier
  ds_read_b128 v[80:83], v60 offset:0
  ds_read_b128 v[84:87], v60 offset:1024
  ds_read_b128 v[88:91], v60 offset:2048
  ds_read_b128 v[92:95], v60 offset:3072
  s_waitcnt vmcnt(36)
  s_waitcnt lgkmcnt(3)
  v_pk_add_f32 v[96:97], v[96:97], v[80:81]
  v_pk_add_f32 v[98:99], v[98:99], v[82:83]
  v_cvt_pk_bf16_f32 v64, v96, v97
  v_cvt_pk_bf16_f32 v65, v98, v99
  buffer_store_dwordx2 v[64:65], v56, s[36:39], s6 offen offset:0 sc1
  s_waitcnt lgkmcnt(2)
  v_pk_add_f32 v[100:101], v[100:101], v[84:85]
  v_pk_add_f32 v[102:103], v[102:103], v[86:87]
  v_cvt_pk_bf16_f32 v66, v100, v101
  v_cvt_pk_bf16_f32 v67, v102, v103
  buffer_store_dwordx2 v[66:67], v56, s[36:39], s6 offen offset:512 sc1
  s_waitcnt lgkmcnt(1)
  v_pk_add_f32 v[104:105], v[104:105], v[88:89]
  v_pk_add_f32 v[106:107], v[106:107], v[90:91]
  v_cvt_pk_bf16_f32 v68, v104, v105
  v_cvt_pk_bf16_f32 v69, v106, v107
  buffer_store_dwordx2 v[68:69], v56, s[36:39], s6 offen offset:1024 sc1
  s_waitcnt lgkmcnt(0)
  v_pk_add_f32 v[108:109], v[108:109], v[92:93]
  v_pk_add_f32 v[110:111], v[110:111], v[94:95]
  v_cvt_pk_bf16_f32 v70, v108, v109
  v_cvt_pk_bf16_f32 v71, v110, v111
  buffer_store_dwordx2 v[70:71], v56, s[36:39], s6 offen offset:1536 sc1
  buffer_load_dwordx4 a[144:147], v18, s[36:39], s34 offen offset:0 sc1
  buffer_load_dwordx4 a[148:151], v18, s[36:39], s34 offen offset:1024 sc1
  buffer_load_dwordx4 a[152:155], v18, s[36:39], s34 offen offset:2048 sc1
  buffer_load_dwordx4 a[156:159], v18, s[36:39], s34 offen offset:3072 sc1
  s_add_u32 s34, s34, 4096
  buffer_load_dwordx4 a[160:163], v18, s[36:39], s34 offen offset:0 sc1
  buffer_load_dwordx4 a[164:167], v18, s[36:39], s34 offen offset:1024 sc1
  buffer_load_dwordx4 a[168:171], v18, s[36:39], s34 offen offset:2048 sc1
  buffer_load_dwordx4 a[172:175], v18, s[36:39], s34 offen offset:3072 sc1
  s_add_u32 s34, s34, 4096
  buffer_load_dwordx4 a[176:179], v18, s[36:39], s34 offen offset:0 sc1
  buffer_load_dwordx4 a[180:183], v18, s[36:39], s34 offen offset:1024 sc1
  buffer_load_dwordx4 a[184:187], v18, s[36:39], s34 offen offset:2048 sc1
  buffer_load_dwordx4 a[188:191], v18, s[36:39], s34 offen offset:3072 sc1
  s_add_u32 s34, s34, 4096
  v_lshrrev_b32 v10, 3, v1
  v_mul_u32_u24 v10, 4224, v10
  v_bfe_u32 v11, v1, 4, 2
  v_lshlrev_b32 v11, 1, v11
  v_and_b32 v16, 7, v1
  v_xor_b32 v11, v11, v16
  v_lshl_add_u32 v10, v11, 4, v10
  s_lshl_b32 s54, s48, 7
  v_add_u32 v19, s54, v10
  s_mul_i32 s4, s44, 135168
  s_add_u32 s4, s4, 4849664
  s_lshl_b32 s5, s44, 12
  s_add_u32 s5, s5, 66560
  v_lshrrev_b32 v10, 2, v1
  v_lshlrev_b32 v10, 7, v10
  v_and_b32 v11, 3, v1
  v_lshl_add_u32 v10, v11, 3, v10
  v_add_u32 v10, 66560, v10
  v_bfe_u32 v11, v1, 3, 2
  s_add_u32 s54, s44, 0
  s_and_b32 s54, s54, 3
  s_lshl_b32 s68, s54, 6
  v_xor_b32 v16, s54, v11
  v_lshl_add_u32 v12, v16, 5, v10
  s_add_u32 s54, s44, 1
  s_and_b32 s54, s54, 3
  s_lshl_b32 s69, s54, 6
  v_xor_b32 v16, s54, v11
  v_lshl_add_u32 v13, v16, 5, v10
  s_add_u32 s54, s44, 2
  s_and_b32 s54, s54, 3
  s_lshl_b32 s70, s54, 6
  v_xor_b32 v16, s54, v11
  v_lshl_add_u32 v14, v16, 5, v10
  s_add_u32 s54, s44, 3
  s_and_b32 s54, s54, 3
  s_lshl_b32 s71, s54, 6
  v_xor_b32 v16, s54, v11
  v_lshl_add_u32 v15, v16, 5, v10
  v_mov_b32 v152, 0x3f803f80
  v_mov_b32 v153, 0x3f803f80
  v_mov_b32 v154, 0x3f803f80
  v_mov_b32 v155, 0x3f803f80
  v_lshrrev_b32 v11, 5, v1
  v_lshlrev_b32 v11, 4, v11
  v_bfe_u32 v16, v1, 2, 2
  v_add_u32 v11, v11, v16
  s_lshl_b32 s54, s51, 7
  s_lshl_b32 s55, s44, 5
  s_add_u32 s54, s54, s55
  v_add_u32 v11, s54, v11
  v_lshlrev_b32 v11, 7, v11
  v_and_b32 v16, 3, v1
  v_lshl_add_u32 v11, v16, 3, v11
  v_add_u32 v11, 66560, v11
  s_and_b32 s54, s49, 1
  s_lshl_b32 s54, s54, 1
  v_bfe_u32 v16, v1, 4, 1
  v_add_u32 v16, s54, v16
  v_bfe_u32 v17, v1, 3, 1
  v_xor_b32 v16, v16, v17
  v_lshl_add_u32 v156, v16, 5, v11
  v_xor_b32 v16, 2, v16
  v_lshl_add_u32 v157, v16, 5, v11
  v_and_b32 v10, 15, v1
  v_lshlrev_b32 v10, 2, v10
  v_add_u32 v11, 132096, v10
  s_lshl_b32 s54, s44, 6
  v_add_u32 v158, s54, v11
  v_lshrrev_b32 v10, 4, v1
  v_lshlrev_b32 v10, 4, v10
  v_add_u32 v10, 132096, v10
  v_add_u32 v160, s68, v10
  v_add_u32 v164, s68, v11
  v_add_u32 v161, s69, v10
  v_add_u32 v165, s69, v11
  v_add_u32 v162, s70, v10
  v_add_u32 v166, s70, v11
  v_add_u32 v163, s71, v10
  v_add_u32 v167, s71, v11
  v_and_b32 v10, 15, v1
  v_lshlrev_b32 v10, 4, v10
  v_bfe_u32 v11, v1, 4, 1
  v_lshl_add_u32 v10, v11, 3, v10
  v_lshrrev_b32 v11, 5, v1
  v_lshl_add_u32 v168, v11, 10, v10
  v_lshrrev_b32 v10, 4, v1
  v_lshlrev_b32 v10, 8, v10
  v_and_b32 v11, 15, v1
  v_lshl_add_u32 v169, v11, 2, v10
  v_lshlrev_b32 v183, 2, v1
  s_lshl_b32 s6, s49, 5
  s_add_u32 s6, s6, s48
  s_lshl_b32 s6, s6, 2
  s_add_u32 s6, s6, s44
  s_mul_i32 s6, s6, 1152
  s_add_u32 s6, s6, 262144
  s_lshl_b32 s7, s49, 2
  s_add_u32 s7, s7, s44
  s_mul_i32 s7, s7, 65792
  s_lshl_b32 s63, s48, 11
  s_add_u32 s7, s7, s63
  s_add_u32 s7, s7, 11534336
  s_lshl_b32 s54, s49, 5
  s_mul_i32 s54, s54, 4608
  s_lshr_b32 s55, s48, 3
  s_mul_i32 s55, s55, 1152
  s_add_u32 s54, s54, s55
  s_add_u32 s3, s54, 262144
  s_and_b32 s56, s48, 7
  s_cmp_eq_u32 s44, 2
  s_cselect_b32 s57, 3, 7
  s_cselect_b32 s58, 1, 0
  s_mov_b32 s42, 0x0f0f0f0f
  s_cselect_b32 s42, s42, -1
  s_mov_b32 s43, s42
  s_lshl_b32 s59, s56, 7
  s_cmp_eq_u32 s44, 2
  s_cselect_b32 s59, 1024, s59
  s_lshl_b32 s60, s56, 6
  v_lshrrev_b32 v10, 3, v1
  v_mul_u32_u24 v10, 4608, v10
  v_and_b32 v11, s57, v1
  v_lshl_add_u32 v11, v11, 4, v10
  v_add_u32 v170, s59, v11
  s_lshl_b32 s60, s56, 6
  s_cmp_eq_u32 s44, 2
  s_cselect_b32 s60, 512, s60
  v_lshrrev_b32 v10, 3, v1
  v_mul_u32_u24 v10, 20608, v10
  v_and_b32 v11, 7, v1
  v_lshl_add_u32 v10, v11, 3, v10
  v_add_u32 v171, s60, v10
  s_lshr_b32 s40, s48, 3
  s_lshl_b32 s63, s49, 2
  s_add_u32 s40, s40, s63
  s_mul_i32 s40, s40, 640
  s_add_u32 s40, s40, 17825792
  s_cmp_eq_u32 s56, 0
  s_cselect_b32 s57, 2, 3
  s_cmp_ge_u32 s44, s57
  s_cselect_b32 s41, 1, 0
  v_and_b32 v10, 3, v1
  v_cmp_eq_u32 s[72:73], 1, v10
  v_cmp_eq_u32 s[74:75], 2, v10
  v_lshlrev_b32 v18, 4, v1
  s_lshl_b32 s34, s51, 2
  s_add_u32 s34, s34, s44
  s_lshl_b32 s34, s34, 15
  s_add_u32 s34, s34, 4325376
  s_waitcnt vmcnt(0)
  v_mfma_f32_16x16x32_bf16 v[28:31], v[152:155], a[0:3], 0
  v_mfma_f32_16x16x32_bf16 v[32:35], v[152:155], a[64:67], 0
  v_mfma_f32_16x16x32_bf16 v[36:39], a[128:131], v[152:155], 0
  v_mfma_f32_16x16x32_bf16 v[28:31], v[152:155], a[4:7], v[28:31]
  v_mfma_f32_16x16x32_bf16 v[32:35], v[152:155], a[68:71], v[32:35]
  v_mfma_f32_16x16x32_bf16 v[36:39], a[132:135], v[152:155], v[36:39]
  v_mfma_f32_16x16x32_bf16 v[28:31], v[152:155], a[8:11], v[28:31]
  v_mfma_f32_16x16x32_bf16 v[32:35], v[152:155], a[72:75], v[32:35]
  v_mfma_f32_16x16x32_bf16 v[36:39], a[136:139], v[152:155], v[36:39]
  v_mfma_f32_16x16x32_bf16 v[28:31], v[152:155], a[12:15], v[28:31]
  v_mfma_f32_16x16x32_bf16 v[32:35], v[152:155], a[76:79], v[32:35]
  v_mfma_f32_16x16x32_bf16 v[36:39], a[140:143], v[152:155], v[36:39]
  v_mfma_f32_16x16x32_bf16 v[28:31], v[152:155], a[16:19], v[28:31]
  v_mfma_f32_16x16x32_bf16 v[32:35], v[152:155], a[80:83], v[32:35]
  v_mfma_f32_16x16x32_bf16 v[36:39], a[144:147], v[152:155], v[36:39]
  v_mfma_f32_16x16x32_bf16 v[28:31], v[152:155], a[20:23], v[28:31]
  v_mfma_f32_16x16x32_bf16 v[32:35], v[152:155], a[84:87], v[32:35]
  v_mfma_f32_16x16x32_bf16 v[36:39], a[148:151], v[152:155], v[36:39]
  v_mfma_f32_16x16x32_bf16 v[28:31], v[152:155], a[24:27], v[28:31]
  v_mfma_f32_16x16x32_bf16 v[32:35], v[152:155], a[88:91], v[32:35]
  v_mfma_f32_16x16x32_bf16 v[36:39], a[152:155], v[152:155], v[36:39]
  v_mfma_f32_16x16x32_bf16 v[28:31], v[152:155], a[28:31], v[28:31]
  v_mfma_f32_16x16x32_bf16 v[32:35], v[152:155], a[92:95], v[32:35]
  v_mfma_f32_16x16x32_bf16 v[36:39], a[156:159], v[152:155], v[36:39]
  v_mfma_f32_16x16x32_bf16 v[28:31], v[152:155], a[32:35], v[28:31]
  v_mfma_f32_16x16x32_bf16 v[32:35], v[152:155], a[96:99], v[32:35]
  v_mfma_f32_16x16x32_bf16 v[36:39], a[160:163], v[152:155], v[36:39]
  v_mfma_f32_16x16x32_bf16 v[28:31], v[152:155], a[36:39], v[28:31]
  v_mfma_f32_16x16x32_bf16 v[32:35], v[152:155], a[100:103], v[32:35]
  v_mfma_f32_16x16x32_bf16 v[36:39], a[164:167], v[152:155], v[36:39]
  v_mfma_f32_16x16x32_bf16 v[28:31], v[152:155], a[40:43], v[28:31]
  v_mfma_f32_16x16x32_bf16 v[32:35], v[152:155], a[104:107], v[32:35]
  v_mfma_f32_16x16x32_bf16 v[36:39], a[168:171], v[152:155], v[36:39]
  v_mfma_f32_16x16x32_bf16 v[28:31], v[152:155], a[44:47], v[28:31]
  v_mfma_f32_16x16x32_bf16 v[32:35], v[152:155], a[108:111], v[32:35]
  v_mfma_f32_16x16x32_bf16 v[36:39], a[172:175], v[152:155], v[36:39]
  v_mfma_f32_16x16x32_bf16 v[28:31], v[152:155], a[48:51], v[28:31]
  v_mfma_f32_16x16x32_bf16 v[32:35], v[152:155], a[112:115], v[32:35]
  v_mfma_f32_16x16x32_bf16 v[36:39], a[176:179], v[152:155], v[36:39]
  v_mfma_f32_16x16x32_bf16 v[28:31], v[152:155], a[52:55], v[28:31]
  v_mfma_f32_16x16x32_bf16 v[32:35], v[152:155], a[116:119], v[32:35]
  v_mfma_f32_16x16x32_bf16 v[36:39], a[180:183], v[152:155], v[36:39]
  v_mfma_f32_16x16x32_bf16 v[28:31], v[152:155], a[56:59], v[28:31]
  v_mfma_f32_16x16x32_bf16 v[32:35], v[152:155], a[120:123], v[32:35]
  v_mfma_f32_16x16x32_bf16 v[36:39], a[184:187], v[152:155], v[36:39]
  v_mfma_f32_16x16x32_bf16 v[28:31], v[152:155], a[60:63], v[28:31]
  v_mfma_f32_16x16x32_bf16 v[32:35], v[152:155], a[124:127], v[32:35]
  v_mfma_f32_16x16x32_bf16 v[36:39], a[188:191], v[152:155], v[36:39]
  s_nop 5
  v_sub_f32 v2, 0, v28
  v_sub_f32 v3, 0, v28
  v_sub_f32 v4, 0, v32
  v_sub_f32 v5, 0, v32
  v_sub_f32 v6, 0, v36
  v_sub_f32 v7, 0, v37
  v_sub_f32 v8, 0, v38
  v_sub_f32 v9, 0, v39
  v_lshl_add_u32 v21, v1, 4, s5
  s_barrier
  s_sleep 2
  s_add_u32 s54, s4, 0
  s_add_u32 m0, s5, 0
  s_nop 0
  buffer_load_dwordx4 v19, s[36:39], s54 offen sc1 lds
  s_add_u32 s54, s4, 33792
  s_add_u32 m0, s5, 1024
  s_nop 0
  buffer_load_dwordx4 v19, s[36:39], s54 offen sc1 lds
  s_add_u32 s54, s4, 67584
  s_add_u32 m0, s5, 2048
  s_nop 0
  buffer_load_dwordx4 v19, s[36:39], s54 offen sc1 lds
  s_add_u32 s54, s4, 101376
  s_add_u32 m0, s5, 3072
  s_nop 0
  buffer_load_dwordx4 v19, s[36:39], s54 offen sc1 lds
  s_add_u32 s54, s4, 540672
  s_add_u32 m0, s5, 16384
  s_nop 0
  buffer_load_dwordx4 v19, s[36:39], s54 offen sc1 lds
  s_add_u32 s54, s4, 574464
  s_add_u32 m0, s5, 17408
  s_nop 0
  buffer_load_dwordx4 v19, s[36:39], s54 offen sc1 lds
  s_add_u32 s54, s4, 608256
  s_add_u32 m0, s5, 18432
  s_nop 0
  buffer_load_dwordx4 v19, s[36:39], s54 offen sc1 lds
  s_add_u32 s54, s4, 642048
  s_add_u32 m0, s5, 19456
  s_nop 0
  buffer_load_dwordx4 v19, s[36:39], s54 offen sc1 lds
  s_add_u32 s54, s4, 1081344
  s_add_u32 m0, s5, 32768
  s_nop 0
  buffer_load_dwordx4 v19, s[36:39], s54 offen sc1 lds
  s_add_u32 s54, s4, 1115136
  s_add_u32 m0, s5, 33792
  s_nop 0
  buffer_load_dwordx4 v19, s[36:39], s54 offen sc1 lds
  s_add_u32 s54, s4, 1148928
  s_add_u32 m0, s5, 34816
  s_nop 0
  buffer_load_dwordx4 v19, s[36:39], s54 offen sc1 lds
  s_add_u32 s54, s4, 1182720
  s_add_u32 m0, s5, 35840
  s_nop 0
  buffer_load_dwordx4 v19, s[36:39], s54 offen sc1 lds
  v_mov_b32 v176, -1
  v_mov_b32 v177, -1
  v_mov_b32 v178, -1
  v_mov_b32 v179, -1
  s_lshr_b32 s62, s44, 1
  s_lshl_b32 s61, s47, 1
  s_add_u32 s62, s62, s61
  s_mul_i32 s62, s62, 4224
  s_and_b32 s61, s44, 1
  s_lshl_b32 s61, s61, 11
  s_add_u32 s62, s62, s61
  s_add_u32 s62, s62, 7077888
  s_lshl_b32 s63, s51, 7
  s_lshl_b32 s61, s44, 5
  s_add_u32 s63, s63, s61
  s_lshl_b32 s63, s63, 6
  s_mul_i32 s61, s50, 33024
  s_add_u32 s63, s63, s61
  s_add_u32 s63, s63, 21037056
  s_lshl_b32 s60, s50, 2
  s_add_u32 s60, s60, s51
  s_lshl_b32 s60, s60, 8
  s_add_u32 s60, s60, 196608
  s_waitcnt vmcnt(8)
L_gv_19:
  ds_read_b32 v56, v21 offset:0
  ds_read_b32 v57, v21 offset:1024
  ds_read_b32 v58, v21 offset:2048
  ds_read_b32 v59, v21 offset:3072
  s_waitcnt lgkmcnt(0)
  v_max3_u32 v56, v56, v57, v58
  v_max_u32 v56, v56, v59
  v_cmp_eq_u32 vcc, -1, v56
  s_cbranch_vccz L_gvk_20
  s_sub_u32 s52, s52, 1
  s_cbranch_scc1 L_gvx_21
  s_sleep 8
  s_add_u32 s54, s4, 0
  s_add_u32 m0, s5, 0
  s_nop 0
  buffer_load_dwordx4 v19, s[36:39], s54 offen sc1 lds
  s_add_u32 s54, s4, 33792
  s_add_u32 m0, s5, 1024
  s_nop 0
  buffer_load_dwordx4 v19, s[36:39], s54 offen sc1 lds
  s_add_u32 s54, s4, 67584
  s_add_u32 m0, s5, 2048
  s_nop 0
  buffer_load_dwordx4 v19, s[36:39], s54 offen sc1 lds
  s_add_u32 s54, s4, 101376
  s_add_u32 m0, s5, 3072
  s_nop 0
  buffer_load_dwordx4 v19, s[36:39], s54 offen sc1 lds
  s_add_u32 s54, s4, 540672
  s_add_u32 m0, s5, 16384
  s_nop 0
  buffer_load_dwordx4 v19, s[36:39], s54 offen sc1 lds
  s_add_u32 s54, s4, 574464
  s_add_u32 m0, s5, 17408
  s_nop 0
  buffer_load_dwordx4 v19, s[36:39], s54 offen sc1 lds
  s_add_u32 s54, s4, 608256
  s_add_u32 m0, s5, 18432
  s_nop 0
  buffer_load_dwordx4 v19, s[36:39], s54 offen sc1 lds
  s_add_u32 s54, s4, 642048
  s_add_u32 m0, s5, 19456
  s_nop 0
  buffer_load_dwordx4 v19, s[36:39], s54 offen sc1 lds
  s_add_u32 s54, s4, 1081344
  s_add_u32 m0, s5, 32768
  s_nop 0
  buffer_load_dwordx4 v19, s[36:39], s54 offen sc1 lds
  s_add_u32 s54, s4, 1115136
  s_add_u32 m0, s5, 33792
  s_nop 0
  buffer_load_dwordx4 v19, s[36:39], s54 offen sc1 lds
  s_add_u32 s54, s4, 1148928
  s_add_u32 m0, s5, 34816
  s_nop 0
  buffer_load_dwordx4 v19, s[36:39], s54 offen sc1 lds
  s_add_u32 s54, s4, 1182720
  s_add_u32 m0, s5, 35840
  s_nop 0
  buffer_load_dwordx4 v19, s[36:39], s54 offen sc1 lds
  s_waitcnt vmcnt(8)
  s_branch L_gv_19
L_gvx_21:
  s_mov_b32 s52, 0
L_gvk_20:
  s_barrier
  ds_read_b64_tr_b16 v[64:65], v12 offset:0
  ds_read_b64_tr_b16 v[66:67], v12 offset:2048
  ds_read_b64_tr_b16 v[68:69], v13 offset:0
  ds_read_b64_tr_b16 v[70:71], v13 offset:2048
  ds_read_b64_tr_b16 v[72:73], v14 offset:0
  ds_read_b64_tr_b16 v[74:75], v14 offset:2048
  ds_read_b64_tr_b16 v[76:77], v15 offset:0
  ds_read_b64_tr_b16 v[78:79], v15 offset:2048
  s_waitcnt lgkmcnt(0)
  v_mfma_f32_16x16x32_bf16 v[96:99], v[64:67], a[0:3], 0
  ds_read_b64_tr_b16 v[80:81], v12 offset:4096
  v_mfma_f32_16x16x32_bf16 v[144:147], v[64:67], v[64:67], 0
  ds_read_b64_tr_b16 v[82:83], v12 offset:6144
  s_add_u32 s54, s4, 1622016
  s_add_u32 m0, s5, 49152
  s_nop 0
  buffer_load_dwordx4 v19, s[36:39], s54 offen sc1 lds
  v_mfma_f32_16x16x32_bf16 v[112:115], v[64:67], a[64:67], 0
  ds_read_b64_tr_b16 v[84:85], v13 offset:4096
  v_mfma_f32_16x16x32_bf16 v[148:151], v[152:155], v[64:67], 0
  ds_read_b64_tr_b16 v[86:87], v13 offset:6144
  v_mfma_f32_16x16x32_bf16 v[100:103], v[68:71], a[0:3], 0
  ds_read_b64_tr_b16 v[88:89], v14 offset:4096
  s_add_u32 s54, s4, 1655808
  s_add_u32 m0, s5, 50176
  s_nop 0
  buffer_load_dwordx4 v19, s[36:39], s54 offen sc1 lds
  v_mfma_f32_16x16x32_bf16 v[116:119], v[68:71], a[64:67], 0
  ds_read_b64_tr_b16 v[90:91], v14 offset:6144
  v_mfma_f32_16x16x32_bf16 v[104:107], v[72:75], a[0:3], 0
  ds_read_b64_tr_b16 v[92:93], v15 offset:4096
  v_mfma_f32_16x16x32_bf16 v[120:123], v[72:75], a[64:67], 0
  ds_read_b64_tr_b16 v[94:95], v15 offset:6144
  s_add_u32 s54, s4, 1689600
  s_add_u32 m0, s5, 51200
  s_nop 0
  buffer_load_dwordx4 v19, s[36:39], s54 offen sc1 lds
  v_mfma_f32_16x16x32_bf16 v[108:111], v[76:79], a[0:3], 0
  v_mfma_f32_16x16x32_bf16 v[124:127], v[76:79], a[64:67], 0
  s_waitcnt lgkmcnt(0)
  s_waitcnt vmcnt(7)
  v_mfma_f32_16x16x32_bf16 v[96:99], v[80:83], a[4:7], v[96:99]
  ds_read_b64_tr_b16 v[64:65], v12 offset:8192
  v_mfma_f32_16x16x32_bf16 v[144:147], v[80:83], v[80:83], v[144:147]
  ds_read_b64_tr_b16 v[66:67], v12 offset:10240
  s_add_u32 s54, s4, 1723392
  s_add_u32 m0, s5, 52224
  s_nop 0
  buffer_load_dwordx4 v19, s[36:39], s54 offen sc1 lds
  v_mfma_f32_16x16x32_bf16 v[112:115], v[80:83], a[68:71], v[112:115]
  ds_read_b64_tr_b16 v[68:69], v13 offset:8192
  v_mfma_f32_16x16x32_bf16 v[148:151], v[152:155], v[80:83], v[148:151]
  ds_read_b64_tr_b16 v[70:71], v13 offset:10240
  v_mfma_f32_16x16x32_bf16 v[100:103], v[84:87], a[4:7], v[100:103]
  ds_read_b64_tr_b16 v[72:73], v14 offset:8192
  v_mfma_f32_16x16x32_bf16 v[116:119], v[84:87], a[68:71], v[116:119]
  ds_read_b64_tr_b16 v[74:75], v14 offset:10240
  v_mfma_f32_16x16x32_bf16 v[104:107], v[88:91], a[4:7], v[104:107]
  ds_read_b64_tr_b16 v[76:77], v15 offset:8192
  v_mfma_f32_16x16x32_bf16 v[120:123], v[88:91], a[68:71], v[120:123]
  ds_read_b64_tr_b16 v[78:79], v15 offset:10240
  v_mfma_f32_16x16x32_bf16 v[108:111], v[92:95], a[4:7], v[108:111]
  ds_read_b32 v56, v21 offset:16384
  v_mfma_f32_16x16x32_bf16 v[124:127], v[92:95], a[68:71], v[124:127]
  ds_read_b32 v57, v21 offset:17408
  ds_read_b32 v58, v21 offset:18432
  ds_read_b32 v59, v21 offset:19456
  s_waitcnt lgkmcnt(0)
  v_mfma_f32_16x16x32_bf16 v[96:99], v[64:67], a[8:11], v[96:99]
  ds_read_b64_tr_b16 v[80:81], v12 offset:12288
  v_mfma_f32_16x16x32_bf16 v[144:147], v[64:67], v[64:67], v[144:147]
  ds_read_b64_tr_b16 v[82:83], v12 offset:14336
  v_mfma_f32_16x16x32_bf16 v[112:115], v[64:67], a[72:75], v[112:115]
  ds_read_b64_tr_b16 v[84:85], v13 offset:12288
  v_max3_u32 v56, v56, v57, v58
  v_mfma_f32_16x16x32_bf16 v[148:151], v[152:155], v[64:67], v[148:151]
  ds_read_b64_tr_b16 v[86:87], v13 offset:14336
  v_mfma_f32_16x16x32_bf16 v[100:103], v[68:71], a[8:11], v[100:103]
  ds_read_b64_tr_b16 v[88:89], v14 offset:12288
  v_max_u32 v56, v56, v59
  v_mfma_f32_16x16x32_bf16 v[116:119], v[68:71], a[72:75], v[116:119]
  ds_read_b64_tr_b16 v[90:91], v14 offset:14336
  v_mfma_f32_16x16x32_bf16 v[104:107], v[72:75], a[8:11], v[104:107]
  ds_read_b64_tr_b16 v[92:93], v15 offset:12288
  v_cmp_eq_u32 vcc, -1, v56
  v_mfma_f32_16x16x32_bf16 v[120:123], v[72:75], a[72:75], v[120:123]
  ds_read_b64_tr_b16 v[94:95], v15 offset:14336
  v_mfma_f32_16x16x32_bf16 v[108:111], v[76:79], a[8:11], v[108:111]
  v_mfma_f32_16x16x32_bf16 v[124:127], v[76:79], a[72:75], v[124:127]
  s_cbranch_vccz L_gok_22
  s_add_u32 s54, s4, 540672
  s_add_u32 m0, s5, 16384
  s_nop 0
  buffer_load_dwordx4 v19, s[36:39], s54 offen sc1 lds
  s_add_u32 s54, s4, 574464
  s_add_u32 m0, s5, 17408
  s_nop 0
  buffer_load_dwordx4 v19, s[36:39], s54 offen sc1 lds
  s_add_u32 s54, s4, 608256
  s_add_u32 m0, s5, 18432
  s_nop 0
  buffer_load_dwordx4 v19, s[36:39], s54 offen sc1 lds
  s_add_u32 s54, s4, 642048
  s_add_u32 m0, s5, 19456
  s_nop 0
  buffer_load_dwordx4 v19, s[36:39], s54 offen sc1 lds
  s_waitcnt vmcnt(0)
L_gv_23:
  ds_read_b32 v56, v21 offset:16384
  ds_read_b32 v57, v21 offset:17408
  ds_read_b32 v58, v21 offset:18432
  ds_read_b32 v59, v21 offset:19456
  s_waitcnt lgkmcnt(0)
  v_max3_u32 v56, v56, v57, v58
  v_max_u32 v56, v56, v59
  v_cmp_eq_u32 vcc, -1, v56
  s_cbranch_vccz L_gvk_24
  s_sub_u32 s52, s52, 1
  s_cbranch_scc1 L_gvx_25
  s_sleep 8
  s_add_u32 s54, s4, 540672
  s_add_u32 m0, s5, 16384
  s_nop 0
  buffer_load_dwordx4 v19, s[36:39], s54 offen sc1 lds
  s_add_u32 s54, s4, 574464
  s_add_u32 m0, s5, 17408
  s_nop 0
  buffer_load_dwordx4 v19, s[36:39], s54 offen sc1 lds
  s_add_u32 s54, s4, 608256
  s_add_u32 m0, s5, 18432
  s_nop 0
  buffer_load_dwordx4 v19, s[36:39], s54 offen sc1 lds
  s_add_u32 s54, s4, 642048
  s_add_u32 m0, s5, 19456
  s_nop 0
  buffer_load_dwordx4 v19, s[36:39], s54 offen sc1 lds
  s_waitcnt vmcnt(0)
  s_branch L_gv_23
L_gvx_25:
  s_mov_b32 s52, 0
L_gvk_24:
L_gok_22:
  s_barrier
  s_waitcnt lgkmcnt(0)
  v_mfma_f32_16x16x32_bf16 v[96:99], v[80:83], a[12:15], v[96:99]
  ds_read_b64_tr_b16 v[64:65], v12 offset:16384
  v_mfma_f32_16x16x32_bf16 v[144:147], v[80:83], v[80:83], v[144:147]
  ds_read_b64_tr_b16 v[66:67], v12 offset:18432
  v_mfma_f32_16x16x32_bf16 v[112:115], v[80:83], a[76:79], v[112:115]
  ds_read_b64_tr_b16 v[68:69], v13 offset:16384
  v_mfma_f32_16x16x32_bf16 v[148:151], v[152:155], v[80:83], v[148:151]
  ds_read_b64_tr_b16 v[70:71], v13 offset:18432
  v_mfma_f32_16x16x32_bf16 v[100:103], v[84:87], a[12:15], v[100:103]
  ds_read_b64_tr_b16 v[72:73], v14 offset:16384
  v_mfma_f32_16x16x32_bf16 v[116:119], v[84:87], a[76:79], v[116:119]
  ds_read_b64_tr_b16 v[74:75], v14 offset:18432
  v_mfma_f32_16x16x32_bf16 v[104:107], v[88:91], a[12:15], v[104:107]
  ds_read_b64_tr_b16 v[76:77], v15 offset:16384
  v_mfma_f32_16x16x32_bf16 v[120:123], v[88:91], a[76:79], v[120:123]
  ds_read_b64_tr_b16 v[78:79], v15 offset:18432
  v_mfma_f32_16x16x32_bf16 v[108:111], v[92:95], a[12:15], v[108:111]
  v_mfma_f32_16x16x32_bf16 v[124:127], v[92:95], a[76:79], v[124:127]
  s_waitcnt lgkmcnt(0)
  v_mfma_f32_16x16x32_bf16 v[96:99], v[64:67], a[16:19], v[96:99]
  ds_read_b64_tr_b16 v[80:81], v12 offset:20480
  v_mfma_f32_16x16x32_bf16 v[144:147], v[64:67], v[64:67], v[144:147]
  ds_read_b64_tr_b16 v[82:83], v12 offset:22528
  v_mfma_f32_16x16x32_bf16 v[112:115], v[64:67], a[80:83], v[112:115]
  ds_read_b64_tr_b16 v[84:85], v13 offset:20480
  v_mfma_f32_16x16x32_bf16 v[148:151], v[152:155], v[64:67], v[148:151]
  ds_read_b64_tr_b16 v[86:87], v13 offset:22528
  v_mfma_f32_16x16x32_bf16 v[100:103], v[68:71], a[16:19], v[100:103]
  ds_read_b64_tr_b16 v[88:89], v14 offset:20480
  buffer_load_dwordx4 a[192:195], v18, s[36:39], s34 offen offset:0 sc1
  v_mfma_f32_16x16x32_bf16 v[116:119], v[68:71], a[80:83], v[116:119]
  ds_read_b64_tr_b16 v[90:91], v14 offset:22528
  v_mfma_f32_16x16x32_bf16 v[104:107], v[72:75], a[16:19], v[104:107]
  ds_read_b64_tr_b16 v[92:93], v15 offset:20480
  v_mfma_f32_16x16x32_bf16 v[120:123], v[72:75], a[80:83], v[120:123]
  ds_read_b64_tr_b16 v[94:95], v15 offset:22528
  v_mfma_f32_16x16x32_bf16 v[108:111], v[76:79], a[16:19], v[108:111]
  v_mfma_f32_16x16x32_bf16 v[124:127], v[76:79], a[80:83], v[124:127]
  buffer_store_dwordx4 v[176:179], v18, s[36:39], s62 offen sc1
  s_waitcnt lgkmcnt(0)
  s_waitcnt vmcnt(6)
  v_mfma_f32_16x16x32_bf16 v[96:99], v[80:83], a[20:23], v[96:99]
  ds_read_b64_tr_b16 v[64:65], v12 offset:24576
  v_mfma_f32_16x16x32_bf16 v[144:147], v[80:83], v[80:83], v[144:147]
  ds_read_b64_tr_b16 v[66:67], v12 offset:26624
  v_mfma_f32_16x16x32_bf16 v[112:115], v[80:83], a[84:87], v[112:115]
  ds_read_b64_tr_b16 v[68:69], v13 offset:24576
  v_mfma_f32_16x16x32_bf16 v[148:151], v[152:155], v[80:83], v[148:151]
  ds_read_b64_tr_b16 v[70:71], v13 offset:26624
  v_mfma_f32_16x16x32_bf16 v[100:103], v[84:87], a[20:23], v[100:103]
  ds_read_b64_tr_b16 v[72:73], v14 offset:24576
  buffer_load_dwordx4 a[196:199], v18, s[36:39], s34 offen offset:1024 sc1
  v_mfma_f32_16x16x32_bf16 v[116:119], v[84:87], a[84:87], v[116:119]
  ds_read_b64_tr_b16 v[74:75], v14 offset:26624
  v_mfma_f32_16x16x32_bf16 v[104:107], v[88:91], a[20:23], v[104:107]
  ds_read_b64_tr_b16 v[76:77], v15 offset:24576
  v_mfma_f32_16x16x32_bf16 v[120:123], v[88:91], a[84:87], v[120:123]
  ds_read_b64_tr_b16 v[78:79], v15 offset:26624
  v_mfma_f32_16x16x32_bf16 v[108:111], v[92:95], a[20:23], v[108:111]
  ds_read_b32 v56, v21 offset:32768
  v_mfma_f32_16x16x32_bf16 v[124:127], v[92:95], a[84:87], v[124:127]
  ds_read_b32 v57, v21 offset:33792
  ds_read_b32 v58, v21 offset:34816
  ds_read_b32 v59, v21 offset:35840
  buffer_store_dwordx4 v[176:179], v18, s[36:39], s62 offen offset:1024 sc1
  s_waitcnt lgkmcnt(0)
  v_mfma_f32_16x16x32_bf16 v[96:99], v[64:67], a[24:27], v[96:99]
  ds_read_b64_tr_b16 v[80:81], v12 offset:28672
  v_mfma_f32_16x16x32_bf16 v[144:147], v[64:67], v[64:67], v[144:147]
  ds_read_b64_tr_b16 v[82:83], v12 offset:30720
  v_mfma_f32_16x16x32_bf16 v[112:115], v[64:67], a[88:91], v[112:115]
  ds_read_b64_tr_b16 v[84:85], v13 offset:28672
  v_max3_u32 v56, v56, v57, v58
  v_mfma_f32_16x16x32_bf16 v[148:151], v[152:155], v[64:67], v[148:151]
  ds_read_b64_tr_b16 v[86:87], v13 offset:30720
  v_mfma_f32_16x16x32_bf16 v[100:103], v[68:71], a[24:27], v[100:103]
  ds_read_b64_tr_b16 v[88:89], v14 offset:28672
  v_max_u32 v56, v56, v59
  buffer_load_dwordx4 a[200:203], v18, s[36:39], s34 offen offset:2048 sc1
  v_mfma_f32_16x16x32_bf16 v[116:119], v[68:71], a[88:91], v[116:119]
  ds_read_b64_tr_b16 v[90:91], v14 offset:30720
  v_mfma_f32_16x16x32_bf16 v[104:107], v[72:75], a[24:27], v[104:107]
  ds_read_b64_tr_b16 v[92:93], v15 offset:28672
  v_cmp_eq_u32 vcc, -1, v56
  v_mfma_f32_16x16x32_bf16 v[120:123], v[72:75], a[88:91], v[120:123]
  ds_read_b64_tr_b16 v[94:95], v15 offset:30720
  v_mfma_f32_16x16x32_bf16 v[108:111], v[76:79], a[24:27], v[108:111]
  v_mfma_f32_16x16x32_bf16 v[124:127], v[76:79], a[88:91], v[124:127]
  s_cbranch_vccz L_gok_26
  s_add_u32 s54, s4, 1081344
  s_add_u32 m0, s5, 32768
  s_nop 0
  buffer_load_dwordx4 v19, s[36:39], s54 offen sc1 lds
  s_add_u32 s54, s4, 1115136
  s_add_u32 m0, s5, 33792
  s_nop 0
  buffer_load_dwordx4 v19, s[36:39], s54 offen sc1 lds
  s_add_u32 s54, s4, 1148928
  s_add_u32 m0, s5, 34816
  s_nop 0
  buffer_load_dwordx4 v19, s[36:39], s54 offen sc1 lds
  s_add_u32 s54, s4, 1182720
  s_add_u32 m0, s5, 35840
  s_nop 0
  buffer_load_dwordx4 v19, s[36:39], s54 offen sc1 lds
  s_waitcnt vmcnt(0)
L_gv_27:
  ds_read_b32 v56, v21 offset:32768
  ds_read_b32 v57, v21 offset:33792
  ds_read_b32 v58, v21 offset:34816
  ds_read_b32 v59, v21 offset:35840
  s_waitcnt lgkmcnt(0)
  v_max3_u32 v56, v56, v57, v58
  v_max_u32 v56, v56, v59
  v_cmp_eq_u32 vcc, -1, v56
  s_cbranch_vccz L_gvk_28
  s_sub_u32 s52, s52, 1
  s_cbranch_scc1 L_gvx_29
  s_sleep 8
  s_add_u32 s54, s4, 1081344
  s_add_u32 m0, s5, 32768
  s_nop 0
  buffer_load_dwordx4 v19, s[36:39], s54 offen sc1 lds
  s_add_u32 s54, s4, 1115136
  s_add_u32 m0, s5, 33792
  s_nop 0
  buffer_load_dwordx4 v19, s[36:39], s54 offen sc1 lds
  s_add_u32 s54, s4, 1148928
  s_add_u32 m0, s5, 34816
  s_nop 0
  buffer_load_dwordx4 v19, s[36:39], s54 offen sc1 lds
  s_add_u32 s54, s4, 1182720
  s_add_u32 m0, s5, 35840
  s_nop 0
  buffer_load_dwordx4 v19, s[36:39], s54 offen sc1 lds
  s_waitcnt vmcnt(0)
  s_branch L_gv_27
L_gvx_29:
  s_mov_b32 s52, 0
L_gvk_28:
L_gok_26:
  buffer_store_dwordx4 v[176:179], v18, s[36:39], s63 offen sc1
  s_barrier
  s_waitcnt lgkmcnt(0)
  v_mfma_f32_16x16x32_bf16 v[96:99], v[80:83], a[28:31], v[96:99]
  ds_read_b64_tr_b16 v[64:65], v12 offset:32768
  v_mfma_f32_16x16x32_bf16 v[144:147], v[80:83], v[80:83], v[144:147]
  ds_read_b64_tr_b16 v[66:67], v12 offset:34816
  v_mfma_f32_16x16x32_bf16 v[112:115], v[80:83], a[92:95], v[112:115]
  ds_read_b64_tr_b16 v[68:69], v13 offset:32768
  v_mfma_f32_16x16x32_bf16 v[148:151], v[152:155], v[80:83], v[148:151]
  ds_read_b64_tr_b16 v[70:71], v13 offset:34816
  v_mfma_f32_16x16x32_bf16 v[100:103], v[84:87], a[28:31], v[100:103]
  ds_read_b64_tr_b16 v[72:73], v14 offset:32768
  buffer_load_dwordx4 a[204:207], v18, s[36:39], s34 offen offset:3072 sc1
  s_add_u32 s34, s34, 4096
  v_mfma_f32_16x16x32_bf16 v[116:119], v[84:87], a[92:95], v[116:119]
  ds_read_b64_tr_b16 v[74:75], v14 offset:34816
  v_mfma_f32_16x16x32_bf16 v[104:107], v[88:91], a[28:31], v[104:107]
  ds_read_b64_tr_b16 v[76:77], v15 offset:32768
  v_mfma_f32_16x16x32_bf16 v[120:123], v[88:91], a[92:95], v[120:123]
  ds_read_b64_tr_b16 v[78:79], v15 offset:34816
  v_mfma_f32_16x16x32_bf16 v[108:111], v[92:95], a[28:31], v[108:111]
  v_mfma_f32_16x16x32_bf16 v[124:127], v[92:95], a[92:95], v[124:127]
  buffer_store_dwordx4 v[176:179], v18, s[36:39], s63 offen offset:1024 sc1
  s_waitcnt lgkmcnt(0)
  v_mfma_f32_16x16x32_bf16 v[96:99], v[64:67], a[32:35], v[96:99]
  ds_read_b64_tr_b16 v[80:81], v12 offset:36864
  v_mfma_f32_16x16x32_bf16 v[144:147], v[64:67], v[64:67], v[144:147]
  ds_read_b64_tr_b16 v[82:83], v12 offset:38912
  v_mfma_f32_16x16x32_bf16 v[112:115], v[64:67], a[96:99], v[112:115]
  ds_read_b64_tr_b16 v[84:85], v13 offset:36864
  v_mfma_f32_16x16x32_bf16 v[148:151], v[152:155], v[64:67], v[148:151]
  ds_read_b64_tr_b16 v[86:87], v13 offset:38912
  v_mfma_f32_16x16x32_bf16 v[100:103], v[68:71], a[32:35], v[100:103]
  ds_read_b64_tr_b16 v[88:89], v14 offset:36864
  buffer_load_dwordx4 a[208:211], v18, s[36:39], s34 offen offset:0 sc1
  v_mfma_f32_16x16x32_bf16 v[116:119], v[68:71], a[96:99], v[116:119]
  ds_read_b64_tr_b16 v[90:91], v14 offset:38912
  v_mfma_f32_16x16x32_bf16 v[104:107], v[72:75], a[32:35], v[104:107]
  ds_read_b64_tr_b16 v[92:93], v15 offset:36864
  v_mfma_f32_16x16x32_bf16 v[120:123], v[72:75], a[96:99], v[120:123]
  ds_read_b64_tr_b16 v[94:95], v15 offset:38912
  v_mfma_f32_16x16x32_bf16 v[108:111], v[76:79], a[32:35], v[108:111]
  v_mfma_f32_16x16x32_bf16 v[124:127], v[76:79], a[96:99], v[124:127]
  buffer_store_dword v176, v183, s[36:39], s60 offen sc1
  s_waitcnt lgkmcnt(0)
  s_waitcnt vmcnt(10)
  v_mfma_f32_16x16x32_bf16 v[96:99], v[80:83], a[36:39], v[96:99]
  ds_read_b64_tr_b16 v[64:65], v12 offset:40960
  v_mfma_f32_16x16x32_bf16 v[144:147], v[80:83], v[80:83], v[144:147]
  ds_read_b64_tr_b16 v[66:67], v12 offset:43008
  v_mfma_f32_16x16x32_bf16 v[112:115], v[80:83], a[100:103], v[112:115]
  ds_read_b64_tr_b16 v[68:69], v13 offset:40960
  v_mfma_f32_16x16x32_bf16 v[148:151], v[152:155], v[80:83], v[148:151]
  ds_read_b64_tr_b16 v[70:71], v13 offset:43008
  v_mfma_f32_16x16x32_bf16 v[100:103], v[84:87], a[36:39], v[100:103]
  ds_read_b64_tr_b16 v[72:73], v14 offset:40960
  buffer_load_dwordx4 a[212:215], v18, s[36:39], s34 offen offset:1024 sc1
  v_mfma_f32_16x16x32_bf16 v[116:119], v[84:87], a[100:103], v[116:119]
  ds_read_b64_tr_b16 v[74:75], v14 offset:43008
  v_mfma_f32_16x16x32_bf16 v[104:107], v[88:91], a[36:39], v[104:107]
  ds_read_b64_tr_b16 v[76:77], v15 offset:40960
  v_mfma_f32_16x16x32_bf16 v[120:123], v[88:91], a[100:103], v[120:123]
  ds_read_b64_tr_b16 v[78:79], v15 offset:43008
  v_mfma_f32_16x16x32_bf16 v[108:111], v[92:95], a[36:39], v[108:111]
  ds_read_b32 v56, v21 offset:49152
  v_mfma_f32_16x16x32_bf16 v[124:127], v[92:95], a[100:103], v[124:127]
  ds_read_b32 v57, v21 offset:50176
  ds_read_b32 v58, v21 offset:51200
  ds_read_b32 v59, v21 offset:52224
  buffer_load_dwordx4 a[216:219], v18, s[36:39], s34 offen offset:2048 sc1
  s_waitcnt lgkmcnt(0)
  v_mfma_f32_16x16x32_bf16 v[96:99], v[64:67], a[40:43], v[96:99]
  ds_read_b64_tr_b16 v[80:81], v12 offset:45056
  v_mfma_f32_16x16x32_bf16 v[144:147], v[64:67], v[64:67], v[144:147]
  ds_read_b64_tr_b16 v[82:83], v12 offset:47104
  v_mfma_f32_16x16x32_bf16 v[112:115], v[64:67], a[104:107], v[112:115]
  ds_read_b64_tr_b16 v[84:85], v13 offset:45056
  v_max3_u32 v56, v56, v57, v58
  v_mfma_f32_16x16x32_bf16 v[148:151], v[152:155], v[64:67], v[148:151]
  ds_read_b64_tr_b16 v[86:87], v13 offset:47104
  v_mfma_f32_16x16x32_bf16 v[100:103], v[68:71], a[40:43], v[100:103]
  ds_read_b64_tr_b16 v[88:89], v14 offset:45056
  v_max_u32 v56, v56, v59
  buffer_load_dwordx4 a[220:223], v18, s[36:39], s34 offen offset:3072 sc1
  s_add_u32 s34, s34, 4096
  v_mfma_f32_16x16x32_bf16 v[116:119], v[68:71], a[104:107], v[116:119]
  ds_read_b64_tr_b16 v[90:91], v14 offset:47104
  v_mfma_f32_16x16x32_bf16 v[104:107], v[72:75], a[40:43], v[104:107]
  ds_read_b64_tr_b16 v[92:93], v15 offset:45056
  v_cmp_eq_u32 vcc, -1, v56
  v_mfma_f32_16x16x32_bf16 v[120:123], v[72:75], a[104:107], v[120:123]
  ds_read_b64_tr_b16 v[94:95], v15 offset:47104
  v_mfma_f32_16x16x32_bf16 v[108:111], v[76:79], a[40:43], v[108:111]
  v_mfma_f32_16x16x32_bf16 v[124:127], v[76:79], a[104:107], v[124:127]
  s_cbranch_vccz L_gok_30
  s_add_u32 s54, s4, 1622016
  s_add_u32 m0, s5, 49152
  s_nop 0
  buffer_load_dwordx4 v19, s[36:39], s54 offen sc1 lds
  s_add_u32 s54, s4, 1655808
  s_add_u32 m0, s5, 50176
  s_nop 0
  buffer_load_dwordx4 v19, s[36:39], s54 offen sc1 lds
  s_add_u32 s54, s4, 1689600
  s_add_u32 m0, s5, 51200
  s_nop 0
  buffer_load_dwordx4 v19, s[36:39], s54 offen sc1 lds
  s_add_u32 s54, s4, 1723392
  s_add_u32 m0, s5, 52224
  s_nop 0
  buffer_load_dwordx4 v19, s[36:39], s54 offen sc1 lds
  s_waitcnt vmcnt(0)
L_gv_31:
  ds_read_b32 v56, v21 offset:49152
  ds_read_b32 v57, v21 offset:50176
  ds_read_b32 v58, v21 offset:51200
  ds_read_b32 v59, v21 offset:52224
  s_waitcnt lgkmcnt(0)
  v_max3_u32 v56, v56, v57, v58
  v_max_u32 v56, v56, v59
  v_cmp_eq_u32 vcc, -1, v56
  s_cbranch_vccz L_gvk_32
  s_sub_u32 s52, s52, 1
  s_cbranch_scc1 L_gvx_33
  s_sleep 8
  s_add_u32 s54, s4, 1622016
  s_add_u32 m0, s5, 49152
  s_nop 0
  buffer_load_dwordx4 v19, s[36:39], s54 offen sc1 lds
  s_add_u32 s54, s4, 1655808
  s_add_u32 m0, s5, 50176
  s_nop 0
  buffer_load_dwordx4 v19, s[36:39], s54 offen sc1 lds
  s_add_u32 s54, s4, 1689600
  s_add_u32 m0, s5, 51200
  s_nop 0
  buffer_load_dwordx4 v19, s[36:39], s54 offen sc1 lds
  s_add_u32 s54, s4, 1723392
  s_add_u32 m0, s5, 52224
  s_nop 0
  buffer_load_dwordx4 v19, s[36:39], s54 offen sc1 lds
  s_waitcnt vmcnt(0)
  s_branch L_gv_31
L_gvx_33:
  s_mov_b32 s52, 0
L_gvk_32:
L_gok_30:
  buffer_load_dwordx4 a[224:227], v18, s[36:39], s34 offen offset:0 sc1
  s_barrier
  s_waitcnt lgkmcnt(0)
  v_mfma_f32_16x16x32_bf16 v[96:99], v[80:83], a[44:47], v[96:99]
  ds_read_b64_tr_b16 v[64:65], v12 offset:49152
  v_mfma_f32_16x16x32_bf16 v[144:147], v[80:83], v[80:83], v[144:147]
  ds_read_b64_tr_b16 v[66:67], v12 offset:51200
  v_mfma_f32_16x16x32_bf16 v[112:115], v[80:83], a[108:111], v[112:115]
  ds_read_b64_tr_b16 v[68:69], v13 offset:49152
  v_mfma_f32_16x16x32_bf16 v[148:151], v[152:155], v[80:83], v[148:151]
  ds_read_b64_tr_b16 v[70:71], v13 offset:51200
  v_mfma_f32_16x16x32_bf16 v[100:103], v[84:87], a[44:47], v[100:103]
  ds_read_b64_tr_b16 v[72:73], v14 offset:49152
  buffer_load_dwordx4 a[228:231], v18, s[36:39], s34 offen offset:1024 sc1
  v_mfma_f32_16x16x32_bf16 v[116:119], v[84:87], a[108:111], v[116:119]
  ds_read_b64_tr_b16 v[74:75], v14 offset:51200
  v_mfma_f32_16x16x32_bf16 v[104:107], v[88:91], a[44:47], v[104:107]
  ds_read_b64_tr_b16 v[76:77], v15 offset:49152
  v_mfma_f32_16x16x32_bf16 v[120:123], v[88:91], a[108:111], v[120:123]
  ds_read_b64_tr_b16 v[78:79], v15 offset:51200
  v_mfma_f32_16x16x32_bf16 v[108:111], v[92:95], a[44:47], v[108:111]
  v_mfma_f32_16x16x32_bf16 v[124:127], v[92:95], a[108:111], v[124:127]
  buffer_load_dwordx4 a[232:235], v18, s[36:39], s34 offen offset:2048 sc1
  s_waitcnt lgkmcnt(0)
  v_mfma_f32_16x16x32_bf16 v[96:99], v[64:67], a[48:51], v[96:99]
  ds_read_b64_tr_b16 v[80:81], v12 offset:53248
  v_mfma_f32_16x16x32_bf16 v[144:147], v[64:67], v[64:67], v[144:147]
  ds_read_b64_tr_b16 v[82:83], v12 offset:55296
  v_mfma_f32_16x16x32_bf16 v[112:115], v[64:67], a[112:115], v[112:115]
  ds_read_b64_tr_b16 v[84:85], v13 offset:53248
  v_mfma_f32_16x16x32_bf16 v[148:151], v[152:155], v[64:67], v[148:151]
  ds_read_b64_tr_b16 v[86:87], v13 offset:55296
  v_mfma_f32_16x16x32_bf16 v[100:103], v[68:71], a[48:51], v[100:103]
  ds_read_b64_tr_b16 v[88:89], v14 offset:53248
  buffer_load_dwordx4 a[236:239], v18, s[36:39], s34 offen offset:3072 sc1
  s_add_u32 s34, s34, 4096
  v_mfma_f32_16x16x32_bf16 v[116:119], v[68:71], a[112:115], v[116:119]
  ds_read_b64_tr_b16 v[90:91], v14 offset:55296
  v_mfma_f32_16x16x32_bf16 v[104:107], v[72:75], a[48:51], v[104:107]
  ds_read_b64_tr_b16 v[92:93], v15 offset:53248
  v_mfma_f32_16x16x32_bf16 v[120:123], v[72:75], a[112:115], v[120:123]
  ds_read_b64_tr_b16 v[94:95], v15 offset:55296
  v_mfma_f32_16x16x32_bf16 v[108:111], v[76:79], a[48:51], v[108:111]
  v_mfma_f32_16x16x32_bf16 v[124:127], v[76:79], a[112:115], v[124:127]
  buffer_load_dwordx4 a[240:243], v18, s[36:39], s34 offen offset:0 sc1
  s_waitcnt lgkmcnt(0)
  v_mfma_f32_16x16x32_bf16 v[96:99], v[80:83], a[52:55], v[96:99]
  ds_read_b64_tr_b16 v[64:65], v12 offset:57344
  v_mfma_f32_16x16x32_bf16 v[144:147], v[80:83], v[80:83], v[144:147]
  ds_read_b64_tr_b16 v[66:67], v12 offset:59392
  v_mfma_f32_16x16x32_bf16 v[112:115], v[80:83], a[116:119], v[112:115]
  ds_read_b64_tr_b16 v[68:69], v13 offset:57344
  v_mfma_f32_16x16x32_bf16 v[148:151], v[152:155], v[80:83], v[148:151]
  ds_read_b64_tr_b16 v[70:71], v13 offset:59392
  v_mfma_f32_16x16x32_bf16 v[100:103], v[84:87], a[52:55], v[100:103]
  ds_read_b64_tr_b16 v[72:73], v14 offset:57344
  buffer_load_dwordx4 a[244:247], v18, s[36:39], s34 offen offset:1024 sc1
  v_mfma_f32_16x16x32_bf16 v[116:119], v[84:87], a[116:119], v[116:119]
  ds_read_b64_tr_b16 v[74:75], v14 offset:59392
  v_mfma_f32_16x16x32_bf16 v[104:107], v[88:91], a[52:55], v[104:107]
  ds_read_b64_tr_b16 v[76:77], v15 offset:57344
  v_mfma_f32_16x16x32_bf16 v[120:123], v[88:91], a[116:119], v[120:123]
  ds_read_b64_tr_b16 v[78:79], v15 offset:59392
  v_mfma_f32_16x16x32_bf16 v[108:111], v[92:95], a[52:55], v[108:111]
  v_mfma_f32_16x16x32_bf16 v[124:127], v[92:95], a[116:119], v[124:127]
  buffer_load_dwordx4 a[248:251], v18, s[36:39], s34 offen offset:2048 sc1
  s_waitcnt lgkmcnt(0)
  v_mfma_f32_16x16x32_bf16 v[96:99], v[64:67], a[56:59], v[96:99]
  ds_read_b64_tr_b16 v[80:81], v12 offset:61440
  v_mfma_f32_16x16x32_bf16 v[144:147], v[64:67], v[64:67], v[144:147]
  ds_read_b64_tr_b16 v[82:83], v12 offset:63488
  v_mfma_f32_16x16x32_bf16 v[112:115], v[64:67], a[120:123], v[112:115]
  ds_read_b64_tr_b16 v[84:85], v13 offset:61440
  v_mfma_f32_16x16x32_bf16 v[148:151], v[152:155], v[64:67], v[148:151]
  ds_read_b64_tr_b16 v[86:87], v13 offset:63488
  v_mfma_f32_16x16x32_bf16 v[100:103], v[68:71], a[56:59], v[100:103]
  ds_read_b64_tr_b16 v[88:89], v14 offset:61440
  buffer_load_dwordx4 a[252:255], v18, s[36:39], s34 offen offset:3072 sc1
  s_add_u32 s34, s34, 4096
  v_mfma_f32_16x16x32_bf16 v[116:119], v[68:71], a[120:123], v[116:119]
  ds_read_b64_tr_b16 v[90:91], v14 offset:63488
  v_mfma_f32_16x16x32_bf16 v[104:107], v[72:75], a[56:59], v[104:107]
  ds_read_b64_tr_b16 v[92:93], v15 offset:61440
  v_mfma_f32_16x16x32_bf16 v[120:123], v[72:75], a[120:123], v[120:123]
  ds_read_b64_tr_b16 v[94:95], v15 offset:63488
  v_mfma_f32_16x16x32_bf16 v[108:111], v[76:79], a[56:59], v[108:111]
  v_mfma_f32_16x16x32_bf16 v[124:127], v[76:79], a[120:123], v[124:127]
  buffer_load_dwordx4 v[192:195], v18, s[36:39], s34 offen offset:0 sc1
  s_waitcnt lgkmcnt(0)
  v_mfma_f32_16x16x32_bf16 v[144:147], v[80:83], v[80:83], v[144:147]
  v_and_b32 v10, 3, v1
  v_cmp_eq_u32 s[72:73], 1, v10
  v_mfma_f32_16x16x32_bf16 v[148:151], v[152:155], v[80:83], v[148:151]
  v_cmp_eq_u32 s[74:75], 2, v10
  v_cmp_eq_u32 vcc, 3, v10
  v_mfma_f32_16x16x32_bf16 v[96:99], v[80:83], a[60:63], v[96:99]
  v_mfma_f32_16x16x32_bf16 v[112:115], v[80:83], a[124:127], v[112:115]
  v_mfma_f32_16x16x32_bf16 v[100:103], v[84:87], a[60:63], v[100:103]
  v_cndmask_b32 v11, v144, v145, s[72:73]
  v_cndmask_b32 v11, v11, v146, s[74:75]
  v_cndmask_b32 v11, v11, v147, vcc
  v_mul_f32 v20, s80, v148
  buffer_load_dwordx4 v[196:199], v18, s[36:39], s34 offen offset:1024 sc1
  v_mfma_f32_16x16x32_bf16 v[116:119], v[84:87], a[124:127], v[116:119]
  v_mul_f32 v21, s80, v11
  v_fma_f32 v21, -v20, v20, v21
  v_max_f32 v21, 0, v21
  v_cvt_pk_bf16_f32 v20, v20, v21
  v_mfma_f32_16x16x32_bf16 v[104:107], v[88:91], a[60:63], v[104:107]
  v_and_b32 v21, s76, v20
  v_lshlrev_b32 v16, 16, v20
  v_add_f32 v21, 0x3727c5ac, v21
  v_cvt_pk_bf16_f32 v21, v21, v21
  v_mfma_f32_16x16x32_bf16 v[120:123], v[88:91], a[124:127], v[120:123]
  v_lshlrev_b32 v21, 16, v21
  v_sqrt_f32 v21, v21
  s_nop 0
  v_cvt_pk_bf16_f32 v21, v21, v21
  v_lshlrev_b32 v21, 16, v21
  v_mfma_f32_16x16x32_bf16 v[108:111], v[92:95], a[60:63], v[108:111]
  v_rcp_f32 v17, v21
  s_nop 0
  v_mul_f32 v16, v16, v17
  v_mfma_f32_16x16x32_bf16 v[124:127], v[92:95], a[124:127], v[124:127]
  buffer_load_dwordx4 v[200:203], v18, s[36:39], s34 offen offset:2048 sc1
  s_mov_b32 s56, 0x00f0000f
  s_mov_b32 s57, 0xf0000f00
  s_mov_b64 exec, s[56:57]
  ds_write_b32 v158, v17
  ds_write_b32 v158, v16 offset:256
  s_mov_b64 exec, -1
  ds_read_b64_tr_b16 v[184:185], v156 offset:0
  ds_read_b64_tr_b16 v[186:187], v157 offset:512
  ds_read_b64_tr_b16 v[188:189], v156 offset:1024
  ds_read_b64_tr_b16 v[190:191], v157 offset:1536
  s_waitcnt lgkmcnt(0)
  s_barrier
  ds_read_b128 v[24:27], v160
  ds_read_b128 v[40:43], v160 offset:256
  ds_read_b128 v[28:31], v161
  ds_read_b128 v[44:47], v161 offset:256
  ds_read_b128 v[32:35], v162
  ds_read_b128 v[48:51], v162 offset:256
  ds_read_b128 v[36:39], v163
  ds_read_b128 v[52:55], v163 offset:256
  ds_read_b32 v56, v164
  ds_read_b32 v176, v164 offset:256
  ds_read_b32 v58, v165
  ds_read_b32 v178, v165 offset:256
  ds_read_b32 v60, v166
  ds_read_b32 v180, v166 offset:256
  ds_read_b32 v62, v167
  ds_read_b32 v182, v167 offset:256
  s_waitcnt lgkmcnt(14)
  v_pk_mul_f32 v[172:173], v[40:41], v[4:5]
  v_pk_mul_f32 v[174:175], v[42:43], v[4:5]
  v_pk_fma_f32 v[172:173], v[24:25], v[112:113], v[172:173]
  v_pk_fma_f32 v[174:175], v[26:27], v[114:115], v[174:175]
  v_pk_fma_f32 v[88:89], v[40:41], v[2:3], s[66:67]
  v_pk_fma_f32 v[92:93], v[42:43], v[2:3], s[66:67]
  v_pk_fma_f32 v[88:89], v[24:25], v[96:97], v[88:89]
  v_pk_fma_f32 v[92:93], v[26:27], v[98:99], v[92:93]
  v_pk_mul_f32 v[90:91], v[88:89], s[64:65]
  v_pk_mul_f32 v[94:95], v[92:93], s[64:65]
  v_exp_f32 v90, v90 clamp
  v_exp_f32 v91, v91 clamp
  v_exp_f32 v94, v94 clamp
  v_exp_f32 v95, v95 clamp
  v_max_f32 v88, s66, v88
  v_max_f32 v89, s66, v89
  v_max_f32 v92, s66, v92
  v_max_f32 v93, s66, v93
  v_pk_add_f32 v[88:89], v[88:89], v[90:91]
  v_pk_add_f32 v[92:93], v[92:93], v[94:95]
  v_cvt_pk_bf16_f32 v72, v88, v89
  v_cvt_pk_bf16_f32 v73, v92, v93
  v_cvt_pk_bf16_f32 v80, v172, v173
  v_cvt_pk_bf16_f32 v81, v174, v175
  s_waitcnt lgkmcnt(12)
  v_pk_mul_f32 v[172:173], v[44:45], v[4:5]
  v_pk_mul_f32 v[174:175], v[46:47], v[4:5]
  v_pk_fma_f32 v[172:173], v[28:29], v[116:117], v[172:173]
  v_pk_fma_f32 v[174:175], v[30:31], v[118:119], v[174:175]
  v_pk_fma_f32 v[88:89], v[44:45], v[2:3], s[66:67]
  v_pk_fma_f32 v[92:93], v[46:47], v[2:3], s[66:67]
  v_pk_fma_f32 v[88:89], v[28:29], v[100:101], v[88:89]
  v_pk_fma_f32 v[92:93], v[30:31], v[102:103], v[92:93]
  v_pk_mul_f32 v[90:91], v[88:89], s[64:65]
  v_pk_mul_f32 v[94:95], v[92:93], s[64:65]
  v_exp_f32 v90, v90 clamp
  v_exp_f32 v91, v91 clamp
  v_exp_f32 v94, v94 clamp
  v_exp_f32 v95, v95 clamp
  v_max_f32 v88, s66, v88
  v_max_f32 v89, s66, v89
  v_max_f32 v92, s66, v92
  v_max_f32 v93, s66, v93
  v_pk_add_f32 v[88:89], v[88:89], v[90:91]
  v_pk_add_f32 v[92:93], v[92:93], v[94:95]
  v_cvt_pk_bf16_f32 v74, v88, v89
  v_cvt_pk_bf16_f32 v75, v92, v93
  v_cvt_pk_bf16_f32 v82, v172, v173
  v_cvt_pk_bf16_f32 v83, v174, v175
  s_nop 1
  v_mfma_f32_16x16x32_bf16 v[144:147], v[80:83], v[72:75], 0
  v_mfma_f32_16x16x32_bf16 v[148:151], v[152:155], v[72:75], 0
  s_waitcnt lgkmcnt(10)
  v_pk_mul_f32 v[172:173], v[48:49], v[4:5]
  v_pk_mul_f32 v[174:175], v[50:51], v[4:5]
  v_pk_fma_f32 v[172:173], v[32:33], v[120:121], v[172:173]
  v_pk_fma_f32 v[174:175], v[34:35], v[122:123], v[174:175]
  v_pk_fma_f32 v[88:89], v[48:49], v[2:3], s[66:67]
  v_pk_fma_f32 v[92:93], v[50:51], v[2:3], s[66:67]
  v_pk_fma_f32 v[88:89], v[32:33], v[104:105], v[88:89]
  v_pk_fma_f32 v[92:93], v[34:35], v[106:107], v[92:93]
  v_pk_mul_f32 v[90:91], v[88:89], s[64:65]
  v_pk_mul_f32 v[94:95], v[92:93], s[64:65]
  v_exp_f32 v90, v90 clamp
  v_exp_f32 v91, v91 clamp
  v_exp_f32 v94, v94 clamp
  v_exp_f32 v95, v95 clamp
  v_max_f32 v88, s66, v88
  v_max_f32 v89, s66, v89
  v_max_f32 v92, s66, v92
  v_max_f32 v93, s66, v93
  v_pk_add_f32 v[88:89], v[88:89], v[90:91]
  v_pk_add_f32 v[92:93], v[92:93], v[94:95]
  v_cvt_pk_bf16_f32 v76, v88, v89
  v_cvt_pk_bf16_f32 v77, v92, v93
  v_cvt_pk_bf16_f32 v84, v172, v173
  v_cvt_pk_bf16_f32 v85, v174, v175
  s_waitcnt lgkmcnt(8)
  v_pk_mul_f32 v[172:173], v[52:53], v[4:5]
  v_pk_mul_f32 v[174:175], v[54:55], v[4:5]
  v_pk_fma_f32 v[172:173], v[36:37], v[124:125], v[172:173]
  v_pk_fma_f32 v[174:175], v[38:39], v[126:127], v[174:175]
  v_pk_fma_f32 v[88:89], v[52:53], v[2:3], s[66:67]
  v_pk_fma_f32 v[92:93], v[54:55], v[2:3], s[66:67]
  v_pk_fma_f32 v[88:89], v[36:37], v[108:109], v[88:89]
  v_pk_fma_f32 v[92:93], v[38:39], v[110:111], v[92:93]
  v_pk_mul_f32 v[90:91], v[88:89], s[64:65]
  v_pk_mul_f32 v[94:95], v[92:93], s[64:65]
  v_exp_f32 v90, v90 clamp
  v_exp_f32 v91, v91 clamp
  v_exp_f32 v94, v94 clamp
  v_exp_f32 v95, v95 clamp
  v_max_f32 v88, s66, v88
  v_max_f32 v89, s66, v89
  v_max_f32 v92, s66, v92
  v_max_f32 v93, s66, v93
  v_pk_add_f32 v[88:89], v[88:89], v[90:91]
  v_pk_add_f32 v[92:93], v[92:93], v[94:95]
  v_cvt_pk_bf16_f32 v78, v88, v89
  v_cvt_pk_bf16_f32 v79, v92, v93
  v_cvt_pk_bf16_f32 v86, v172, v173
  v_cvt_pk_bf16_f32 v87, v174, v175
  s_nop 1
  v_mfma_f32_16x16x32_bf16 v[144:147], v[84:87], v[76:79], v[144:147]
  v_mfma_f32_16x16x32_bf16 v[148:151], v[152:155], v[76:79], v[148:151]
  s_waitcnt vmcnt(14) lgkmcnt(0)
  s_waitcnt lgkmcnt(0)
  s_nop 4
  buffer_store_dword v144, v169, s[36:39], s6 offen offset:0 sc1
  buffer_store_dword v145, v169, s[36:39], s6 offen offset:64 sc1
  buffer_store_dword v146, v169, s[36:39], s6 offen offset:128 sc1
  buffer_store_dword v147, v169, s[36:39], s6 offen offset:192 sc1
  s_mov_b64 exec, 0xffff
  buffer_store_dword v148, v183, s[36:39], s6 offen offset:1024 sc1
  s_mov_b64 exec, -1
  ds_read_b64_tr_b16 v[64:65], v12 offset:0
  ds_read_b64_tr_b16 v[66:67], v12 offset:2048
  ds_read_b64_tr_b16 v[68:69], v13 offset:0
  ds_read_b64_tr_b16 v[70:71], v13 offset:2048
  ds_read_b64_tr_b16 v[72:73], v14 offset:0
  ds_read_b64_tr_b16 v[74:75], v14 offset:2048
  ds_read_b64_tr_b16 v[76:77], v15 offset:0
  ds_read_b64_tr_b16 v[78:79], v15 offset:2048
  ds_read_b64_tr_b16 v[80:81], v12 offset:4096
  ds_read_b64_tr_b16 v[82:83], v12 offset:6144
  ds_read_b64_tr_b16 v[84:85], v13 offset:4096
  ds_read_b64_tr_b16 v[86:87], v13 offset:6144
  ds_read_b64_tr_b16 v[88:89], v14 offset:4096
  ds_read_b64_tr_b16 v[90:91], v14 offset:6144
  ds_read_b64_tr_b16 v[92:93], v15 offset:4096
  ds_read_b64_tr_b16 v[94:95], v15 offset:6144
  s_waitcnt lgkmcnt(8)
  v_mfma_f32_16x16x32_bf16 v[128:131], a[128:131], v[64:67], 0
  ds_read_b64_tr_b16 v[112:113], v12 offset:8192
  ds_read_b64_tr_b16 v[114:115], v12 offset:10240
  buffer_load_dwordx4 v[204:207], v18, s[36:39], s34 offen offset:3072 sc1
  s_add_u32 s34, s34, 4096
  v_mfma_f32_16x16x32_bf16 v[132:135], a[128:131], v[68:71], 0
  ds_read_b64_tr_b16 v[116:117], v13 offset:8192
  ds_read_b64_tr_b16 v[118:119], v13 offset:10240
  v_mfma_f32_16x16x32_bf16 v[136:139], a[128:131], v[72:75], 0
  ds_read_b64_tr_b16 v[120:121], v14 offset:8192
  ds_read_b64_tr_b16 v[122:123], v14 offset:10240
  buffer_load_dwordx4 v[208:211], v18, s[36:39], s34 offen offset:0 sc1
  v_mfma_f32_16x16x32_bf16 v[140:143], a[128:131], v[76:79], 0
  ds_read_b64_tr_b16 v[124:125], v15 offset:8192
  ds_read_b64_tr_b16 v[126:127], v15 offset:10240
  s_waitcnt lgkmcnt(8)
  v_mfma_f32_16x16x32_bf16 v[128:131], a[132:135], v[80:83], v[128:131]
  ds_read_b64_tr_b16 v[64:65], v12 offset:12288
  ds_read_b64_tr_b16 v[66:67], v12 offset:14336
  buffer_load_dwordx4 v[212:215], v18, s[36:39], s34 offen offset:1024 sc1
  v_mfma_f32_16x16x32_bf16 v[132:135], a[132:135], v[84:87], v[132:135]
  ds_read_b64_tr_b16 v[68:69], v13 offset:12288
  ds_read_b64_tr_b16 v[70:71], v13 offset:14336
  v_mfma_f32_16x16x32_bf16 v[136:139], a[132:135], v[88:91], v[136:139]
  ds_read_b64_tr_b16 v[72:73], v14 offset:12288
  ds_read_b64_tr_b16 v[74:75], v14 offset:14336
  buffer_load_dwordx4 v[216:219], v18, s[36:39], s34 offen offset:2048 sc1
  v_mfma_f32_16x16x32_bf16 v[140:143], a[132:135], v[92:95], v[140:143]
  ds_read_b64_tr_b16 v[76:77], v15 offset:12288
  ds_read_b64_tr_b16 v[78:79], v15 offset:14336
  s_waitcnt lgkmcnt(8)
  v_mfma_f32_16x16x32_bf16 v[128:131], a[136:139], v[112:115], v[128:131]
  ds_read_b64_tr_b16 v[80:81], v12 offset:16384
  ds_read_b64_tr_b16 v[82:83], v12 offset:18432
  buffer_load_dwordx4 v[220:223], v18, s[36:39], s34 offen offset:3072 sc1
  s_add_u32 s34, s34, 4096
  v_mfma_f32_16x16x32_bf16 v[132:135], a[136:139], v[116:119], v[132:135]
  ds_read_b64_tr_b16 v[84:85], v13 offset:16384
  ds_read_b64_tr_b16 v[86:87], v13 offset:18432
  v_mfma_f32_16x16x32_bf16 v[136:139], a[136:139], v[120:123], v[136:139]
  ds_read_b64_tr_b16 v[88:89], v14 offset:16384
  ds_read_b64_tr_b16 v[90:91], v14 offset:18432
  buffer_load_dwordx4 v[224:227], v18, s[36:39], s34 offen offset:0 sc1
  v_mfma_f32_16x16x32_bf16 v[140:143], a[136:139], v[124:127], v[140:143]
  ds_read_b64_tr_b16 v[92:93], v15 offset:16384
  ds_read_b64_tr_b16 v[94:95], v15 offset:18432
  s_waitcnt lgkmcnt(8)
  v_mfma_f32_16x16x32_bf16 v[128:131], a[140:143], v[64:67], v[128:131]
  ds_read_b64_tr_b16 v[112:113], v12 offset:20480
  ds_read_b64_tr_b16 v[114:115], v12 offset:22528
  buffer_load_dwordx4 v[228:231], v18, s[36:39], s34 offen offset:1024 sc1
  v_mfma_f32_16x16x32_bf16 v[132:135], a[140:143], v[68:71], v[132:135]
  ds_read_b64_tr_b16 v[116:117], v13 offset:20480
  ds_read_b64_tr_b16 v[118:119], v13 offset:22528
  v_mfma_f32_16x16x32_bf16 v[136:139], a[140:143], v[72:75], v[136:139]
  ds_read_b64_tr_b16 v[120:121], v14 offset:20480
  ds_read_b64_tr_b16 v[122:123], v14 offset:22528
  buffer_load_dwordx4 v[232:235], v18, s[36:39], s34 offen offset:2048 sc1
  v_mfma_f32_16x16x32_bf16 v[140:143], a[140:143], v[76:79], v[140:143]
  ds_read_b64_tr_b16 v[124:125], v15 offset:20480
  ds_read_b64_tr_b16 v[126:127], v15 offset:22528
  s_waitcnt lgkmcnt(8)
  v_mfma_f32_16x16x32_bf16 v[128:131], a[144:147], v[80:83], v[128:131]
  ds_read_b64_tr_b16 v[64:65], v12 offset:24576
  ds_read_b64_tr_b16 v[66:67], v12 offset:26624
  buffer_load_dwordx4 v[236:239], v18, s[36:39], s34 offen offset:3072 sc1
  s_add_u32 s34, s34, 4096
  v_mfma_f32_16x16x32_bf16 v[132:135], a[144:147], v[84:87], v[132:135]
  ds_read_b64_tr_b16 v[68:69], v13 offset:24576
  ds_read_b64_tr_b16 v[70:71], v13 offset:26624
  v_mfma_f32_16x16x32_bf16 v[136:139], a[144:147], v[88:91], v[136:139]
  ds_read_b64_tr_b16 v[72:73], v14 offset:24576
  ds_read_b64_tr_b16 v[74:75], v14 offset:26624
  buffer_load_dwordx4 v[240:243], v18, s[36:39], s34 offen offset:0 sc1
  v_mfma_f32_16x16x32_bf16 v[140:143], a[144:147], v[92:95], v[140:143]
  ds_read_b64_tr_b16 v[76:77], v15 offset:24576
  ds_read_b64_tr_b16 v[78:79], v15 offset:26624
  s_waitcnt lgkmcnt(8)
  v_mfma_f32_16x16x32_bf16 v[128:131], a[148:151], v[112:115], v[128:131]
  ds_read_b64_tr_b16 v[80:81], v12 offset:28672
  ds_read_b64_tr_b16 v[82:83], v12 offset:30720
  buffer_load_dwordx4 v[244:247], v18, s[36:39], s34 offen offset:1024 sc1
  v_mfma_f32_16x16x32_bf16 v[132:135], a[148:151], v[116:119], v[132:135]
  ds_read_b64_tr_b16 v[84:85], v13 offset:28672
  ds_read_b64_tr_b16 v[86:87], v13 offset:30720
  v_mfma_f32_16x16x32_bf16 v[136:139], a[148:151], v[120:123], v[136:139]
  ds_read_b64_tr_b16 v[88:89], v14 offset:28672
  ds_read_b64_tr_b16 v[90:91], v14 offset:30720
  buffer_load_dwordx4 v[248:251], v18, s[36:39], s34 offen offset:2048 sc1
  v_mfma_f32_16x16x32_bf16 v[140:143], a[148:151], v[124:127], v[140:143]
  ds_read_b64_tr_b16 v[92:93], v15 offset:28672
  ds_read_b64_tr_b16 v[94:95], v15 offset:30720
  s_waitcnt lgkmcnt(8)
  v_mfma_f32_16x16x32_bf16 v[128:131], a[152:155], v[64:67], v[128:131]
  ds_read_b64_tr_b16 v[112:113], v12 offset:32768
  ds_read_b64_tr_b16 v[114:115], v12 offset:34816
  buffer_load_dwordx4 v[252:255], v18, s[36:39], s34 offen offset:3072 sc1
  s_add_u32 s34, s34, 4096
  v_mfma_f32_16x16x32_bf16 v[132:135], a[152:155], v[68:71], v[132:135]
  ds_read_b64_tr_b16 v[116:117], v13 offset:32768
  ds_read_b64_tr_b16 v[118:119], v13 offset:34816
  v_mfma_f32_16x16x32_bf16 v[136:139], a[152:155], v[72:75], v[136:139]
  ds_read_b64_tr_b16 v[120:121], v14 offset:32768
  ds_read_b64_tr_b16 v[122:123], v14 offset:34816
  v_mfma_f32_16x16x32_bf16 v[140:143], a[152:155], v[76:79], v[140:143]
  ds_read_b64_tr_b16 v[124:125], v15 offset:32768
  ds_read_b64_tr_b16 v[126:127], v15 offset:34816
  s_waitcnt lgkmcnt(8)
  v_mfma_f32_16x16x32_bf16 v[128:131], a[156:159], v[80:83], v[128:131]
  ds_read_b64_tr_b16 v[64:65], v12 offset:36864
  ds_read_b64_tr_b16 v[66:67], v12 offset:38912
  v_mfma_f32_16x16x32_bf16 v[132:135], a[156:159], v[84:87], v[132:135]
  ds_read_b64_tr_b16 v[68:69], v13 offset:36864
  ds_read_b64_tr_b16 v[70:71], v13 offset:38912
  v_mfma_f32_16x16x32_bf16 v[136:139], a[156:159], v[88:91], v[136:139]
  ds_read_b64_tr_b16 v[72:73], v14 offset:36864
  ds_read_b64_tr_b16 v[74:75], v14 offset:38912
  v_mfma_f32_16x16x32_bf16 v[140:143], a[156:159], v[92:95], v[140:143]
  ds_read_b64_tr_b16 v[76:77], v15 offset:36864
  ds_read_b64_tr_b16 v[78:79], v15 offset:38912
  s_waitcnt lgkmcnt(8)
  v_mfma_f32_16x16x32_bf16 v[128:131], a[160:163], v[112:115], v[128:131]
  ds_read_b64_tr_b16 v[80:81], v12 offset:40960
  ds_read_b64_tr_b16 v[82:83], v12 offset:43008
  v_mfma_f32_16x16x32_bf16 v[132:135], a[160:163], v[116:119], v[132:135]
  ds_read_b64_tr_b16 v[84:85], v13 offset:40960
  ds_read_b64_tr_b16 v[86:87], v13 offset:43008
  v_mfma_f32_16x16x32_bf16 v[136:139], a[160:163], v[120:123], v[136:139]
  ds_read_b64_tr_b16 v[88:89], v14 offset:40960
  ds_read_b64_tr_b16 v[90:91], v14 offset:43008
  v_mfma_f32_16x16x32_bf16 v[140:143], a[160:163], v[124:127], v[140:143]
  ds_read_b64_tr_b16 v[92:93], v15 offset:40960
  ds_read_b64_tr_b16 v[94:95], v15 offset:43008
  s_waitcnt lgkmcnt(8)
  v_mfma_f32_16x16x32_bf16 v[128:131], a[164:167], v[64:67], v[128:131]
  ds_read_b64_tr_b16 v[112:113], v12 offset:45056
  ds_read_b64_tr_b16 v[114:115], v12 offset:47104
  v_mfma_f32_16x16x32_bf16 v[132:135], a[164:167], v[68:71], v[132:135]
  ds_read_b64_tr_b16 v[116:117], v13 offset:45056
  ds_read_b64_tr_b16 v[118:119], v13 offset:47104
  v_mfma_f32_16x16x32_bf16 v[136:139], a[164:167], v[72:75], v[136:139]
  ds_read_b64_tr_b16 v[120:121], v14 offset:45056
  ds_read_b64_tr_b16 v[122:123], v14 offset:47104
  v_mfma_f32_16x16x32_bf16 v[140:143], a[164:167], v[76:79], v[140:143]
  ds_read_b64_tr_b16 v[124:125], v15 offset:45056
  ds_read_b64_tr_b16 v[126:127], v15 offset:47104
  s_waitcnt lgkmcnt(8)
  v_mfma_f32_16x16x32_bf16 v[128:131], a[168:171], v[80:83], v[128:131]
  ds_read_b64_tr_b16 v[64:65], v12 offset:49152
  ds_read_b64_tr_b16 v[66:67], v12 offset:51200
  v_mfma_f32_16x16x32_bf16 v[132:135], a[168:171], v[84:87], v[132:135]
  ds_read_b64_tr_b16 v[68:69], v13 offset:49152
  ds_read_b64_tr_b16 v[70:71], v13 offset:51200
  v_mfma_f32_16x16x32_bf16 v[136:139], a[168:171], v[88:91], v[136:139]
  ds_read_b64_tr_b16 v[72:73], v14 offset:49152
  ds_read_b64_tr_b16 v[74:75], v14 offset:51200
  v_mfma_f32_16x16x32_bf16 v[140:143], a[168:171], v[92:95], v[140:143]
  ds_read_b64_tr_b16 v[76:77], v15 offset:49152
  ds_read_b64_tr_b16 v[78:79], v15 offset:51200
  s_waitcnt lgkmcnt(8)
  s_cmp_eq_u32 s41, 0
  s_cbranch_scc1 L_rl_34
  s_add_u32 s58, s3, 0
  buffer_load_dwordx4 v[24:27], v170, s[36:39], s58 offen sc1
  s_add_u32 s58, s3, 36864
  buffer_load_dwordx4 v[28:31], v170, s[36:39], s58 offen sc1
  s_add_u32 s58, s3, 73728
  buffer_load_dwordx4 v[32:35], v170, s[36:39], s58 offen sc1
  s_add_u32 s58, s3, 110592
  buffer_load_dwordx4 v[36:39], v170, s[36:39], s58 offen sc1
L_rl_34:
  v_mfma_f32_16x16x32_bf16 v[128:131], a[172:175], v[112:115], v[128:131]
  ds_read_b64_tr_b16 v[80:81], v12 offset:53248
  ds_read_b64_tr_b16 v[82:83], v12 offset:55296
  v_mfma_f32_16x16x32_bf16 v[132:135], a[172:175], v[116:119], v[132:135]
  ds_read_b64_tr_b16 v[84:85], v13 offset:53248
  ds_read_b64_tr_b16 v[86:87], v13 offset:55296
  v_mfma_f32_16x16x32_bf16 v[136:139], a[172:175], v[120:123], v[136:139]
  ds_read_b64_tr_b16 v[88:89], v14 offset:53248
  ds_read_b64_tr_b16 v[90:91], v14 offset:55296
  v_mfma_f32_16x16x32_bf16 v[140:143], a[172:175], v[124:127], v[140:143]
  ds_read_b64_tr_b16 v[92:93], v15 offset:53248
  ds_read_b64_tr_b16 v[94:95], v15 offset:55296
  s_waitcnt lgkmcnt(8)
  v_mfma_f32_16x16x32_bf16 v[128:131], a[176:179], v[64:67], v[128:131]
  ds_read_b64_tr_b16 v[112:113], v12 offset:57344
  ds_read_b64_tr_b16 v[114:115], v12 offset:59392
  v_mfma_f32_16x16x32_bf16 v[132:135], a[176:179], v[68:71], v[132:135]
  ds_read_b64_tr_b16 v[116:117], v13 offset:57344
  ds_read_b64_tr_b16 v[118:119], v13 offset:59392
  v_mfma_f32_16x16x32_bf16 v[136:139], a[176:179], v[72:75], v[136:139]
  ds_read_b64_tr_b16 v[120:121], v14 offset:57344
  ds_read_b64_tr_b16 v[122:123], v14 offset:59392
  v_mfma_f32_16x16x32_bf16 v[140:143], a[176:179], v[76:79], v[140:143]
  ds_read_b64_tr_b16 v[124:125], v15 offset:57344
  ds_read_b64_tr_b16 v[126:127], v15 offset:59392
  s_waitcnt lgkmcnt(8)
  v_mfma_f32_16x16x32_bf16 v[128:131], a[180:183], v[80:83], v[128:131]
  ds_read_b64_tr_b16 v[64:65], v12 offset:61440
  ds_read_b64_tr_b16 v[66:67], v12 offset:63488
  v_mfma_f32_16x16x32_bf16 v[132:135], a[180:183], v[84:87], v[132:135]
  ds_read_b64_tr_b16 v[68:69], v13 offset:61440
  ds_read_b64_tr_b16 v[70:71], v13 offset:63488
  v_mfma_f32_16x16x32_bf16 v[136:139], a[180:183], v[88:91], v[136:139]
  ds_read_b64_tr_b16 v[72:73], v14 offset:61440
  ds_read_b64_tr_b16 v[74:75], v14 offset:63488
  v_mfma_f32_16x16x32_bf16 v[140:143], a[180:183], v[92:95], v[140:143]
  ds_read_b64_tr_b16 v[76:77], v15 offset:61440
  ds_read_b64_tr_b16 v[78:79], v15 offset:63488
  s_waitcnt lgkmcnt(8)
  v_mfma_f32_16x16x32_bf16 v[128:131], a[184:187], v[112:115], v[128:131]
  v_mfma_f32_16x16x32_bf16 v[132:135], a[184:187], v[116:119], v[132:135]
  v_mfma_f32_16x16x32_bf16 v[136:139], a[184:187], v[120:123], v[136:139]
  v_mfma_f32_16x16x32_bf16 v[140:143], a[184:187], v[124:127], v[140:143]
  s_waitcnt lgkmcnt(0)
  v_mfma_f32_16x16x32_bf16 v[128:131], a[188:191], v[64:67], v[128:131]
  v_mfma_f32_16x16x32_bf16 v[132:135], a[188:191], v[68:71], v[132:135]
  v_mfma_f32_16x16x32_bf16 v[136:139], a[188:191], v[72:75], v[136:139]
  v_mfma_f32_16x16x32_bf16 v[140:143], a[188:191], v[76:79], v[140:143]
  v_pk_fma_f32 v[64:65], v[176:177], v[6:7], s[66:67] op_sel_hi:[0,1,1]
  v_pk_fma_f32 v[68:69], v[176:177], v[8:9], s[66:67] op_sel_hi:[0,1,1]
  v_pk_fma_f32 v[72:73], v[178:179], v[6:7], s[66:67] op_sel_hi:[0,1,1]
  v_pk_fma_f32 v[76:77], v[178:179], v[8:9], s[66:67] op_sel_hi:[0,1,1]
  s_nop 0
  v_pk_fma_f32 v[64:65], v[56:57], v[128:129], v[64:65] op_sel_hi:[0,1,1]
  v_pk_fma_f32 v[68:69], v[56:57], v[130:131], v[68:69] op_sel_hi:[0,1,1]
  v_pk_fma_f32 v[72:73], v[58:59], v[132:133], v[72:73] op_sel_hi:[0,1,1]
  v_pk_fma_f32 v[76:77], v[58:59], v[134:135], v[76:77] op_sel_hi:[0,1,1]
  v_pk_mul_f32 v[66:67], v[64:65], s[64:65]
  v_pk_mul_f32 v[70:71], v[68:69], s[64:65]
  v_pk_mul_f32 v[74:75], v[72:73], s[64:65]
  v_pk_mul_f32 v[78:79], v[76:77], s[64:65]
  v_exp_f32 v66, v66 clamp
  v_exp_f32 v67, v67 clamp
  v_exp_f32 v70, v70 clamp
  v_exp_f32 v71, v71 clamp
  v_exp_f32 v74, v74 clamp
  v_exp_f32 v75, v75 clamp
  v_exp_f32 v78, v78 clamp
  v_exp_f32 v79, v79 clamp
  v_max_f32 v64, s66, v64
  v_max_f32 v65, s66, v65
  v_max_f32 v68, s66, v68
  v_max_f32 v69, s66, v69
  v_max_f32 v72, s66, v72
  v_max_f32 v73, s66, v73
  v_max_f32 v76, s66, v76
  v_max_f32 v77, s66, v77
  v_pk_add_f32 v[64:65], v[64:65], v[66:67]
  v_pk_add_f32 v[68:69], v[68:69], v[70:71]
  v_pk_add_f32 v[72:73], v[72:73], v[74:75]
  v_pk_add_f32 v[76:77], v[76:77], v[78:79]
  v_cvt_pk_bf16_f32 v96, v64, v65
  v_cvt_pk_bf16_f32 v97, v68, v69
  v_cvt_pk_bf16_f32 v98, v72, v73
  v_cvt_pk_bf16_f32 v99, v76, v77
  v_pk_fma_f32 v[64:65], v[180:181], v[6:7], s[66:67] op_sel_hi:[0,1,1]
  v_pk_fma_f32 v[68:69], v[180:181], v[8:9], s[66:67] op_sel_hi:[0,1,1]
  v_pk_fma_f32 v[72:73], v[182:183], v[6:7], s[66:67] op_sel_hi:[0,1,1]
  v_pk_fma_f32 v[76:77], v[182:183], v[8:9], s[66:67] op_sel_hi:[0,1,1]
  v_pk_fma_f32 v[64:65], v[60:61], v[136:137], v[64:65] op_sel_hi:[0,1,1]
  v_pk_fma_f32 v[68:69], v[60:61], v[138:139], v[68:69] op_sel_hi:[0,1,1]
  v_pk_fma_f32 v[72:73], v[62:63], v[140:141], v[72:73] op_sel_hi:[0,1,1]
  v_pk_fma_f32 v[76:77], v[62:63], v[142:143], v[76:77] op_sel_hi:[0,1,1]
  v_pk_mul_f32 v[66:67], v[64:65], s[64:65]
  v_pk_mul_f32 v[70:71], v[68:69], s[64:65]
  v_pk_mul_f32 v[74:75], v[72:73], s[64:65]
  v_pk_mul_f32 v[78:79], v[76:77], s[64:65]
  v_exp_f32 v66, v66 clamp
  v_exp_f32 v67, v67 clamp
  v_exp_f32 v70, v70 clamp
  v_exp_f32 v71, v71 clamp
  v_exp_f32 v74, v74 clamp
  v_exp_f32 v75, v75 clamp
  v_exp_f32 v78, v78 clamp
  v_exp_f32 v79, v79 clamp
  v_max_f32 v64, s66, v64
  v_max_f32 v65, s66, v65
  v_max_f32 v68, s66, v68
  v_max_f32 v69, s66, v69
  v_max_f32 v72, s66, v72
  v_max_f32 v73, s66, v73
  v_max_f32 v76, s66, v76
  v_max_f32 v77, s66, v77
  v_pk_add_f32 v[64:65], v[64:65], v[66:67]
  v_pk_add_f32 v[68:69], v[68:69], v[70:71]
  v_pk_add_f32 v[72:73], v[72:73], v[74:75]
  v_pk_add_f32 v[76:77], v[76:77], v[78:79]
  v_cvt_pk_bf16_f32 v100, v64, v65
  v_cvt_pk_bf16_f32 v101, v68, v69
  v_cvt_pk_bf16_f32 v102, v72, v73
  v_cvt_pk_bf16_f32 v103, v76, v77
  s_lshl_b32 s56, s68, 2
  s_add_u32 s56, s56, s7
  buffer_store_dwordx2 v[96:97], v168, s[36:39], s56 offen sc1
  s_lshl_b32 s56, s69, 2
  s_add_u32 s56, s56, s7
  buffer_store_dwordx2 v[98:99], v168, s[36:39], s56 offen sc1
  s_lshl_b32 s56, s70, 2
  s_add_u32 s56, s56, s7
  buffer_store_dwordx2 v[100:101], v168, s[36:39], s56 offen sc1
  s_lshl_b32 s56, s71, 2
  s_add_u32 s56, s56, s7
  buffer_store_dwordx2 v[102:103], v168, s[36:39], s56 offen sc1
  s_cmp_eq_u32 s41, 0
  s_cbranch_scc1 L_red_35
  s_waitcnt vmcnt(4)
  s_branch L_r0_38
L_rp_36:
  s_add_u32 s58, s3, 0
  buffer_load_dwordx4 v[24:27], v170, s[36:39], s58 offen sc1
  s_add_u32 s58, s3, 36864
  buffer_load_dwordx4 v[28:31], v170, s[36:39], s58 offen sc1
  s_add_u32 s58, s3, 73728
  buffer_load_dwordx4 v[32:35], v170, s[36:39], s58 offen sc1
  s_add_u32 s58, s3, 110592
  buffer_load_dwordx4 v[36:39], v170, s[36:39], s58 offen sc1
  s_waitcnt vmcnt(0)
L_r0_38:
  v_max3_u32 v56, v24, v28, v32
  v_max_u32 v56, v56, v36
  v_cmp_eq_u32 vcc, -1, v56
  s_cbranch_vccz L_rg_37
  s_sleep 2
  s_sub_u32 s52, s52, 1
  s_cbranch_scc0 L_rp_36
  s_mov_b32 s52, 0
L_rg_37:
  v_pk_add_f32 v[24:25], v[24:25], v[28:29]
  v_pk_add_f32 v[26:27], v[26:27], v[30:31]
  v_pk_add_f32 v[32:33], v[32:33], v[36:37]
  v_pk_add_f32 v[34:35], v[34:35], v[38:39]
  v_pk_add_f32 v[24:25], v[24:25], v[32:33]
  v_pk_add_f32 v[26:27], v[26:27], v[34:35]
  s_nop 0
  v_add_f32_dpp v24, v24, v24 row_ror:8 row_mask:0xf bank_mask:0xf
  v_add_f32_dpp v25, v25, v25 row_ror:8 row_mask:0xf bank_mask:0xf
  v_add_f32_dpp v26, v26, v26 row_ror:8 row_mask:0xf bank_mask:0xf
  v_add_f32_dpp v27, v27, v27 row_ror:8 row_mask:0xf bank_mask:0xf
  v_mov_b32 v28, v24
  v_mov_b32 v29, v25
  v_mov_b32 v30, v26
  v_mov_b32 v31, v27
  v_permlane16_swap_b32 v24, v28
  v_permlane16_swap_b32 v25, v29
  v_permlane16_swap_b32 v26, v30
  v_permlane16_swap_b32 v27, v31
  v_add_f32 v24, v24, v28
  v_add_f32 v25, v25, v29
  v_add_f32 v26, v26, v30
  v_add_f32 v27, v27, v31
  v_mov_b32 v28, v24
  v_mov_b32 v29, v25
  v_mov_b32 v30, v26
  v_mov_b32 v31, v27
  v_permlane32_swap_b32 v24, v28
  v_permlane32_swap_b32 v25, v29
  v_permlane32_swap_b32 v26, v30
  v_permlane32_swap_b32 v27, v31
  v_add_f32 v24, v24, v28
  v_add_f32 v25, v25, v29
  v_add_f32 v26, v26, v30
  v_add_f32 v27, v27, v31
  v_cvt_pk_bf16_f32 v28, v24, v25
  v_cvt_pk_bf16_f32 v29, v26, v27
  s_mov_b64 exec, s[42:43]
  buffer_store_dwordx2 v[28:29], v171, s[36:39], s40 offen sc1
  s_mov_b64 exec, -1
L_red_35:
  v_and_b32 v10, 31, v1
  v_min_u32 v10, 16, v10
  v_lshlrev_b32 v10, 5, v10
  v_lshrrev_b32 v11, 5, v1
  v_lshl_add_u32 v10, v11, 4, v10
  s_lshl_b32 s54, s44, 3
  s_mul_i32 s4, s54, 640
  s_add_u32 s4, s4, 17825792
  s_mul_i32 s55, s45, 20608
  s_add_u32 s4, s4, s55
  v_and_b32 v11, 31, v1
  v_lshlrev_b32 v11, 4, v11
  v_lshrrev_b32 v12, 5, v1
  v_lshl_add_u32 v11, v12, 10, v11
  s_mul_i32 s5, s54, 65792
  s_add_u32 s5, s5, 11534336
  s_lshl_b32 s57, s48, 11
  s_add_u32 s5, s5, s57
  s_and_b32 s57, s50, 1
  s_lshl_b32 s57, s57, 9
  s_add_u32 s5, s5, s57
  s_mul_i32 s3, s44, 5120
  s_add_u32 s3, s3, 99328
  v_add_u32 v10, s3, v10
  v_lshlrev_b32 v19, 4, v1
  s_lshl_b32 s54, s44, 13
  s_add_u32 s54, s54, 66560
  v_lshl_add_u32 v12, v1, 4, s54
  v_lshlrev_b32 v13, 4, v1
  v_add_u32 v13, 66560, v13
  v_and_b32 v14, 31, v1
  v_mul_u32_u24 v14, 80, v14
  v_lshrrev_b32 v15, 5, v1
  v_lshl_add_u32 v14, v15, 5, v14
  s_mul_i32 s58, s44, 2560
  s_add_u32 s58, s58, 134144
  v_add_u32 v14, s58, v14
  v_lshrrev_b32 v15, 4, v1
  v_lshlrev_b32 v15, 3, v15
  v_bfe_u32 v16, v1, 2, 2
  v_add_u32 v15, v15, v16
  v_mul_u32_u24 v15, 80, v15
  v_and_b32 v16, 3, v1
  v_lshl_add_u32 v15, v16, 3, v15
  v_add_u32 v15, s58, v15
  v_and_b32 v16, 15, v1
  v_lshlrev_b32 v16, 6, v16
  v_lshrrev_b32 v17, 4, v1
  v_lshl_add_u32 v16, v17, 4, v16
  s_lshl_b32 s6, s51, 7
  s_lshl_b32 s55, s44, 5
  s_add_u32 s6, s6, s55
  s_lshl_b32 s6, s6, 6
  s_mul_i32 s55, s50, 33024
  s_add_u32 s6, s6, s55
  s_add_u32 s6, s6, 9306112
  v_bfe_u32 v17, v1, 1, 2
  v_lshlrev_b32 v17, 12, v17
  v_bfe_u32 v18, v1, 3, 2
  v_lshl_add_u32 v17, v18, 4, v17
  v_and_b32 v18, 1, v1
  v_lshl_add_u32 v17, v18, 3, v17
  v_lshrrev_b32 v18, 5, v1
  v_lshl_add_u32 v17, v18, 2, v17
  s_lshl_b32 s7, s50, 6
  s_add_u32 s7, s7, 16384
  s_barrier
  s_add_u32 s57, s5, 0
  buffer_load_dwordx4 v[56:59], v11, s[36:39], s57 offen sc1
  s_add_u32 s57, s5, 65792
  buffer_load_dwordx4 v[60:63], v11, s[36:39], s57 offen sc1
  s_add_u32 s57, s5, 131584
  buffer_load_dwordx4 v[64:67], v11, s[36:39], s57 offen sc1
  s_add_u32 s57, s5, 197376
  buffer_load_dwordx4 v[68:71], v11, s[36:39], s57 offen sc1
  s_add_u32 s57, s5, 263168
  buffer_load_dwordx4 v[72:75], v11, s[36:39], s57 offen sc1
  s_add_u32 s57, s5, 328960
  buffer_load_dwordx4 v[76:79], v11, s[36:39], s57 offen sc1
  s_add_u32 s57, s5, 394752
  buffer_load_dwordx4 v[80:83], v11, s[36:39], s57 offen sc1
  s_add_u32 s57, s5, 460544
  buffer_load_dwordx4 v[84:87], v11, s[36:39], s57 offen sc1
  s_sleep 4
L_of_39:
  s_add_u32 s57, s4, 0
  s_add_u32 m0, s3, 0
  s_nop 0
  buffer_load_dwordx4 v19, s[36:39], s57 offen sc1 lds
  s_add_u32 s57, s4, 1024
  s_add_u32 m0, s3, 1024
  s_nop 0
  buffer_load_dwordx4 v19, s[36:39], s57 offen sc1 lds
  s_add_u32 s57, s4, 2048
  s_add_u32 m0, s3, 2048
  s_nop 0
  buffer_load_dwordx4 v19, s[36:39], s57 offen sc1 lds
  s_add_u32 s57, s4, 3072
  s_add_u32 m0, s3, 3072
  s_nop 0
  buffer_load_dwordx4 v19, s[36:39], s57 offen sc1 lds
  s_add_u32 s57, s4, 4096
  s_add_u32 m0, s3, 4096
  s_nop 0
  buffer_load_dwordx4 v19, s[36:39], s57 offen sc1 lds
  s_waitcnt vmcnt(0)
  ds_read_b128 v[24:27], v10 offset:0
  ds_read_b128 v[28:31], v10 offset:640
  ds_read_b128 v[32:35], v10 offset:1280
  ds_read_b128 v[36:39], v10 offset:1920
  ds_read_b128 v[40:43], v10 offset:2560
  ds_read_b128 v[44:47], v10 offset:3200
  ds_read_b128 v[48:51], v10 offset:3840
  ds_read_b128 v[52:55], v10 offset:4480
  s_waitcnt lgkmcnt(0)
  v_max3_u32 v18, v24, v26, v28
  v_max3_u32 v18, v18, v30, v32
  v_max3_u32 v18, v18, v34, v36
  v_max3_u32 v18, v18, v38, v40
  v_max3_u32 v18, v18, v42, v44
  v_max3_u32 v18, v18, v46, v48
  v_max3_u32 v18, v18, v50, v52
  v_max_u32 v18, v18, v54
  v_cmp_eq_u32 vcc, -1, v18
  s_cbranch_vccz L_ofk_40
  s_sleep 2
  s_sub_u32 s52, s52, 1
  s_cbranch_scc0 L_of_39
  s_mov_b32 s52, 0
L_ofk_40:
L_oq_41:
  v_max3_u32 v18, v56, v58, v60
  v_max3_u32 v18, v18, v62, v64
  v_max3_u32 v18, v18, v66, v68
  v_max3_u32 v18, v18, v70, v72
  v_max3_u32 v18, v18, v74, v76
  v_max3_u32 v18, v18, v78, v80
  v_max3_u32 v18, v18, v82, v84
  v_max_u32 v18, v18, v86
  v_cmp_eq_u32 vcc, -1, v18
  s_cbranch_vccz L_oqk_42
  s_sub_u32 s52, s52, 1
  s_cbranch_scc1 L_oqk_42_x
  s_add_u32 s57, s5, 0
  buffer_load_dwordx4 v[56:59], v11, s[36:39], s57 offen sc1
  s_add_u32 s57, s5, 65792
  buffer_load_dwordx4 v[60:63], v11, s[36:39], s57 offen sc1
  s_add_u32 s57, s5, 131584
  buffer_load_dwordx4 v[64:67], v11, s[36:39], s57 offen sc1
  s_add_u32 s57, s5, 197376
  buffer_load_dwordx4 v[68:71], v11, s[36:39], s57 offen sc1
  s_add_u32 s57, s5, 263168
  buffer_load_dwordx4 v[72:75], v11, s[36:39], s57 offen sc1
  s_add_u32 s57, s5, 328960
  buffer_load_dwordx4 v[76:79], v11, s[36:39], s57 offen sc1
  s_add_u32 s57, s5, 394752
  buffer_load_dwordx4 v[80:83], v11, s[36:39], s57 offen sc1
  s_add_u32 s57, s5, 460544
  buffer_load_dwordx4 v[84:87], v11, s[36:39], s57 offen sc1
  s_waitcnt vmcnt(0)
  s_branch L_oq_41
L_oqk_42_x:
  s_mov_b32 s52, 0
L_oqk_42:
  v_mfma_f32_32x32x16_bf16 v[88:103], v[24:27], v[56:59], 0
  v_mfma_f32_32x32x16_bf16 v[104:119], v[28:31], v[60:63], 0
  v_mfma_f32_32x32x16_bf16 v[120:135], v[32:35], v[64:67], 0
  v_mfma_f32_32x32x16_bf16 v[136:151], v[36:39], v[68:71], 0
  v_mfma_f32_32x32x16_bf16 v[152:167], v[40:43], v[72:75], 0
  v_mfma_f32_32x32x16_bf16 v[168:183], v[44:47], v[76:79], 0
  s_nop 6
  v_add_f32 v96, s66, v96
  v_add_f32 v112, s66, v112
  v_rcp_f32 v96, v96
  v_rcp_f32 v112, v112
  v_pk_mul_f32 v[88:89], v[88:89], v[96:97] op_sel_hi:[1,0]
  v_pk_mul_f32 v[104:105], v[104:105], v[112:113] op_sel_hi:[1,0]
  v_pk_mul_f32 v[90:91], v[90:91], v[96:97] op_sel_hi:[1,0]
  v_pk_mul_f32 v[106:107], v[106:107], v[112:113] op_sel_hi:[1,0]
  v_pk_mul_f32 v[92:93], v[92:93], v[96:97] op_sel_hi:[1,0]
  v_pk_mul_f32 v[108:109], v[108:109], v[112:113] op_sel_hi:[1,0]
  v_pk_mul_f32 v[94:95], v[94:95], v[96:97] op_sel_hi:[1,0]
  v_pk_mul_f32 v[110:111], v[110:111], v[112:113] op_sel_hi:[1,0]
  v_cvt_pk_bf16_f32 v98, v88, v89
  v_cvt_pk_bf16_f32 v99, v90, v91
  v_cvt_pk_bf16_f32 v100, v92, v93
  v_cvt_pk_bf16_f32 v101, v94, v95
  ds_write_b128 v12, v[98:101] offset:0
  v_cvt_pk_bf16_f32 v114, v104, v105
  v_cvt_pk_bf16_f32 v115, v106, v107
  v_cvt_pk_bf16_f32 v116, v108, v109
  v_cvt_pk_bf16_f32 v117, v110, v111
  ds_write_b128 v12, v[114:117] offset:1024
  v_mfma_f32_32x32x16_bf16 v[24:39], v[48:51], v[80:83], 0
  v_mfma_f32_32x32x16_bf16 v[56:71], v[52:55], v[84:87], 0
  v_add_f32 v128, s66, v128
  v_add_f32 v144, s66, v144
  v_rcp_f32 v128, v128
  v_rcp_f32 v144, v144
  v_pk_mul_f32 v[120:121], v[120:121], v[128:129] op_sel_hi:[1,0]
  v_pk_mul_f32 v[136:137], v[136:137], v[144:145] op_sel_hi:[1,0]
  v_pk_mul_f32 v[122:123], v[122:123], v[128:129] op_sel_hi:[1,0]
  v_pk_mul_f32 v[138:139], v[138:139], v[144:145] op_sel_hi:[1,0]
  v_pk_mul_f32 v[124:125], v[124:125], v[128:129] op_sel_hi:[1,0]
  v_pk_mul_f32 v[140:141], v[140:141], v[144:145] op_sel_hi:[1,0]
  v_pk_mul_f32 v[126:127], v[126:127], v[128:129] op_sel_hi:[1,0]
  v_pk_mul_f32 v[142:143], v[142:143], v[144:145] op_sel_hi:[1,0]
  v_cvt_pk_bf16_f32 v130, v120, v121
  v_cvt_pk_bf16_f32 v131, v122, v123
  v_cvt_pk_bf16_f32 v132, v124, v125
  v_cvt_pk_bf16_f32 v133, v126, v127
  ds_write_b128 v12, v[130:133] offset:2048
  v_cvt_pk_bf16_f32 v146, v136, v137
  v_cvt_pk_bf16_f32 v147, v138, v139
  v_cvt_pk_bf16_f32 v148, v140, v141
  v_cvt_pk_bf16_f32 v149, v142, v143
  ds_write_b128 v12, v[146:149] offset:3072
  v_add_f32 v160, s66, v160
  v_add_f32 v176, s66, v176
  v_rcp_f32 v160, v160
  v_rcp_f32 v176, v176
  v_pk_mul_f32 v[152:153], v[152:153], v[160:161] op_sel_hi:[1,0]
  v_pk_mul_f32 v[168:169], v[168:169], v[176:177] op_sel_hi:[1,0]
  v_pk_mul_f32 v[154:155], v[154:155], v[160:161] op_sel_hi:[1,0]
  v_pk_mul_f32 v[170:171], v[170:171], v[176:177] op_sel_hi:[1,0]
  v_pk_mul_f32 v[156:157], v[156:157], v[160:161] op_sel_hi:[1,0]
  v_pk_mul_f32 v[172:173], v[172:173], v[176:177] op_sel_hi:[1,0]
  v_pk_mul_f32 v[158:159], v[158:159], v[160:161] op_sel_hi:[1,0]
  v_pk_mul_f32 v[174:175], v[174:175], v[176:177] op_sel_hi:[1,0]
  v_cvt_pk_bf16_f32 v162, v152, v153
  v_cvt_pk_bf16_f32 v163, v154, v155
  v_cvt_pk_bf16_f32 v164, v156, v157
  v_cvt_pk_bf16_f32 v165, v158, v159
  ds_write_b128 v12, v[162:165] offset:4096
  v_cvt_pk_bf16_f32 v178, v168, v169
  v_cvt_pk_bf16_f32 v179, v170, v171
  v_cvt_pk_bf16_f32 v180, v172, v173
  v_cvt_pk_bf16_f32 v181, v174, v175
  ds_write_b128 v12, v[178:181] offset:5120
  v_add_f32 v32, s66, v32
  v_add_f32 v64, s66, v64
  v_rcp_f32 v32, v32
  v_rcp_f32 v64, v64
  v_pk_mul_f32 v[24:25], v[24:25], v[32:33] op_sel_hi:[1,0]
  v_pk_mul_f32 v[56:57], v[56:57], v[64:65] op_sel_hi:[1,0]
  v_pk_mul_f32 v[26:27], v[26:27], v[32:33] op_sel_hi:[1,0]
  v_pk_mul_f32 v[58:59], v[58:59], v[64:65] op_sel_hi:[1,0]
  v_pk_mul_f32 v[28:29], v[28:29], v[32:33] op_sel_hi:[1,0]
  v_pk_mul_f32 v[60:61], v[60:61], v[64:65] op_sel_hi:[1,0]
  v_pk_mul_f32 v[30:31], v[30:31], v[32:33] op_sel_hi:[1,0]
  v_pk_mul_f32 v[62:63], v[62:63], v[64:65] op_sel_hi:[1,0]
  v_cvt_pk_bf16_f32 v34, v24, v25
  v_cvt_pk_bf16_f32 v35, v26, v27
  v_cvt_pk_bf16_f32 v36, v28, v29
  v_cvt_pk_bf16_f32 v37, v30, v31
  ds_write_b128 v12, v[34:37] offset:6144
  v_cvt_pk_bf16_f32 v66, v56, v57
  v_cvt_pk_bf16_f32 v67, v58, v59
  v_cvt_pk_bf16_f32 v68, v60, v61
  v_cvt_pk_bf16_f32 v69, v62, v63
  ds_write_b128 v12, v[66:69] offset:7168
  s_waitcnt lgkmcnt(0)
  s_barrier
  ds_read_b128 v[56:59], v13 offset:0
  ds_read_b128 v[60:63], v13 offset:1024
  ds_read_b128 v[64:67], v13 offset:2048
  ds_read_b128 v[68:71], v13 offset:3072
  ds_read_b128 v[72:75], v13 offset:4096
  ds_read_b128 v[76:79], v13 offset:5120
  ds_read_b128 v[80:83], v13 offset:6144
  ds_read_b128 v[84:87], v13 offset:7168
  v_lshlrev_b32 v104, 16, v184
  v_and_b32 v105, s76, v184
  v_lshlrev_b32 v106, 16, v185
  v_and_b32 v107, s76, v185
  v_lshlrev_b32 v108, 16, v186
  v_and_b32 v109, s76, v186
  v_lshlrev_b32 v110, 16, v187
  v_and_b32 v111, s76, v187
  v_lshlrev_b32 v112, 16, v188
  v_and_b32 v113, s76, v188
  v_lshlrev_b32 v114, 16, v189
  v_and_b32 v115, s76, v189
  v_lshlrev_b32 v116, 16, v190
  v_and_b32 v117, s76, v190
  v_lshlrev_b32 v118, 16, v191
  v_and_b32 v119, s76, v191
  s_waitcnt lgkmcnt(7)
  v_mfma_f32_32x32x16_bf16 v[24:39], a[192:195], v[56:59], 0
  ds_read_b128 v[56:59], v13 offset:8192
  s_waitcnt lgkmcnt(7)
  v_mfma_f32_32x32x16_bf16 v[24:39], a[196:199], v[60:63], v[24:39]
  ds_read_b128 v[60:63], v13 offset:9216
  s_waitcnt lgkmcnt(7)
  v_mfma_f32_32x32x16_bf16 v[24:39], a[200:203], v[64:67], v[24:39]
  ds_read_b128 v[64:67], v13 offset:10240
  s_waitcnt lgkmcnt(7)
  v_mfma_f32_32x32x16_bf16 v[24:39], a[204:207], v[68:71], v[24:39]
  ds_read_b128 v[68:71], v13 offset:11264
  s_waitcnt lgkmcnt(7)
  v_mfma_f32_32x32x16_bf16 v[24:39], a[208:211], v[72:75], v[24:39]
  ds_read_b128 v[72:75], v13 offset:12288
  s_waitcnt lgkmcnt(7)
  v_mfma_f32_32x32x16_bf16 v[24:39], a[212:215], v[76:79], v[24:39]
  ds_read_b128 v[76:79], v13 offset:13312
  s_waitcnt lgkmcnt(7)
  v_mfma_f32_32x32x16_bf16 v[24:39], a[216:219], v[80:83], v[24:39]
  ds_read_b128 v[80:83], v13 offset:14336
  s_waitcnt lgkmcnt(7)
  v_mfma_f32_32x32x16_bf16 v[24:39], a[220:223], v[84:87], v[24:39]
  ds_read_b128 v[84:87], v13 offset:15360
  s_waitcnt lgkmcnt(7)
  v_mfma_f32_32x32x16_bf16 v[24:39], a[224:227], v[56:59], v[24:39]
  ds_read_b128 v[56:59], v13 offset:16384
  s_waitcnt lgkmcnt(7)
  v_mfma_f32_32x32x16_bf16 v[24:39], a[228:231], v[60:63], v[24:39]
  ds_read_b128 v[60:63], v13 offset:17408
  s_waitcnt lgkmcnt(7)
  v_mfma_f32_32x32x16_bf16 v[24:39], a[232:235], v[64:67], v[24:39]
  ds_read_b128 v[64:67], v13 offset:18432
  s_waitcnt lgkmcnt(7)
  v_mfma_f32_32x32x16_bf16 v[24:39], a[236:239], v[68:71], v[24:39]
  ds_read_b128 v[68:71], v13 offset:19456
  s_waitcnt lgkmcnt(7)
  v_mfma_f32_32x32x16_bf16 v[24:39], a[240:243], v[72:75], v[24:39]
  ds_read_b128 v[72:75], v13 offset:20480
  s_waitcnt lgkmcnt(7)
  v_mfma_f32_32x32x16_bf16 v[24:39], a[244:247], v[76:79], v[24:39]
  ds_read_b128 v[76:79], v13 offset:21504
  s_waitcnt lgkmcnt(7)
  v_mfma_f32_32x32x16_bf16 v[24:39], a[248:251], v[80:83], v[24:39]
  ds_read_b128 v[80:83], v13 offset:22528
  s_waitcnt lgkmcnt(7)
  v_mfma_f32_32x32x16_bf16 v[24:39], a[252:255], v[84:87], v[24:39]
  ds_read_b128 v[84:87], v13 offset:23552
  s_waitcnt lgkmcnt(7)
  v_mfma_f32_32x32x16_bf16 v[24:39], v[192:195], v[56:59], v[24:39]
  ds_read_b128 v[56:59], v13 offset:24576
  s_waitcnt lgkmcnt(7)
  v_mfma_f32_32x32x16_bf16 v[24:39], v[196:199], v[60:63], v[24:39]
  ds_read_b128 v[60:63], v13 offset:25600
  s_waitcnt lgkmcnt(7)
  v_mfma_f32_32x32x16_bf16 v[24:39], v[200:203], v[64:67], v[24:39]
  ds_read_b128 v[64:67], v13 offset:26624
  s_waitcnt lgkmcnt(7)
  v_mfma_f32_32x32x16_bf16 v[24:39], v[204:207], v[68:71], v[24:39]
  ds_read_b128 v[68:71], v13 offset:27648
  s_waitcnt lgkmcnt(7)
  v_mfma_f32_32x32x16_bf16 v[24:39], v[208:211], v[72:75], v[24:39]
  ds_read_b128 v[72:75], v13 offset:28672
  s_waitcnt lgkmcnt(7)
  v_mfma_f32_32x32x16_bf16 v[24:39], v[212:215], v[76:79], v[24:39]
  ds_read_b128 v[76:79], v13 offset:29696
  s_waitcnt lgkmcnt(7)
  v_mfma_f32_32x32x16_bf16 v[24:39], v[216:219], v[80:83], v[24:39]
  ds_read_b128 v[80:83], v13 offset:30720
  s_waitcnt lgkmcnt(7)
  v_mfma_f32_32x32x16_bf16 v[24:39], v[220:223], v[84:87], v[24:39]
  ds_read_b128 v[84:87], v13 offset:31744
  s_waitcnt lgkmcnt(7)
  v_mfma_f32_32x32x16_bf16 v[24:39], v[224:227], v[56:59], v[24:39]
  s_waitcnt lgkmcnt(6)
  v_mfma_f32_32x32x16_bf16 v[24:39], v[228:231], v[60:63], v[24:39]
  s_waitcnt lgkmcnt(5)
  v_mfma_f32_32x32x16_bf16 v[24:39], v[232:235], v[64:67], v[24:39]
  s_waitcnt lgkmcnt(4)
  v_mfma_f32_32x32x16_bf16 v[24:39], v[236:239], v[68:71], v[24:39]
  s_waitcnt lgkmcnt(3)
  v_mfma_f32_32x32x16_bf16 v[24:39], v[240:243], v[72:75], v[24:39]
  s_waitcnt lgkmcnt(2)
  v_mfma_f32_32x32x16_bf16 v[24:39], v[244:247], v[76:79], v[24:39]
  s_waitcnt lgkmcnt(1)
  v_mfma_f32_32x32x16_bf16 v[24:39], v[248:251], v[80:83], v[24:39]
  s_waitcnt lgkmcnt(0)
  v_mfma_f32_32x32x16_bf16 v[24:39], v[252:255], v[84:87], v[24:39]
  s_nop 11
  v_pk_add_f32 v[104:105], v[104:105], v[24:25]
  v_pk_add_f32 v[106:107], v[106:107], v[26:27]
  v_pk_add_f32 v[108:109], v[108:109], v[28:29]
  v_pk_add_f32 v[110:111], v[110:111], v[30:31]
  v_pk_add_f32 v[112:113], v[112:113], v[32:33]
  v_pk_add_f32 v[114:115], v[114:115], v[34:35]
  v_pk_add_f32 v[116:117], v[116:117], v[36:37]
  v_pk_add_f32 v[118:119], v[118:119], v[38:39]
  v_cvt_pk_bf16_f32 v120, v104, v105
  v_cvt_pk_bf16_f32 v121, v106, v107
  v_cvt_pk_bf16_f32 v122, v108, v109
  v_cvt_pk_bf16_f32 v123, v110, v111
  v_cvt_pk_bf16_f32 v124, v112, v113
  v_cvt_pk_bf16_f32 v125, v114, v115
  v_cvt_pk_bf16_f32 v126, v116, v117
  v_cvt_pk_bf16_f32 v127, v118, v119
  ds_write_b128 v14, v[120:123]
  ds_write_b128 v14, v[124:127] offset:16
  v_pk_add_f32 v[64:65], v[104:105], v[106:107]
  v_pk_mul_f32 v[66:67], v[104:105], v[104:105]
  v_pk_add_f32 v[68:69], v[108:109], v[110:111]
  v_pk_mul_f32 v[70:71], v[106:107], v[106:107]
  v_pk_fma_f32 v[66:67], v[108:109], v[108:109], v[66:67]
  v_pk_fma_f32 v[70:71], v[110:111], v[110:111], v[70:71]
  v_pk_fma_f32 v[66:67], v[112:113], v[112:113], v[66:67]
  v_pk_add_f32 v[64:65], v[64:65], v[112:113]
  v_pk_fma_f32 v[70:71], v[114:115], v[114:115], v[70:71]
  v_pk_add_f32 v[68:69], v[68:69], v[114:115]
  v_pk_fma_f32 v[66:67], v[116:117], v[116:117], v[66:67]
  v_pk_add_f32 v[64:65], v[64:65], v[116:117]
  v_pk_fma_f32 v[70:71], v[118:119], v[118:119], v[70:71]
  v_pk_add_f32 v[68:69], v[68:69], v[118:119]
  s_waitcnt lgkmcnt(0)
  ds_read_b64_tr_b16 v[80:81], v15 offset:0
  ds_read_b64_tr_b16 v[82:83], v15 offset:320
  ds_read_b64_tr_b16 v[84:85], v15 offset:32
  ds_read_b64_tr_b16 v[86:87], v15 offset:352
  v_pk_add_f32 v[64:65], v[64:65], v[68:69]
  v_pk_add_f32 v[66:67], v[66:67], v[70:71]
  v_add_f32 v64, v64, v65
  v_add_f32 v65, v66, v67
  s_nop 1
  v_permlane32_swap_b32 v64, v65
  v_add_f32 v64, v64, v65
  s_lshl_b32 s54, s44, 8
  s_add_u32 s54, s54, 132096
  v_lshl_add_u32 v66, v1, 2, s54
  ds_write_b32 v66, v64
  s_waitcnt lgkmcnt(1)
  buffer_store_dwordx4 v[80:83], v16, s[36:39], s6 offen sc1
  buffer_store_dwordx4 v[84:87], v16, s[36:39], s6 offen offset:1024 sc1
  s_waitcnt lgkmcnt(0)
  s_barrier
  s_cmp_lg_u32 s44, 0
  s_cbranch_scc1 L_osp_43
  v_lshlrev_b32 v66, 2, v1
  v_add_u32 v67, 132096, v66
  ds_read_b32 v68, v67 offset:0
  ds_read_b32 v69, v67 offset:256
  ds_read_b32 v70, v67 offset:512
  ds_read_b32 v71, v67 offset:768
  s_lshl_b32 s54, s50, 10
  s_add_u32 s54, s54, 196608
  s_lshl_b32 s55, s51, 8
  s_add_u32 s55, s55, s54
  s_waitcnt lgkmcnt(0)
  v_add_f32 v68, v68, v69
  v_add_f32 v70, v70, v71
  v_add_f32 v68, v68, v70
  buffer_store_dword v68, v66, s[36:39], s55 offen sc1
  s_sleep 8
L_spp_44:
  buffer_load_dword v72, v66, s[36:39], s54 offen offset:0 sc1
  buffer_load_dword v73, v66, s[36:39], s54 offen offset:256 sc1
  buffer_load_dword v74, v66, s[36:39], s54 offen offset:512 sc1
  buffer_load_dword v75, v66, s[36:39], s54 offen offset:768 sc1
  s_waitcnt vmcnt(0)
  v_max3_u32 v76, v72, v73, v74
  v_max_u32 v76, v76, v75
  v_cmp_eq_u32 vcc, -1, v76
  s_cbranch_vccz L_spk_45
  s_sleep 1
  s_sub_u32 s52, s52, 1
  s_cbranch_scc0 L_spp_44
  s_mov_b32 s52, 0
L_spk_45:
  v_add_f32 v72, v72, v73
  v_add_f32 v74, v74, v75
  v_add_f32 v72, v72, v74
  v_mov_b32 v73, v72
  s_nop 1
  v_permlane32_swap_b32 v72, v73
  v_mul_f32 v76, s80, v72
  v_mul_f32 v77, s80, v73
  v_fma_f32 v77, -v76, v76, v77
  v_max_f32 v77, 0, v77
  v_cvt_pk_bf16_f32 v76, v76, v77
  v_and_b32 v77, s76, v76
  v_lshlrev_b32 v74, 16, v76
  v_add_f32 v77, 0x3727c5ac, v77
  v_cvt_pk_bf16_f32 v77, v77, v77
  v_lshlrev_b32 v77, 16, v77
  v_sqrt_f32 v77, v77
  s_nop 0
  v_cvt_pk_bf16_f32 v77, v77, v77
  v_lshlrev_b32 v77, 16, v77
  v_rcp_f32 v75, v77
  v_and_b32 v67, 31, v1
  v_lshlrev_b32 v67, 3, v67
  v_add_u32 v67, 133120, v67
  ds_write_b64 v67, v[74:75]
L_osp_43:
  v_lshlrev_b32 v104, 16, v120
  v_and_b32 v105, s76, v120
  v_lshlrev_b32 v106, 16, v121
  v_and_b32 v107, s76, v121
  v_lshlrev_b32 v108, 16, v122
  v_and_b32 v109, s76, v122
  v_lshlrev_b32 v110, 16, v123
  v_and_b32 v111, s76, v123
  v_lshlrev_b32 v112, 16, v124
  v_and_b32 v113, s76, v124
  v_lshlrev_b32 v114, 16, v125
  v_and_b32 v115, s76, v125
  v_lshlrev_b32 v116, 16, v126
  v_and_b32 v117, s76, v126
  v_lshlrev_b32 v118, 16, v127
  v_and_b32 v119, s76, v127
  v_and_b32 v67, 31, v1
  v_lshlrev_b32 v67, 3, v67
  v_add_u32 v67, 133120, v67
  s_waitcnt lgkmcnt(0)
  s_barrier
  ds_read_b64 v[74:75], v67
  s_waitcnt lgkmcnt(0)
  v_pk_add_f32 v[104:105], v[104:105], v[74:75] op_sel_hi:[1,0] neg_lo:[0,1] neg_hi:[0,1]
  v_pk_add_f32 v[106:107], v[106:107], v[74:75] op_sel_hi:[1,0] neg_lo:[0,1] neg_hi:[0,1]
  v_pk_add_f32 v[108:109], v[108:109], v[74:75] op_sel_hi:[1,0] neg_lo:[0,1] neg_hi:[0,1]
  v_pk_add_f32 v[110:111], v[110:111], v[74:75] op_sel_hi:[1,0] neg_lo:[0,1] neg_hi:[0,1]
  v_pk_add_f32 v[112:113], v[112:113], v[74:75] op_sel_hi:[1,0] neg_lo:[0,1] neg_hi:[0,1]
  v_pk_add_f32 v[114:115], v[114:115], v[74:75] op_sel_hi:[1,0] neg_lo:[0,1] neg_hi:[0,1]
  v_pk_add_f32 v[116:117], v[116:117], v[74:75] op_sel_hi:[1,0] neg_lo:[0,1] neg_hi:[0,1]
  v_pk_add_f32 v[118:119], v[118:119], v[74:75] op_sel_hi:[1,0] neg_lo:[0,1] neg_hi:[0,1]
  v_cvt_pk_bf16_f32 v120, v104, v105
  v_cvt_pk_bf16_f32 v121, v106, v107
  v_cvt_pk_bf16_f32 v122, v108, v109
  v_cvt_pk_bf16_f32 v123, v110, v111
  v_cvt_pk_bf16_f32 v124, v112, v113
  v_cvt_pk_bf16_f32 v125, v114, v115
  v_cvt_pk_bf16_f32 v126, v116, v117
  v_cvt_pk_bf16_f32 v127, v118, v119
  v_lshlrev_b32 v104, 16, v120
  v_and_b32 v105, s76, v120
  v_lshlrev_b32 v106, 16, v121
  v_and_b32 v107, s76, v121
  v_lshlrev_b32 v108, 16, v122
  v_and_b32 v109, s76, v122
  v_lshlrev_b32 v110, 16, v123
  v_and_b32 v111, s76, v123
  v_lshlrev_b32 v112, 16, v124
  v_and_b32 v113, s76, v124
  v_lshlrev_b32 v114, 16, v125
  v_and_b32 v115, s76, v125
  v_lshlrev_b32 v116, 16, v126
  v_and_b32 v117, s76, v126
  v_lshlrev_b32 v118, 16, v127
  v_and_b32 v119, s76, v127
  v_pk_mul_f32 v[104:105], v[104:105], v[74:75] op_sel:[0,1] op_sel_hi:[1,1]
  v_pk_mul_f32 v[106:107], v[106:107], v[74:75] op_sel:[0,1] op_sel_hi:[1,1]
  v_pk_mul_f32 v[108:109], v[108:109], v[74:75] op_sel:[0,1] op_sel_hi:[1,1]
  v_pk_mul_f32 v[110:111], v[110:111], v[74:75] op_sel:[0,1] op_sel_hi:[1,1]
  v_pk_mul_f32 v[112:113], v[112:113], v[74:75] op_sel:[0,1] op_sel_hi:[1,1]
  v_pk_mul_f32 v[114:115], v[114:115], v[74:75] op_sel:[0,1] op_sel_hi:[1,1]
  v_pk_mul_f32 v[116:117], v[116:117], v[74:75] op_sel:[0,1] op_sel_hi:[1,1]
  v_pk_mul_f32 v[118:119], v[118:119], v[74:75] op_sel:[0,1] op_sel_hi:[1,1]
  v_cvt_pk_bf16_f32 v120, v104, v105
  v_cvt_pk_bf16_f32 v121, v106, v107
  v_cvt_pk_bf16_f32 v122, v108, v109
  v_cvt_pk_bf16_f32 v123, v110, v111
  v_cvt_pk_bf16_f32 v124, v112, v113
  v_cvt_pk_bf16_f32 v125, v114, v115
  v_cvt_pk_bf16_f32 v126, v116, v117
  v_cvt_pk_bf16_f32 v127, v118, v119
  ds_write_b128 v14, v[120:123] offset:10240
  ds_write_b128 v14, v[124:127] offset:10256
  s_add_u32 s7, s6, 11730944
  s_waitcnt lgkmcnt(0)
  ds_read_b64_tr_b16 v[88:89], v15 offset:10240
  ds_read_b64_tr_b16 v[90:91], v15 offset:10560
  ds_read_b64_tr_b16 v[92:93], v15 offset:10272
  ds_read_b64_tr_b16 v[94:95], v15 offset:10592
  s_waitcnt vmcnt(0) lgkmcnt(0)
  buffer_store_dwordx4 v[88:91], v16, s[36:39], s7 offen sc1
  buffer_store_dwordx4 v[92:95], v16, s[36:39], s7 offen offset:1024 sc1
  s_barrier
  s_lshr_b32 s4, s44, 1
  s_and_b32 s5, s44, 1
  v_and_b32 v10, 3, v1
  v_sub_u32 v10, 3, v10
  v_mul_u32_u24 v12, 4160, v10
  v_bfe_u32 v10, v1, 5, 1
  v_lshlrev_b32 v13, 5, v10
  v_sub_u32 v12, v12, v13
  v_bfe_u32 v11, v1, 4, 1
  v_lshl_add_u32 v12, v11, 4, v12
  v_bfe_u32 v10, v1, 2, 2
  v_lshlrev_b32 v10, 3, v10
  v_sub_u32 v12, v12, v10
  s_mul_i32 s56, s4, 16640
  s_lshl_b32 s57, s5, 8
  s_sub_u32 s56, s56, s57
  s_add_u32 s56, s56, 312
  v_and_b32 v10, 15, v1
  v_lshlrev_b32 v14, 5, v10
  v_sub_u32 v14, v14, v13
  v_lshl_add_u32 v14, v11, 4, v14
  s_mul_i32 s58, s4, 4608
  s_sub_u32 s58, s58, s57
  s_add_u32 s58, s58, 66880
  v_add_u32 v16, s56, v12
  v_add_u32 v17, s58, v14
  v_and_b32 v56, 15, v1
  v_lshlrev_b32 v56, 5, v56
  v_lshrrev_b32 v13, 4, v1
  v_lshl_add_u32 v56, v13, 3, v56
  s_lshl_b32 s56, s5, 11
  v_add_u32 v56, s56, v56
  s_mul_i32 s57, s4, 4608
  s_add_u32 s57, s57, 67072
  v_add_u32 v57, s57, v56
  s_lshl_b32 s57, s4, 12
  s_add_u32 s57, s57, 75776
  v_add_u32 v58, s57, v56
  s_lshl_b32 s56, s44, 12
  s_add_u32 s56, s56, 83968
  v_lshl_add_u32 v59, v1, 4, s56
  s_xor_b32 s56, s44, 1
  s_lshl_b32 s56, s56, 12
  s_add_u32 s56, s56, 83968
  v_lshl_add_u32 v60, v1, 4, s56
  s_lshl_b32 s6, s47, 1
  s_add_u32 s6, s6, s4
  s_mul_i32 s6, s6, 4224
  s_add_u32 s6, s6, 7077888
  v_lshlrev_b32 v10, 4, v0
  v_add_u32 v61, 67072, v10
  v_add_u32 v62, 75776, v10
  v_lshlrev_b32 v63, 4, v0
  s_cmp_lg_u32 s44, 1
  s_cbranch_scc1 L_zp_46
  v_lshrrev_b32 v11, 5, v1
  v_mul_u32_u24 v11, 4608, v11
  v_and_b32 v12, 31, v1
  v_lshl_add_u32 v11, v12, 4, v11
  v_add_u32 v11, 66560, v11
  v_mov_b32 v12, 0
  v_mov_b32 v13, 0
  v_mov_b32 v14, 0
  v_mov_b32 v15, 0
  ds_write_b128 v11, v[12:15]
L_zp_46:
  s_lshl_b32 s7, s47, 7
  s_add_u32 s7, s7, 9306112
  v_lshrrev_b32 v19, 2, v0
  v_mul_u32_u24 v19, 33024, v19
  v_and_b32 v10, 3, v0
  v_lshl_add_u32 v19, v10, 4, v19
  s_sleep 8
  s_add_u32 s54, s7, 11730944
L_cu_47:
  buffer_load_dwordx4 v[48:51], v19, s[36:39], s54 offen sc1
  buffer_load_dwordx4 v[52:55], v19, s[36:39], s54 offen offset:64 sc1
  s_waitcnt vmcnt(0)
  v_max_u32 v10, v48, v52
  v_cmp_eq_u32 vcc, -1, v10
  s_cbranch_vccz L_cuk_48
  s_sleep 2
  s_sub_u32 s52, s52, 1
  s_cbranch_scc0 L_cu_47
  s_mov_b32 s52, 0
L_cuk_48:
  ds_write_b128 v61, v[48:51] offset:0
  ds_write_b128 v61, v[52:55] offset:4608
  s_lshl_b32 s56, s44, 10
  s_add_u32 m0, s56, 75776
  s_add_u32 s57, s7, 0
  buffer_load_dwordx4 v19, s[36:39], s57 offen sc1 lds
  s_lshl_b32 s56, s44, 10
  s_add_u32 m0, s56, 79872
  s_add_u32 s57, s7, 64
  buffer_load_dwordx4 v19, s[36:39], s57 offen sc1 lds
  s_waitcnt lgkmcnt(0)
  s_barrier
  ds_read_b128 v[96:99], v17 offset:192
  ds_read_b64 v[64:65], v16 offset:3776
  ds_read_b64 v[66:67], v16 offset:3784
  ds_read_b128 v[100:103], v17 offset:704
  ds_read_b64 v[68:69], v16 offset:3264
  ds_read_b64 v[70:71], v16 offset:3272
  ds_read_b128 v[104:107], v17 offset:1216
  ds_read_b64 v[72:73], v16 offset:2752
  ds_read_b64 v[74:75], v16 offset:2760
  ds_read_b128 v[108:111], v17 offset:1728
  ds_read_b64 v[76:77], v16 offset:2240
  ds_read_b64 v[78:79], v16 offset:2248
  ds_read_b128 v[112:115], v17 offset:2240
  ds_read_b64 v[80:81], v16 offset:1728
  ds_read_b64 v[82:83], v16 offset:1736
  ds_read_b128 v[116:119], v17 offset:2752
  ds_read_b64 v[84:85], v16 offset:1216
  ds_read_b64 v[86:87], v16 offset:1224
  ds_read_b128 v[120:123], v17 offset:3264
  ds_read_b64 v[88:89], v16 offset:704
  ds_read_b64 v[90:91], v16 offset:712
  ds_read_b128 v[124:127], v17 offset:3776
  ds_read_b64 v[92:93], v16 offset:192
  ds_read_b64 v[94:95], v16 offset:200
  s_mov_b32 s58, s53
  s_mov_b32 s59, s53
  s_waitcnt lgkmcnt(15)
  v_mfma_f32_16x16x32_bf16 v[24:27], v[64:67], v[96:99], 0
  s_waitcnt lgkmcnt(15)
  v_mfma_f32_16x16x32_bf16 v[28:31], v[64:67], v[100:103], 0
  v_mfma_f32_16x16x32_bf16 v[28:31], v[68:71], v[96:99], v[28:31]
  v_mov_b32 v20, -1
  s_waitcnt lgkmcnt(15)
  v_mfma_f32_16x16x32_bf16 v[32:35], v[64:67], v[104:107], 0
  v_mov_b32 v21, -1
  v_mfma_f32_16x16x32_bf16 v[32:35], v[68:71], v[100:103], v[32:35]
  v_mov_b32 v22, -1
  v_mfma_f32_16x16x32_bf16 v[32:35], v[72:75], v[96:99], v[32:35]
  v_mov_b32 v23, -1
  s_waitcnt lgkmcnt(12)
  v_mfma_f32_16x16x32_bf16 v[36:39], v[64:67], v[108:111], 0
  ds_read_b128 v[160:163], v17 offset:128
  s_lshl_b32 s40, s49, 2
  v_mfma_f32_16x16x32_bf16 v[36:39], v[68:71], v[104:107], v[36:39]
  ds_read_b64 v[128:129], v16 offset:3712
  s_add_u32 s40, s40, s44
  v_mfma_f32_16x16x32_bf16 v[36:39], v[72:75], v[100:103], v[36:39]
  ds_read_b64 v[130:131], v16 offset:3720
  s_mul_i32 s40, s40, 65792
  v_mfma_f32_16x16x32_bf16 v[36:39], v[76:79], v[96:99], v[36:39]
  ds_read_b128 v[164:167], v17 offset:640
  s_lshl_b32 s61, s48, 11
  s_waitcnt lgkmcnt(13)
  v_mfma_f32_16x16x32_bf16 v[40:43], v[64:67], v[112:115], 0
  ds_read_b64 v[132:133], v16 offset:3200
  s_add_u32 s40, s40, s61
  v_mfma_f32_16x16x32_bf16 v[40:43], v[68:71], v[108:111], v[40:43]
  ds_read_b64 v[134:135], v16 offset:3208
  s_add_u32 s40, s40, 13697024
  v_mfma_f32_16x16x32_bf16 v[40:43], v[72:75], v[104:107], v[40:43]
  ds_read_b128 v[168:171], v17 offset:1152
  s_lshl_b32 s41, s49, 5
  v_mfma_f32_16x16x32_bf16 v[40:43], v[76:79], v[100:103], v[40:43]
  ds_read_b64 v[136:137], v16 offset:2688
  s_add_u32 s41, s41, s48
  v_mfma_f32_16x16x32_bf16 v[40:43], v[80:83], v[96:99], v[40:43]
  ds_read_b64 v[138:139], v16 offset:2696
  s_lshl_b32 s41, s41, 2
  s_waitcnt lgkmcnt(15)
  v_mfma_f32_16x16x32_bf16 v[44:47], v[64:67], v[116:119], 0
  ds_read_b128 v[172:175], v17 offset:1664
  s_add_u32 s41, s41, s44
  v_mfma_f32_16x16x32_bf16 v[44:47], v[68:71], v[112:115], v[44:47]
  ds_read_b64 v[140:141], v16 offset:2176
  s_mul_i32 s41, s41, 1152
  v_mfma_f32_16x16x32_bf16 v[44:47], v[72:75], v[108:111], v[44:47]
  ds_read_b64 v[142:143], v16 offset:2184
  s_add_u32 s41, s41, 1474560
  v_mfma_f32_16x16x32_bf16 v[44:47], v[76:79], v[104:107], v[44:47]
  ds_read_b128 v[176:179], v17 offset:2176
  s_lshr_b32 s42, s48, 3
  v_mfma_f32_16x16x32_bf16 v[44:47], v[80:83], v[100:103], v[44:47]
  ds_read_b64 v[144:145], v16 offset:1664
  s_lshl_b32 s61, s49, 2
  v_mfma_f32_16x16x32_bf16 v[44:47], v[84:87], v[96:99], v[44:47]
  ds_read_b64 v[146:147], v16 offset:1672
  s_add_u32 s42, s42, s61
  s_waitcnt lgkmcnt(15)
  v_mfma_f32_16x16x32_bf16 v[48:51], v[64:67], v[120:123], 0
  ds_read_b128 v[180:183], v17 offset:2688
  s_mul_i32 s42, s42, 640
  v_mfma_f32_16x16x32_bf16 v[48:51], v[68:71], v[116:119], v[48:51]
  ds_read_b64 v[148:149], v16 offset:1152
  s_add_u32 s42, s42, 18087936
  v_mfma_f32_16x16x32_bf16 v[48:51], v[72:75], v[112:115], v[48:51]
  ds_read_b64 v[150:151], v16 offset:1160
  v_lshlrev_b32 v61, 4, v1
  v_mfma_f32_16x16x32_bf16 v[48:51], v[76:79], v[108:111], v[48:51]
  ds_read_b128 v[184:187], v17 offset:3200
  v_lshlrev_b32 v62, 2, v1
  v_mfma_f32_16x16x32_bf16 v[48:51], v[80:83], v[104:107], v[48:51]
  ds_read_b64 v[152:153], v16 offset:640
  buffer_store_dwordx4 v[20:23], v61, s[36:39], s41 offen sc1
  v_mfma_f32_16x16x32_bf16 v[48:51], v[84:87], v[100:103], v[48:51]
  ds_read_b64 v[154:155], v16 offset:648
  v_mfma_f32_16x16x32_bf16 v[48:51], v[88:91], v[96:99], v[48:51]
  ds_read_b128 v[188:191], v17 offset:3712
  s_waitcnt lgkmcnt(15)
  v_mfma_f32_16x16x32_bf16 v[52:55], v[64:67], v[124:127], 0
  ds_read_b64 v[156:157], v16 offset:128
  v_mfma_f32_16x16x32_bf16 v[52:55], v[68:71], v[120:123], v[52:55]
  ds_read_b64 v[158:159], v16 offset:136
  v_mfma_f32_16x16x32_bf16 v[52:55], v[72:75], v[116:119], v[52:55]
  v_mfma_f32_16x16x32_bf16 v[52:55], v[76:79], v[112:115], v[52:55]
  s_mov_b32 s62, -1
  s_mov_b32 s63, 0
  s_mov_b64 exec, s[62:63]
  buffer_store_dword v20, v62, s[36:39], s41 offen offset:1024 sc1
  s_mov_b64 exec, -1
  v_mfma_f32_16x16x32_bf16 v[52:55], v[80:83], v[108:111], v[52:55]
  v_mfma_f32_16x16x32_bf16 v[52:55], v[84:87], v[104:107], v[52:55]
  v_mfma_f32_16x16x32_bf16 v[52:55], v[88:91], v[100:103], v[52:55]
  v_mfma_f32_16x16x32_bf16 v[52:55], v[92:95], v[96:99], v[52:55]
  s_waitcnt lgkmcnt(0)
  v_mfma_f32_16x16x32_bf16 v[24:27], v[128:131], v[160:163], v[24:27]
  ds_read_b128 v[96:99], v17 offset:64
  v_mfma_f32_16x16x32_bf16 v[28:31], v[128:131], v[164:167], v[28:31]
  ds_read_b64 v[64:65], v16 offset:3648
  buffer_store_dwordx4 v[20:23], v61, s[36:39], s40 offen sc1
  v_mfma_f32_16x16x32_bf16 v[28:31], v[132:135], v[160:163], v[28:31]
  ds_read_b64 v[66:67], v16 offset:3656
  v_mfma_f32_16x16x32_bf16 v[32:35], v[128:131], v[168:171], v[32:35]
  ds_read_b128 v[100:103], v17 offset:576
  v_mfma_f32_16x16x32_bf16 v[32:35], v[132:135], v[164:167], v[32:35]
  ds_read_b64 v[68:69], v16 offset:3136
  v_mfma_f32_16x16x32_bf16 v[32:35], v[136:139], v[160:163], v[32:35]
  ds_read_b64 v[70:71], v16 offset:3144
  v_mfma_f32_16x16x32_bf16 v[36:39], v[128:131], v[172:175], v[36:39]
  ds_read_b128 v[104:107], v17 offset:1088
  v_mfma_f32_16x16x32_bf16 v[36:39], v[132:135], v[168:171], v[36:39]
  ds_read_b64 v[72:73], v16 offset:2624
  buffer_store_dwordx4 v[20:23], v61, s[36:39], s40 offen offset:1024 sc1
  v_mfma_f32_16x16x32_bf16 v[36:39], v[136:139], v[164:167], v[36:39]
  ds_read_b64 v[74:75], v16 offset:2632
  v_mfma_f32_16x16x32_bf16 v[36:39], v[140:143], v[160:163], v[36:39]
  ds_read_b128 v[108:111], v17 offset:1600
  v_mfma_f32_16x16x32_bf16 v[40:43], v[128:131], v[176:179], v[40:43]
  ds_read_b64 v[76:77], v16 offset:2112
  v_mfma_f32_16x16x32_bf16 v[40:43], v[132:135], v[172:175], v[40:43]
  ds_read_b64 v[78:79], v16 offset:2120
  v_mfma_f32_16x16x32_bf16 v[40:43], v[136:139], v[168:171], v[40:43]
  ds_read_b128 v[112:115], v17 offset:2112
  v_mfma_f32_16x16x32_bf16 v[40:43], v[140:143], v[164:167], v[40:43]
  ds_read_b64 v[80:81], v16 offset:1600
  s_cmp_lg_u32 s44, 2
  s_cbranch_scc1 L_ff_49
  s_and_b32 s61, s48, 7
  s_lshl_b32 s62, s61, 6
  v_lshrrev_b32 v61, 3, v1
  v_mul_u32_u24 v61, 20608, v61
  v_and_b32 v62, 7, v1
  v_lshl_add_u32 v61, v62, 3, v61
  v_add_u32 v62, s62, v61
  buffer_store_dwordx2 v[20:21], v62, s[36:39], s42 offen sc1
  s_cmp_lg_u32 s61, 0
  s_cbranch_scc1 L_ff_49
  s_mov_b32 s62, 0x0f0f0f0f
  s_mov_b32 s63, 0x0f0f0f0f
  s_mov_b64 exec, s[62:63]
  buffer_store_dwordx2 v[20:21], v61, s[36:39], s42 offen offset:512 sc1
  s_mov_b64 exec, -1
L_ff_49:
  v_mfma_f32_16x16x32_bf16 v[40:43], v[144:147], v[160:163], v[40:43]
  ds_read_b64 v[82:83], v16 offset:1608
  v_mfma_f32_16x16x32_bf16 v[44:47], v[128:131], v[180:183], v[44:47]
  ds_read_b128 v[116:119], v17 offset:2624
  v_mfma_f32_16x16x32_bf16 v[44:47], v[132:135], v[176:179], v[44:47]
  ds_read_b64 v[84:85], v16 offset:1088
  v_mfma_f32_16x16x32_bf16 v[44:47], v[136:139], v[172:175], v[44:47]
  ds_read_b64 v[86:87], v16 offset:1096
  v_mfma_f32_16x16x32_bf16 v[44:47], v[140:143], v[168:171], v[44:47]
  ds_read_b128 v[120:123], v17 offset:3136
  v_mfma_f32_16x16x32_bf16 v[44:47], v[144:147], v[164:167], v[44:47]
  ds_read_b64 v[88:89], v16 offset:576
  v_mfma_f32_16x16x32_bf16 v[44:47], v[148:151], v[160:163], v[44:47]
  ds_read_b64 v[90:91], v16 offset:584
  v_mfma_f32_16x16x32_bf16 v[48:51], v[128:131], v[184:187], v[48:51]
  ds_read_b128 v[124:127], v17 offset:3648
  v_mfma_f32_16x16x32_bf16 v[48:51], v[132:135], v[180:183], v[48:51]
  ds_read_b64 v[92:93], v16 offset:64
  v_mfma_f32_16x16x32_bf16 v[48:51], v[136:139], v[176:179], v[48:51]
  ds_read_b64 v[94:95], v16 offset:72
  v_mfma_f32_16x16x32_bf16 v[48:51], v[140:143], v[172:175], v[48:51]
  v_mfma_f32_16x16x32_bf16 v[48:51], v[144:147], v[168:171], v[48:51]
  v_mfma_f32_16x16x32_bf16 v[48:51], v[148:151], v[164:167], v[48:51]
  v_mfma_f32_16x16x32_bf16 v[48:51], v[152:155], v[160:163], v[48:51]
  v_mfma_f32_16x16x32_bf16 v[52:55], v[128:131], v[188:191], v[52:55]
  v_mfma_f32_16x16x32_bf16 v[52:55], v[132:135], v[184:187], v[52:55]
  v_mfma_f32_16x16x32_bf16 v[52:55], v[136:139], v[180:183], v[52:55]
  v_mfma_f32_16x16x32_bf16 v[52:55], v[140:143], v[176:179], v[52:55]
  v_mfma_f32_16x16x32_bf16 v[52:55], v[144:147], v[172:175], v[52:55]
  v_mfma_f32_16x16x32_bf16 v[52:55], v[148:151], v[168:171], v[52:55]
  v_mfma_f32_16x16x32_bf16 v[52:55], v[152:155], v[164:167], v[52:55]
  v_mfma_f32_16x16x32_bf16 v[52:55], v[156:159], v[160:163], v[52:55]
  s_waitcnt lgkmcnt(0)
  s_waitcnt vmcnt(0)
  s_barrier
  v_mfma_f32_16x16x32_bf16 v[24:27], v[64:67], v[96:99], v[24:27]
  ds_read_b128 v[160:163], v17 offset:0
  v_mfma_f32_16x16x32_bf16 v[28:31], v[64:67], v[100:103], v[28:31]
  ds_read_b64 v[128:129], v16 offset:3584
  v_mfma_f32_16x16x32_bf16 v[28:31], v[68:71], v[96:99], v[28:31]
  ds_read_b64 v[130:131], v16 offset:3592
  v_mfma_f32_16x16x32_bf16 v[32:35], v[64:67], v[104:107], v[32:35]
  ds_read_b128 v[164:167], v17 offset:512
  v_mfma_f32_16x16x32_bf16 v[32:35], v[68:71], v[100:103], v[32:35]
  ds_read_b64 v[132:133], v16 offset:3072
  v_mfma_f32_16x16x32_bf16 v[32:35], v[72:75], v[96:99], v[32:35]
  ds_read_b64 v[134:135], v16 offset:3080
  v_mfma_f32_16x16x32_bf16 v[36:39], v[64:67], v[108:111], v[36:39]
  ds_read_b128 v[168:171], v17 offset:1024
  v_mfma_f32_16x16x32_bf16 v[36:39], v[68:71], v[104:107], v[36:39]
  ds_read_b64 v[136:137], v16 offset:2560
  v_mfma_f32_16x16x32_bf16 v[36:39], v[72:75], v[100:103], v[36:39]
  ds_read_b64 v[138:139], v16 offset:2568
  v_mfma_f32_16x16x32_bf16 v[36:39], v[76:79], v[96:99], v[36:39]
  ds_read_b128 v[172:175], v17 offset:1536
  v_mfma_f32_16x16x32_bf16 v[40:43], v[64:67], v[112:115], v[40:43]
  ds_read_b64 v[140:141], v16 offset:2048
  v_mfma_f32_16x16x32_bf16 v[40:43], v[68:71], v[108:111], v[40:43]
  ds_read_b64 v[142:143], v16 offset:2056
  v_mfma_f32_16x16x32_bf16 v[40:43], v[72:75], v[104:107], v[40:43]
  ds_read_b128 v[176:179], v17 offset:2048
  v_mfma_f32_16x16x32_bf16 v[40:43], v[76:79], v[100:103], v[40:43]
  ds_read_b64 v[144:145], v16 offset:1536
  v_mfma_f32_16x16x32_bf16 v[40:43], v[80:83], v[96:99], v[40:43]
  ds_read_b64 v[146:147], v16 offset:1544
  v_mfma_f32_16x16x32_bf16 v[44:47], v[64:67], v[116:119], v[44:47]
  ds_read_b128 v[180:183], v17 offset:2560
  v_mfma_f32_16x16x32_bf16 v[44:47], v[68:71], v[112:115], v[44:47]
  ds_read_b64 v[148:149], v16 offset:1024
  v_mfma_f32_16x16x32_bf16 v[44:47], v[72:75], v[108:111], v[44:47]
  ds_read_b64 v[150:151], v16 offset:1032
  v_mfma_f32_16x16x32_bf16 v[44:47], v[76:79], v[104:107], v[44:47]
  ds_read_b128 v[184:187], v17 offset:3072
  v_mfma_f32_16x16x32_bf16 v[44:47], v[80:83], v[100:103], v[44:47]
  ds_read_b64 v[152:153], v16 offset:512
  v_mfma_f32_16x16x32_bf16 v[44:47], v[84:87], v[96:99], v[44:47]
  ds_read_b64 v[154:155], v16 offset:520
  v_mfma_f32_16x16x32_bf16 v[48:51], v[64:67], v[120:123], v[48:51]
  ds_read_b128 v[188:191], v17 offset:3584
  v_mfma_f32_16x16x32_bf16 v[48:51], v[68:71], v[116:119], v[48:51]
  ds_read_b64 v[156:157], v16 offset:0
  v_mfma_f32_16x16x32_bf16 v[48:51], v[72:75], v[112:115], v[48:51]
  ds_read_b64 v[158:159], v16 offset:8
  v_mfma_f32_16x16x32_bf16 v[48:51], v[76:79], v[108:111], v[48:51]
  v_mfma_f32_16x16x32_bf16 v[48:51], v[80:83], v[104:107], v[48:51]
  v_mfma_f32_16x16x32_bf16 v[48:51], v[84:87], v[100:103], v[48:51]
  v_mfma_f32_16x16x32_bf16 v[48:51], v[88:91], v[96:99], v[48:51]
  v_mfma_f32_16x16x32_bf16 v[52:55], v[64:67], v[124:127], v[52:55]
  v_mfma_f32_16x16x32_bf16 v[52:55], v[68:71], v[120:123], v[52:55]
  v_mfma_f32_16x16x32_bf16 v[52:55], v[72:75], v[116:119], v[52:55]
  v_mfma_f32_16x16x32_bf16 v[52:55], v[76:79], v[112:115], v[52:55]
  v_mfma_f32_16x16x32_bf16 v[52:55], v[80:83], v[108:111], v[52:55]
  v_mfma_f32_16x16x32_bf16 v[52:55], v[84:87], v[104:107], v[52:55]
  v_mfma_f32_16x16x32_bf16 v[52:55], v[88:91], v[100:103], v[52:55]
  v_mfma_f32_16x16x32_bf16 v[52:55], v[92:95], v[96:99], v[52:55]
  s_waitcnt lgkmcnt(0)
  v_mfma_f32_16x16x32_bf16 v[24:27], v[128:131], v[160:163], v[24:27]
  ds_read_b64 v[64:65], v57 offset:0
  v_mfma_f32_16x16x32_bf16 v[28:31], v[128:131], v[164:167], v[28:31]
  ds_read_b64 v[72:73], v58 offset:0
  v_mfma_f32_16x16x32_bf16 v[28:31], v[132:135], v[160:163], v[28:31]
  ds_read_b64 v[66:67], v57 offset:512
  v_mfma_f32_16x16x32_bf16 v[32:35], v[128:131], v[168:171], v[32:35]
  ds_read_b64 v[74:75], v58 offset:512
  v_mfma_f32_16x16x32_bf16 v[32:35], v[132:135], v[164:167], v[32:35]
  ds_read_b64 v[68:69], v57 offset:1024
  v_mfma_f32_16x16x32_bf16 v[32:35], v[136:139], v[160:163], v[32:35]
  ds_read_b64 v[76:77], v58 offset:1024
  v_mfma_f32_16x16x32_bf16 v[36:39], v[128:131], v[172:175], v[36:39]
  ds_read_b64 v[70:71], v57 offset:1536
  v_mfma_f32_16x16x32_bf16 v[36:39], v[132:135], v[168:171], v[36:39]
  ds_read_b64 v[78:79], v58 offset:1536
  v_mfma_f32_16x16x32_bf16 v[36:39], v[136:139], v[164:167], v[36:39]
  v_mfma_f32_16x16x32_bf16 v[36:39], v[140:143], v[160:163], v[36:39]
  v_mfma_f32_16x16x32_bf16 v[40:43], v[128:131], v[176:179], v[40:43]
  v_mfma_f32_16x16x32_bf16 v[40:43], v[132:135], v[172:175], v[40:43]
  v_mfma_f32_16x16x32_bf16 v[40:43], v[136:139], v[168:171], v[40:43]
  s_waitcnt lgkmcnt(0)
  v_lshlrev_b32 v96, 16, v64
  v_mfma_f32_16x16x32_bf16 v[40:43], v[140:143], v[164:167], v[40:43]
  v_and_b32 v97, s76, v64
  v_lshlrev_b32 v112, 16, v72
  v_mfma_f32_16x16x32_bf16 v[40:43], v[144:147], v[160:163], v[40:43]
  v_and_b32 v113, s76, v72
  v_lshlrev_b32 v98, 16, v65
  v_mfma_f32_16x16x32_bf16 v[44:47], v[128:131], v[180:183], v[44:47]
  v_and_b32 v99, s76, v65
  v_lshlrev_b32 v114, 16, v73
  v_mfma_f32_16x16x32_bf16 v[44:47], v[132:135], v[176:179], v[44:47]
  v_and_b32 v115, s76, v73
  v_lshlrev_b32 v100, 16, v66
  v_mfma_f32_16x16x32_bf16 v[44:47], v[136:139], v[172:175], v[44:47]
  v_and_b32 v101, s76, v66
  v_lshlrev_b32 v116, 16, v74
  v_mfma_f32_16x16x32_bf16 v[44:47], v[140:143], v[168:171], v[44:47]
  v_and_b32 v117, s76, v74
  v_lshlrev_b32 v102, 16, v67
  v_mfma_f32_16x16x32_bf16 v[44:47], v[144:147], v[164:167], v[44:47]
  v_and_b32 v103, s76, v67
  v_lshlrev_b32 v118, 16, v75
  v_mfma_f32_16x16x32_bf16 v[44:47], v[148:151], v[160:163], v[44:47]
  v_and_b32 v119, s76, v75
  v_lshlrev_b32 v104, 16, v68
  v_mfma_f32_16x16x32_bf16 v[48:51], v[128:131], v[184:187], v[48:51]
  v_and_b32 v105, s76, v68
  v_lshlrev_b32 v120, 16, v76
  v_mfma_f32_16x16x32_bf16 v[48:51], v[132:135], v[180:183], v[48:51]
  v_and_b32 v121, s76, v76
  v_lshlrev_b32 v106, 16, v69
  v_mfma_f32_16x16x32_bf16 v[48:51], v[136:139], v[176:179], v[48:51]
  v_and_b32 v107, s76, v69
  v_lshlrev_b32 v122, 16, v77
  v_mfma_f32_16x16x32_bf16 v[48:51], v[140:143], v[172:175], v[48:51]
  v_and_b32 v123, s76, v77
  v_lshlrev_b32 v108, 16, v70
  v_mfma_f32_16x16x32_bf16 v[48:51], v[144:147], v[168:171], v[48:51]
  v_and_b32 v109, s76, v70
  v_lshlrev_b32 v124, 16, v78
  v_mfma_f32_16x16x32_bf16 v[48:51], v[148:151], v[164:167], v[48:51]
  v_and_b32 v125, s76, v78
  v_lshlrev_b32 v110, 16, v71
  v_mfma_f32_16x16x32_bf16 v[48:51], v[152:155], v[160:163], v[48:51]
  v_and_b32 v111, s76, v71
  v_lshlrev_b32 v126, 16, v79
  v_mfma_f32_16x16x32_bf16 v[52:55], v[128:131], v[188:191], v[52:55]
  v_and_b32 v127, s76, v79
  v_pk_fma_f32 v[96:97], v[96:97], s[58:59], v[112:113]
  v_mfma_f32_16x16x32_bf16 v[52:55], v[132:135], v[184:187], v[52:55]
  v_pk_fma_f32 v[98:99], v[98:99], s[58:59], v[114:115]
  v_pk_fma_f32 v[100:101], v[100:101], s[58:59], v[116:117]
  v_mfma_f32_16x16x32_bf16 v[52:55], v[136:139], v[180:183], v[52:55]
  v_pk_fma_f32 v[102:103], v[102:103], s[58:59], v[118:119]
  v_pk_fma_f32 v[104:105], v[104:105], s[58:59], v[120:121]
  v_mfma_f32_16x16x32_bf16 v[52:55], v[140:143], v[176:179], v[52:55]
  v_pk_fma_f32 v[106:107], v[106:107], s[58:59], v[122:123]
  v_pk_fma_f32 v[108:109], v[108:109], s[58:59], v[124:125]
  v_mfma_f32_16x16x32_bf16 v[52:55], v[144:147], v[172:175], v[52:55]
  v_pk_fma_f32 v[110:111], v[110:111], s[58:59], v[126:127]
  v_mfma_f32_16x16x32_bf16 v[52:55], v[148:151], v[168:171], v[52:55]
  v_mfma_f32_16x16x32_bf16 v[52:55], v[152:155], v[164:167], v[52:55]
  v_mfma_f32_16x16x32_bf16 v[52:55], v[156:159], v[160:163], v[52:55]
  s_cmp_eq_u32 s5, 1
  s_cbranch_scc1 L_p1_50
  s_nop 3
  ds_write_b128 v59, v[40:43] offset:0
  ds_write_b128 v59, v[44:47] offset:1024
  ds_write_b128 v59, v[48:51] offset:2048
  ds_write_b128 v59, v[52:55] offset:3072
  s_branch L_pj_51
L_p1_50:
  ds_write_b128 v59, v[24:27] offset:0
  ds_write_b128 v59, v[28:31] offset:1024
  ds_write_b128 v59, v[32:35] offset:2048
  ds_write_b128 v59, v[36:39] offset:3072
  s_nop 3
  v_mov_b64 v[24:25], v[40:41]
  v_mov_b64 v[26:27], v[42:43]
  v_mov_b64 v[28:29], v[44:45]
  v_mov_b64 v[30:31], v[46:47]
  v_mov_b64 v[32:33], v[48:49]
  v_mov_b64 v[34:35], v[50:51]
  v_mov_b64 v[36:37], v[52:53]
  v_mov_b64 v[38:39], v[54:55]
L_pj_51:
  v_pk_add_f32 v[96:97], v[96:97], v[24:25]
  v_pk_add_f32 v[98:99], v[98:99], v[26:27]
  v_pk_add_f32 v[100:101], v[100:101], v[28:29]
  v_pk_add_f32 v[102:103], v[102:103], v[30:31]
  v_pk_add_f32 v[104:105], v[104:105], v[32:33]
  v_pk_add_f32 v[106:107], v[106:107], v[34:35]
  v_pk_add_f32 v[108:109], v[108:109], v[36:37]
  v_pk_add_f32 v[110:111], v[110:111], v[38:39]
  s_waitcnt lgkmcnt(0)
  s_barrier
  ds_read_b128 v[80:83], v60 offset:0
  ds_read_b128 v[84:87], v60 offset:1024
  ds_read_b128 v[88:91], v60 offset:2048
  ds_read_b128 v[92:95], v60 offset:3072
  s_waitcnt vmcnt(0)
  s_waitcnt lgkmcnt(3)
  v_pk_add_f32 v[96:97], v[96:97], v[80:81]
  v_pk_add_f32 v[98:99], v[98:99], v[82:83]
  v_cvt_pk_bf16_f32 v64, v96, v97
  v_cvt_pk_bf16_f32 v65, v98, v99
  buffer_store_dwordx2 v[64:65], v56, s[36:39], s6 offen offset:0 sc1
  s_waitcnt lgkmcnt(2)
  v_pk_add_f32 v[100:101], v[100:101], v[84:85]
  v_pk_add_f32 v[102:103], v[102:103], v[86:87]
  v_cvt_pk_bf16_f32 v66, v100, v101
  v_cvt_pk_bf16_f32 v67, v102, v103
  buffer_store_dwordx2 v[66:67], v56, s[36:39], s6 offen offset:512 sc1
  s_waitcnt lgkmcnt(1)
  v_pk_add_f32 v[104:105], v[104:105], v[88:89]
  v_pk_add_f32 v[106:107], v[106:107], v[90:91]
  v_cvt_pk_bf16_f32 v68, v104, v105
  v_cvt_pk_bf16_f32 v69, v106, v107
  buffer_store_dwordx2 v[68:69], v56, s[36:39], s6 offen offset:1024 sc1
  s_waitcnt lgkmcnt(0)
  v_pk_add_f32 v[108:109], v[108:109], v[92:93]
  v_pk_add_f32 v[110:111], v[110:111], v[94:95]
  v_cvt_pk_bf16_f32 v70, v108, v109
  v_cvt_pk_bf16_f32 v71, v110, v111
  buffer_store_dwordx2 v[70:71], v56, s[36:39], s6 offen offset:1536 sc1
  v_lshrrev_b32 v10, 3, v1
  v_mul_u32_u24 v10, 4224, v10
  v_bfe_u32 v11, v1, 4, 2
  v_lshlrev_b32 v11, 1, v11
  v_and_b32 v16, 7, v1
  v_xor_b32 v11, v11, v16
  v_lshl_add_u32 v10, v11, 4, v10
  s_lshl_b32 s54, s48, 7
  v_add_u32 v19, s54, v10
  s_mul_i32 s4, s44, 135168
  s_add_u32 s4, s4, 7077888
  s_lshl_b32 s5, s44, 12
  s_add_u32 s5, s5, 66560
  v_lshrrev_b32 v10, 2, v1
  v_lshlrev_b32 v10, 7, v10
  v_and_b32 v11, 3, v1
  v_lshl_add_u32 v10, v11, 3, v10
  v_add_u32 v10, 66560, v10
  v_bfe_u32 v11, v1, 3, 2
  s_add_u32 s54, s44, 0
  s_and_b32 s54, s54, 3
  s_lshl_b32 s68, s54, 6
  v_xor_b32 v16, s54, v11
  v_lshl_add_u32 v12, v16, 5, v10
  s_add_u32 s54, s44, 1
  s_and_b32 s54, s54, 3
  s_lshl_b32 s69, s54, 6
  v_xor_b32 v16, s54, v11
  v_lshl_add_u32 v13, v16, 5, v10
  s_add_u32 s54, s44, 2
  s_and_b32 s54, s54, 3
  s_lshl_b32 s70, s54, 6
  v_xor_b32 v16, s54, v11
  v_lshl_add_u32 v14, v16, 5, v10
  s_add_u32 s54, s44, 3
  s_and_b32 s54, s54, 3
  s_lshl_b32 s71, s54, 6
  v_xor_b32 v16, s54, v11
  v_lshl_add_u32 v15, v16, 5, v10
  v_mov_b32 v152, 0x3f803f80
  v_mov_b32 v153, 0x3f803f80
  v_mov_b32 v154, 0x3f803f80
  v_mov_b32 v155, 0x3f803f80
  v_lshrrev_b32 v11, 5, v1
  v_lshlrev_b32 v11, 4, v11
  v_bfe_u32 v16, v1, 2, 2
  v_add_u32 v11, v11, v16
  s_lshl_b32 s54, s51, 7
  s_lshl_b32 s55, s44, 5
  s_add_u32 s54, s54, s55
  v_add_u32 v11, s54, v11
  v_lshlrev_b32 v11, 7, v11
  v_and_b32 v16, 3, v1
  v_lshl_add_u32 v11, v16, 3, v11
  v_add_u32 v11, 66560, v11
  s_and_b32 s54, s49, 1
  s_lshl_b32 s54, s54, 1
  v_bfe_u32 v16, v1, 4, 1
  v_add_u32 v16, s54, v16
  v_bfe_u32 v17, v1, 3, 1
  v_xor_b32 v16, v16, v17
  v_lshl_add_u32 v156, v16, 5, v11
  v_xor_b32 v16, 2, v16
  v_lshl_add_u32 v157, v16, 5, v11
  v_and_b32 v10, 15, v1
  v_lshlrev_b32 v10, 2, v10
  v_add_u32 v11, 132096, v10
  s_lshl_b32 s54, s44, 6
  v_add_u32 v158, s54, v11
  v_lshrrev_b32 v10, 4, v1
  v_lshlrev_b32 v10, 4, v10
  v_add_u32 v10, 132096, v10
  v_add_u32 v160, s68, v10
  v_add_u32 v164, s68, v11
  v_add_u32 v161, s69, v10
  v_add_u32 v165, s69, v11
  v_add_u32 v162, s70, v10
  v_add_u32 v166, s70, v11
  v_add_u32 v163, s71, v10
  v_add_u32 v167, s71, v11
  v_and_b32 v10, 15, v1
  v_lshlrev_b32 v10, 4, v10
  v_bfe_u32 v11, v1, 4, 1
  v_lshl_add_u32 v10, v11, 3, v10
  v_lshrrev_b32 v11, 5, v1
  v_lshl_add_u32 v168, v11, 10, v10
  v_lshrrev_b32 v10, 4, v1
  v_lshlrev_b32 v10, 8, v10
  v_and_b32 v11, 15, v1
  v_lshl_add_u32 v169, v11, 2, v10
  v_lshlrev_b32 v183, 2, v1
  s_lshl_b32 s6, s49, 5
  s_add_u32 s6, s6, s48
  s_lshl_b32 s6, s6, 2
  s_add_u32 s6, s6, s44
  s_mul_i32 s6, s6, 1152
  s_add_u32 s6, s6, 1474560
  s_lshl_b32 s7, s49, 2
  s_add_u32 s7, s7, s44
  s_mul_i32 s7, s7, 65792
  s_lshl_b32 s63, s48, 11
  s_add_u32 s7, s7, s63
  s_add_u32 s7, s7, 13697024
  s_lshl_b32 s54, s49, 5
  s_mul_i32 s54, s54, 4608
  s_lshr_b32 s55, s48, 3
  s_mul_i32 s55, s55, 1152
  s_add_u32 s54, s54, s55
  s_add_u32 s3, s54, 1474560
  s_and_b32 s56, s48, 7
  s_cmp_eq_u32 s44, 2
  s_cselect_b32 s57, 3, 7
  s_cselect_b32 s58, 1, 0
  s_mov_b32 s42, 0x0f0f0f0f
  s_cselect_b32 s42, s42, -1
  s_mov_b32 s43, s42
  s_lshl_b32 s59, s56, 7
  s_cmp_eq_u32 s44, 2
  s_cselect_b32 s59, 1024, s59
  s_lshl_b32 s60, s56, 6
  v_lshrrev_b32 v10, 3, v1
  v_mul_u32_u24 v10, 4608, v10
  v_and_b32 v11, s57, v1
  v_lshl_add_u32 v11, v11, 4, v10
  v_add_u32 v170, s59, v11
  s_lshl_b32 s60, s56, 6
  s_cmp_eq_u32 s44, 2
  s_cselect_b32 s60, 512, s60
  v_lshrrev_b32 v10, 3, v1
  v_mul_u32_u24 v10, 20608, v10
  v_and_b32 v11, 7, v1
  v_lshl_add_u32 v10, v11, 3, v10
  v_add_u32 v171, s60, v10
  s_lshr_b32 s40, s48, 3
  s_lshl_b32 s63, s49, 2
  s_add_u32 s40, s40, s63
  s_mul_i32 s40, s40, 640
  s_add_u32 s40, s40, 18087936
  s_cmp_eq_u32 s56, 0
  s_cselect_b32 s57, 2, 3
  s_cmp_ge_u32 s44, s57
  s_cselect_b32 s41, 1, 0
  v_and_b32 v10, 3, v1
  v_cmp_eq_u32 s[72:73], 1, v10
  v_cmp_eq_u32 s[74:75], 2, v10
  v_lshl_add_u32 v21, v1, 4, s5
  s_barrier
  s_sleep 2
  s_add_u32 s54, s4, 0
  s_add_u32 m0, s5, 0
  s_nop 0
  buffer_load_dwordx4 v19, s[36:39], s54 offen sc1 lds
  s_add_u32 s54, s4, 33792
  s_add_u32 m0, s5, 1024
  s_nop 0
  buffer_load_dwordx4 v19, s[36:39], s54 offen sc1 lds
  s_add_u32 s54, s4, 67584
  s_add_u32 m0, s5, 2048
  s_nop 0
  buffer_load_dwordx4 v19, s[36:39], s54 offen sc1 lds
  s_add_u32 s54, s4, 101376
  s_add_u32 m0, s5, 3072
  s_nop 0
  buffer_load_dwordx4 v19, s[36:39], s54 offen sc1 lds
  s_add_u32 s54, s4, 540672
  s_add_u32 m0, s5, 16384
  s_nop 0
  buffer_load_dwordx4 v19, s[36:39], s54 offen sc1 lds
  s_add_u32 s54, s4, 574464
  s_add_u32 m0, s5, 17408
  s_nop 0
  buffer_load_dwordx4 v19, s[36:39], s54 offen sc1 lds
  s_add_u32 s54, s4, 608256
  s_add_u32 m0, s5, 18432
  s_nop 0
  buffer_load_dwordx4 v19, s[36:39], s54 offen sc1 lds
  s_add_u32 s54, s4, 642048
  s_add_u32 m0, s5, 19456
  s_nop 0
  buffer_load_dwordx4 v19, s[36:39], s54 offen sc1 lds
  s_add_u32 s54, s4, 1081344
  s_add_u32 m0, s5, 32768
  s_nop 0
  buffer_load_dwordx4 v19, s[36:39], s54 offen sc1 lds
  s_add_u32 s54, s4, 1115136
  s_add_u32 m0, s5, 33792
  s_nop 0
  buffer_load_dwordx4 v19, s[36:39], s54 offen sc1 lds
  s_add_u32 s54, s4, 1148928
  s_add_u32 m0, s5, 34816
  s_nop 0
  buffer_load_dwordx4 v19, s[36:39], s54 offen sc1 lds
  s_add_u32 s54, s4, 1182720
  s_add_u32 m0, s5, 35840
  s_nop 0
  buffer_load_dwordx4 v19, s[36:39], s54 offen sc1 lds
  s_waitcnt vmcnt(8)
L_gv_52:
  ds_read_b32 v56, v21 offset:0
  ds_read_b32 v57, v21 offset:1024
  ds_read_b32 v58, v21 offset:2048
  ds_read_b32 v59, v21 offset:3072
  s_waitcnt lgkmcnt(0)
  v_max3_u32 v56, v56, v57, v58
  v_max_u32 v56, v56, v59
  v_cmp_eq_u32 vcc, -1, v56
  s_cbranch_vccz L_gvk_53
  s_sub_u32 s52, s52, 1
  s_cbranch_scc1 L_gvx_54
  s_sleep 8
  s_add_u32 s54, s4, 0
  s_add_u32 m0, s5, 0
  s_nop 0
  buffer_load_dwordx4 v19, s[36:39], s54 offen sc1 lds
  s_add_u32 s54, s4, 33792
  s_add_u32 m0, s5, 1024
  s_nop 0
  buffer_load_dwordx4 v19, s[36:39], s54 offen sc1 lds
  s_add_u32 s54, s4, 67584
  s_add_u32 m0, s5, 2048
  s_nop 0
  buffer_load_dwordx4 v19, s[36:39], s54 offen sc1 lds
  s_add_u32 s54, s4, 101376
  s_add_u32 m0, s5, 3072
  s_nop 0
  buffer_load_dwordx4 v19, s[36:39], s54 offen sc1 lds
  s_add_u32 s54, s4, 540672
  s_add_u32 m0, s5, 16384
  s_nop 0
  buffer_load_dwordx4 v19, s[36:39], s54 offen sc1 lds
  s_add_u32 s54, s4, 574464
  s_add_u32 m0, s5, 17408
  s_nop 0
  buffer_load_dwordx4 v19, s[36:39], s54 offen sc1 lds
  s_add_u32 s54, s4, 608256
  s_add_u32 m0, s5, 18432
  s_nop 0
  buffer_load_dwordx4 v19, s[36:39], s54 offen sc1 lds
  s_add_u32 s54, s4, 642048
  s_add_u32 m0, s5, 19456
  s_nop 0
  buffer_load_dwordx4 v19, s[36:39], s54 offen sc1 lds
  s_add_u32 s54, s4, 1081344
  s_add_u32 m0, s5, 32768
  s_nop 0
  buffer_load_dwordx4 v19, s[36:39], s54 offen sc1 lds
  s_add_u32 s54, s4, 1115136
  s_add_u32 m0, s5, 33792
  s_nop 0
  buffer_load_dwordx4 v19, s[36:39], s54 offen sc1 lds
  s_add_u32 s54, s4, 1148928
  s_add_u32 m0, s5, 34816
  s_nop 0
  buffer_load_dwordx4 v19, s[36:39], s54 offen sc1 lds
  s_add_u32 s54, s4, 1182720
  s_add_u32 m0, s5, 35840
  s_nop 0
  buffer_load_dwordx4 v19, s[36:39], s54 offen sc1 lds
  s_waitcnt vmcnt(8)
  s_branch L_gv_52
L_gvx_54:
  s_mov_b32 s52, 0
L_gvk_53:
  s_barrier
  ds_read_b64_tr_b16 v[64:65], v12 offset:0
  ds_read_b64_tr_b16 v[66:67], v12 offset:2048
  ds_read_b64_tr_b16 v[68:69], v13 offset:0
  ds_read_b64_tr_b16 v[70:71], v13 offset:2048
  ds_read_b64_tr_b16 v[72:73], v14 offset:0
  ds_read_b64_tr_b16 v[74:75], v14 offset:2048
  ds_read_b64_tr_b16 v[76:77], v15 offset:0
  ds_read_b64_tr_b16 v[78:79], v15 offset:2048
  s_waitcnt lgkmcnt(0)
  v_mfma_f32_16x16x32_bf16 v[96:99], v[64:67], a[0:3], 0
  ds_read_b64_tr_b16 v[80:81], v12 offset:4096
  v_mfma_f32_16x16x32_bf16 v[144:147], v[64:67], v[64:67], 0
  ds_read_b64_tr_b16 v[82:83], v12 offset:6144
  s_add_u32 s54, s4, 1622016
  s_add_u32 m0, s5, 49152
  s_nop 0
  buffer_load_dwordx4 v19, s[36:39], s54 offen sc1 lds
  v_mfma_f32_16x16x32_bf16 v[112:115], v[64:67], a[64:67], 0
  ds_read_b64_tr_b16 v[84:85], v13 offset:4096
  v_mfma_f32_16x16x32_bf16 v[148:151], v[152:155], v[64:67], 0
  ds_read_b64_tr_b16 v[86:87], v13 offset:6144
  v_mfma_f32_16x16x32_bf16 v[100:103], v[68:71], a[0:3], 0
  ds_read_b64_tr_b16 v[88:89], v14 offset:4096
  s_add_u32 s54, s4, 1655808
  s_add_u32 m0, s5, 50176
  s_nop 0
  buffer_load_dwordx4 v19, s[36:39], s54 offen sc1 lds
  v_mfma_f32_16x16x32_bf16 v[116:119], v[68:71], a[64:67], 0
  ds_read_b64_tr_b16 v[90:91], v14 offset:6144
  v_mfma_f32_16x16x32_bf16 v[104:107], v[72:75], a[0:3], 0
  ds_read_b64_tr_b16 v[92:93], v15 offset:4096
  v_mfma_f32_16x16x32_bf16 v[120:123], v[72:75], a[64:67], 0
  ds_read_b64_tr_b16 v[94:95], v15 offset:6144
  s_add_u32 s54, s4, 1689600
  s_add_u32 m0, s5, 51200
  s_nop 0
  buffer_load_dwordx4 v19, s[36:39], s54 offen sc1 lds
  v_mfma_f32_16x16x32_bf16 v[108:111], v[76:79], a[0:3], 0
  v_mfma_f32_16x16x32_bf16 v[124:127], v[76:79], a[64:67], 0
  s_waitcnt lgkmcnt(0)
  s_waitcnt vmcnt(7)
  v_mfma_f32_16x16x32_bf16 v[96:99], v[80:83], a[4:7], v[96:99]
  ds_read_b64_tr_b16 v[64:65], v12 offset:8192
  v_mfma_f32_16x16x32_bf16 v[144:147], v[80:83], v[80:83], v[144:147]
  ds_read_b64_tr_b16 v[66:67], v12 offset:10240
  s_add_u32 s54, s4, 1723392
  s_add_u32 m0, s5, 52224
  s_nop 0
  buffer_load_dwordx4 v19, s[36:39], s54 offen sc1 lds
  v_mfma_f32_16x16x32_bf16 v[112:115], v[80:83], a[68:71], v[112:115]
  ds_read_b64_tr_b16 v[68:69], v13 offset:8192
  v_mfma_f32_16x16x32_bf16 v[148:151], v[152:155], v[80:83], v[148:151]
  ds_read_b64_tr_b16 v[70:71], v13 offset:10240
  v_mfma_f32_16x16x32_bf16 v[100:103], v[84:87], a[4:7], v[100:103]
  ds_read_b64_tr_b16 v[72:73], v14 offset:8192
  v_mfma_f32_16x16x32_bf16 v[116:119], v[84:87], a[68:71], v[116:119]
  ds_read_b64_tr_b16 v[74:75], v14 offset:10240
  v_mfma_f32_16x16x32_bf16 v[104:107], v[88:91], a[4:7], v[104:107]
  ds_read_b64_tr_b16 v[76:77], v15 offset:8192
  v_mfma_f32_16x16x32_bf16 v[120:123], v[88:91], a[68:71], v[120:123]
  ds_read_b64_tr_b16 v[78:79], v15 offset:10240
  v_mfma_f32_16x16x32_bf16 v[108:111], v[92:95], a[4:7], v[108:111]
  ds_read_b32 v56, v21 offset:16384
  v_mfma_f32_16x16x32_bf16 v[124:127], v[92:95], a[68:71], v[124:127]
  ds_read_b32 v57, v21 offset:17408
  ds_read_b32 v58, v21 offset:18432
  ds_read_b32 v59, v21 offset:19456
  s_waitcnt lgkmcnt(0)
  v_mfma_f32_16x16x32_bf16 v[96:99], v[64:67], a[8:11], v[96:99]
  ds_read_b64_tr_b16 v[80:81], v12 offset:12288
  v_mfma_f32_16x16x32_bf16 v[144:147], v[64:67], v[64:67], v[144:147]
  ds_read_b64_tr_b16 v[82:83], v12 offset:14336
  v_mfma_f32_16x16x32_bf16 v[112:115], v[64:67], a[72:75], v[112:115]
  ds_read_b64_tr_b16 v[84:85], v13 offset:12288
  v_max3_u32 v56, v56, v57, v58
  v_mfma_f32_16x16x32_bf16 v[148:151], v[152:155], v[64:67], v[148:151]
  ds_read_b64_tr_b16 v[86:87], v13 offset:14336
  v_mfma_f32_16x16x32_bf16 v[100:103], v[68:71], a[8:11], v[100:103]
  ds_read_b64_tr_b16 v[88:89], v14 offset:12288
  v_max_u32 v56, v56, v59
  v_mfma_f32_16x16x32_bf16 v[116:119], v[68:71], a[72:75], v[116:119]
  ds_read_b64_tr_b16 v[90:91], v14 offset:14336
  v_mfma_f32_16x16x32_bf16 v[104:107], v[72:75], a[8:11], v[104:107]
  ds_read_b64_tr_b16 v[92:93], v15 offset:12288
  v_cmp_eq_u32 vcc, -1, v56
  v_mfma_f32_16x16x32_bf16 v[120:123], v[72:75], a[72:75], v[120:123]
  ds_read_b64_tr_b16 v[94:95], v15 offset:14336
  v_mfma_f32_16x16x32_bf16 v[108:111], v[76:79], a[8:11], v[108:111]
  v_mfma_f32_16x16x32_bf16 v[124:127], v[76:79], a[72:75], v[124:127]
  s_cbranch_vccz L_gok_55
  s_add_u32 s54, s4, 540672
  s_add_u32 m0, s5, 16384
  s_nop 0
  buffer_load_dwordx4 v19, s[36:39], s54 offen sc1 lds
  s_add_u32 s54, s4, 574464
  s_add_u32 m0, s5, 17408
  s_nop 0
  buffer_load_dwordx4 v19, s[36:39], s54 offen sc1 lds
  s_add_u32 s54, s4, 608256
  s_add_u32 m0, s5, 18432
  s_nop 0
  buffer_load_dwordx4 v19, s[36:39], s54 offen sc1 lds
  s_add_u32 s54, s4, 642048
  s_add_u32 m0, s5, 19456
  s_nop 0
  buffer_load_dwordx4 v19, s[36:39], s54 offen sc1 lds
  s_waitcnt vmcnt(0)
L_gv_56:
  ds_read_b32 v56, v21 offset:16384
  ds_read_b32 v57, v21 offset:17408
  ds_read_b32 v58, v21 offset:18432
  ds_read_b32 v59, v21 offset:19456
  s_waitcnt lgkmcnt(0)
  v_max3_u32 v56, v56, v57, v58
  v_max_u32 v56, v56, v59
  v_cmp_eq_u32 vcc, -1, v56
  s_cbranch_vccz L_gvk_57
  s_sub_u32 s52, s52, 1
  s_cbranch_scc1 L_gvx_58
  s_sleep 8
  s_add_u32 s54, s4, 540672
  s_add_u32 m0, s5, 16384
  s_nop 0
  buffer_load_dwordx4 v19, s[36:39], s54 offen sc1 lds
  s_add_u32 s54, s4, 574464
  s_add_u32 m0, s5, 17408
  s_nop 0
  buffer_load_dwordx4 v19, s[36:39], s54 offen sc1 lds
  s_add_u32 s54, s4, 608256
  s_add_u32 m0, s5, 18432
  s_nop 0
  buffer_load_dwordx4 v19, s[36:39], s54 offen sc1 lds
  s_add_u32 s54, s4, 642048
  s_add_u32 m0, s5, 19456
  s_nop 0
  buffer_load_dwordx4 v19, s[36:39], s54 offen sc1 lds
  s_waitcnt vmcnt(0)
  s_branch L_gv_56
L_gvx_58:
  s_mov_b32 s52, 0
L_gvk_57:
L_gok_55:
  s_barrier
  s_waitcnt lgkmcnt(0)
  v_mfma_f32_16x16x32_bf16 v[96:99], v[80:83], a[12:15], v[96:99]
  ds_read_b64_tr_b16 v[64:65], v12 offset:16384
  v_mfma_f32_16x16x32_bf16 v[144:147], v[80:83], v[80:83], v[144:147]
  ds_read_b64_tr_b16 v[66:67], v12 offset:18432
  v_mfma_f32_16x16x32_bf16 v[112:115], v[80:83], a[76:79], v[112:115]
  ds_read_b64_tr_b16 v[68:69], v13 offset:16384
  v_mfma_f32_16x16x32_bf16 v[148:151], v[152:155], v[80:83], v[148:151]
  ds_read_b64_tr_b16 v[70:71], v13 offset:18432
  v_mfma_f32_16x16x32_bf16 v[100:103], v[84:87], a[12:15], v[100:103]
  ds_read_b64_tr_b16 v[72:73], v14 offset:16384
  v_mfma_f32_16x16x32_bf16 v[116:119], v[84:87], a[76:79], v[116:119]
  ds_read_b64_tr_b16 v[74:75], v14 offset:18432
  v_mfma_f32_16x16x32_bf16 v[104:107], v[88:91], a[12:15], v[104:107]
  ds_read_b64_tr_b16 v[76:77], v15 offset:16384
  v_mfma_f32_16x16x32_bf16 v[120:123], v[88:91], a[76:79], v[120:123]
  ds_read_b64_tr_b16 v[78:79], v15 offset:18432
  v_mfma_f32_16x16x32_bf16 v[108:111], v[92:95], a[12:15], v[108:111]
  v_mfma_f32_16x16x32_bf16 v[124:127], v[92:95], a[76:79], v[124:127]
  s_waitcnt lgkmcnt(0)
  v_mfma_f32_16x16x32_bf16 v[96:99], v[64:67], a[16:19], v[96:99]
  ds_read_b64_tr_b16 v[80:81], v12 offset:20480
  v_mfma_f32_16x16x32_bf16 v[144:147], v[64:67], v[64:67], v[144:147]
  ds_read_b64_tr_b16 v[82:83], v12 offset:22528
  v_mfma_f32_16x16x32_bf16 v[112:115], v[64:67], a[80:83], v[112:115]
  ds_read_b64_tr_b16 v[84:85], v13 offset:20480
  v_mfma_f32_16x16x32_bf16 v[148:151], v[152:155], v[64:67], v[148:151]
  ds_read_b64_tr_b16 v[86:87], v13 offset:22528
  v_mfma_f32_16x16x32_bf16 v[100:103], v[68:71], a[16:19], v[100:103]
  ds_read_b64_tr_b16 v[88:89], v14 offset:20480
  v_mfma_f32_16x16x32_bf16 v[116:119], v[68:71], a[80:83], v[116:119]
  ds_read_b64_tr_b16 v[90:91], v14 offset:22528
  v_mfma_f32_16x16x32_bf16 v[104:107], v[72:75], a[16:19], v[104:107]
  ds_read_b64_tr_b16 v[92:93], v15 offset:20480
  v_mfma_f32_16x16x32_bf16 v[120:123], v[72:75], a[80:83], v[120:123]
  ds_read_b64_tr_b16 v[94:95], v15 offset:22528
  v_mfma_f32_16x16x32_bf16 v[108:111], v[76:79], a[16:19], v[108:111]
  v_mfma_f32_16x16x32_bf16 v[124:127], v[76:79], a[80:83], v[124:127]
  s_waitcnt lgkmcnt(0)
  s_waitcnt vmcnt(4)
  v_mfma_f32_16x16x32_bf16 v[96:99], v[80:83], a[20:23], v[96:99]
  ds_read_b64_tr_b16 v[64:65], v12 offset:24576
  v_mfma_f32_16x16x32_bf16 v[144:147], v[80:83], v[80:83], v[144:147]
  ds_read_b64_tr_b16 v[66:67], v12 offset:26624
  v_mfma_f32_16x16x32_bf16 v[112:115], v[80:83], a[84:87], v[112:115]
  ds_read_b64_tr_b16 v[68:69], v13 offset:24576
  v_mfma_f32_16x16x32_bf16 v[148:151], v[152:155], v[80:83], v[148:151]
  ds_read_b64_tr_b16 v[70:71], v13 offset:26624
  v_mfma_f32_16x16x32_bf16 v[100:103], v[84:87], a[20:23], v[100:103]
  ds_read_b64_tr_b16 v[72:73], v14 offset:24576
  v_mfma_f32_16x16x32_bf16 v[116:119], v[84:87], a[84:87], v[116:119]
  ds_read_b64_tr_b16 v[74:75], v14 offset:26624
  v_mfma_f32_16x16x32_bf16 v[104:107], v[88:91], a[20:23], v[104:107]
  ds_read_b64_tr_b16 v[76:77], v15 offset:24576
  v_mfma_f32_16x16x32_bf16 v[120:123], v[88:91], a[84:87], v[120:123]
  ds_read_b64_tr_b16 v[78:79], v15 offset:26624
  v_mfma_f32_16x16x32_bf16 v[108:111], v[92:95], a[20:23], v[108:111]
  ds_read_b32 v56, v21 offset:32768
  v_mfma_f32_16x16x32_bf16 v[124:127], v[92:95], a[84:87], v[124:127]
  ds_read_b32 v57, v21 offset:33792
  ds_read_b32 v58, v21 offset:34816
  ds_read_b32 v59, v21 offset:35840
  s_waitcnt lgkmcnt(0)
  v_mfma_f32_16x16x32_bf16 v[96:99], v[64:67], a[24:27], v[96:99]
  ds_read_b64_tr_b16 v[80:81], v12 offset:28672
  v_mfma_f32_16x16x32_bf16 v[144:147], v[64:67], v[64:67], v[144:147]
  ds_read_b64_tr_b16 v[82:83], v12 offset:30720
  v_mfma_f32_16x16x32_bf16 v[112:115], v[64:67], a[88:91], v[112:115]
  ds_read_b64_tr_b16 v[84:85], v13 offset:28672
  v_max3_u32 v56, v56, v57, v58
  v_mfma_f32_16x16x32_bf16 v[148:151], v[152:155], v[64:67], v[148:151]
  ds_read_b64_tr_b16 v[86:87], v13 offset:30720
  v_mfma_f32_16x16x32_bf16 v[100:103], v[68:71], a[24:27], v[100:103]
  ds_read_b64_tr_b16 v[88:89], v14 offset:28672
  v_max_u32 v56, v56, v59
  v_mfma_f32_16x16x32_bf16 v[116:119], v[68:71], a[88:91], v[116:119]
  ds_read_b64_tr_b16 v[90:91], v14 offset:30720
  v_mfma_f32_16x16x32_bf16 v[104:107], v[72:75], a[24:27], v[104:107]
  ds_read_b64_tr_b16 v[92:93], v15 offset:28672
  v_cmp_eq_u32 vcc, -1, v56
  v_mfma_f32_16x16x32_bf16 v[120:123], v[72:75], a[88:91], v[120:123]
  ds_read_b64_tr_b16 v[94:95], v15 offset:30720
  v_mfma_f32_16x16x32_bf16 v[108:111], v[76:79], a[24:27], v[108:111]
  v_mfma_f32_16x16x32_bf16 v[124:127], v[76:79], a[88:91], v[124:127]
  s_cbranch_vccz L_gok_59
  s_add_u32 s54, s4, 1081344
  s_add_u32 m0, s5, 32768
  s_nop 0
  buffer_load_dwordx4 v19, s[36:39], s54 offen sc1 lds
  s_add_u32 s54, s4, 1115136
  s_add_u32 m0, s5, 33792
  s_nop 0
  buffer_load_dwordx4 v19, s[36:39], s54 offen sc1 lds
  s_add_u32 s54, s4, 1148928
  s_add_u32 m0, s5, 34816
  s_nop 0
  buffer_load_dwordx4 v19, s[36:39], s54 offen sc1 lds
  s_add_u32 s54, s4, 1182720
  s_add_u32 m0, s5, 35840
  s_nop 0
  buffer_load_dwordx4 v19, s[36:39], s54 offen sc1 lds
  s_waitcnt vmcnt(0)
L_gv_60:
  ds_read_b32 v56, v21 offset:32768
  ds_read_b32 v57, v21 offset:33792
  ds_read_b32 v58, v21 offset:34816
  ds_read_b32 v59, v21 offset:35840
  s_waitcnt lgkmcnt(0)
  v_max3_u32 v56, v56, v57, v58
  v_max_u32 v56, v56, v59
  v_cmp_eq_u32 vcc, -1, v56
  s_cbranch_vccz L_gvk_61
  s_sub_u32 s52, s52, 1
  s_cbranch_scc1 L_gvx_62
  s_sleep 8
  s_add_u32 s54, s4, 1081344
  s_add_u32 m0, s5, 32768
  s_nop 0
  buffer_load_dwordx4 v19, s[36:39], s54 offen sc1 lds
  s_add_u32 s54, s4, 1115136
  s_add_u32 m0, s5, 33792
  s_nop 0
  buffer_load_dwordx4 v19, s[36:39], s54 offen sc1 lds
  s_add_u32 s54, s4, 1148928
  s_add_u32 m0, s5, 34816
  s_nop 0
  buffer_load_dwordx4 v19, s[36:39], s54 offen sc1 lds
  s_add_u32 s54, s4, 1182720
  s_add_u32 m0, s5, 35840
  s_nop 0
  buffer_load_dwordx4 v19, s[36:39], s54 offen sc1 lds
  s_waitcnt vmcnt(0)
  s_branch L_gv_60
L_gvx_62:
  s_mov_b32 s52, 0
L_gvk_61:
L_gok_59:
  s_barrier
  s_waitcnt lgkmcnt(0)
  v_mfma_f32_16x16x32_bf16 v[96:99], v[80:83], a[28:31], v[96:99]
  ds_read_b64_tr_b16 v[64:65], v12 offset:32768
  v_mfma_f32_16x16x32_bf16 v[144:147], v[80:83], v[80:83], v[144:147]
  ds_read_b64_tr_b16 v[66:67], v12 offset:34816
  v_mfma_f32_16x16x32_bf16 v[112:115], v[80:83], a[92:95], v[112:115]
  ds_read_b64_tr_b16 v[68:69], v13 offset:32768
  v_mfma_f32_16x16x32_bf16 v[148:151], v[152:155], v[80:83], v[148:151]
  ds_read_b64_tr_b16 v[70:71], v13 offset:34816
  v_mfma_f32_16x16x32_bf16 v[100:103], v[84:87], a[28:31], v[100:103]
  ds_read_b64_tr_b16 v[72:73], v14 offset:32768
  v_mfma_f32_16x16x32_bf16 v[116:119], v[84:87], a[92:95], v[116:119]
  ds_read_b64_tr_b16 v[74:75], v14 offset:34816
  v_mfma_f32_16x16x32_bf16 v[104:107], v[88:91], a[28:31], v[104:107]
  ds_read_b64_tr_b16 v[76:77], v15 offset:32768
  v_mfma_f32_16x16x32_bf16 v[120:123], v[88:91], a[92:95], v[120:123]
  ds_read_b64_tr_b16 v[78:79], v15 offset:34816
  v_mfma_f32_16x16x32_bf16 v[108:111], v[92:95], a[28:31], v[108:111]
  v_mfma_f32_16x16x32_bf16 v[124:127], v[92:95], a[92:95], v[124:127]
  s_waitcnt lgkmcnt(0)
  v_mfma_f32_16x16x32_bf16 v[96:99], v[64:67], a[32:35], v[96:99]
  ds_read_b64_tr_b16 v[80:81], v12 offset:36864
  v_mfma_f32_16x16x32_bf16 v[144:147], v[64:67], v[64:67], v[144:147]
  ds_read_b64_tr_b16 v[82:83], v12 offset:38912
  v_mfma_f32_16x16x32_bf16 v[112:115], v[64:67], a[96:99], v[112:115]
  ds_read_b64_tr_b16 v[84:85], v13 offset:36864
  v_mfma_f32_16x16x32_bf16 v[148:151], v[152:155], v[64:67], v[148:151]
  ds_read_b64_tr_b16 v[86:87], v13 offset:38912
  v_mfma_f32_16x16x32_bf16 v[100:103], v[68:71], a[32:35], v[100:103]
  ds_read_b64_tr_b16 v[88:89], v14 offset:36864
  v_mfma_f32_16x16x32_bf16 v[116:119], v[68:71], a[96:99], v[116:119]
  ds_read_b64_tr_b16 v[90:91], v14 offset:38912
  v_mfma_f32_16x16x32_bf16 v[104:107], v[72:75], a[32:35], v[104:107]
  ds_read_b64_tr_b16 v[92:93], v15 offset:36864
  v_mfma_f32_16x16x32_bf16 v[120:123], v[72:75], a[96:99], v[120:123]
  ds_read_b64_tr_b16 v[94:95], v15 offset:38912
  v_mfma_f32_16x16x32_bf16 v[108:111], v[76:79], a[32:35], v[108:111]
  v_mfma_f32_16x16x32_bf16 v[124:127], v[76:79], a[96:99], v[124:127]
  s_waitcnt lgkmcnt(0)
  s_waitcnt vmcnt(0)
  v_mfma_f32_16x16x32_bf16 v[96:99], v[80:83], a[36:39], v[96:99]
  ds_read_b64_tr_b16 v[64:65], v12 offset:40960
  v_mfma_f32_16x16x32_bf16 v[144:147], v[80:83], v[80:83], v[144:147]
  ds_read_b64_tr_b16 v[66:67], v12 offset:43008
  v_mfma_f32_16x16x32_bf16 v[112:115], v[80:83], a[100:103], v[112:115]
  ds_read_b64_tr_b16 v[68:69], v13 offset:40960
  v_mfma_f32_16x16x32_bf16 v[148:151], v[152:155], v[80:83], v[148:151]
  ds_read_b64_tr_b16 v[70:71], v13 offset:43008
  v_mfma_f32_16x16x32_bf16 v[100:103], v[84:87], a[36:39], v[100:103]
  ds_read_b64_tr_b16 v[72:73], v14 offset:40960
  v_mfma_f32_16x16x32_bf16 v[116:119], v[84:87], a[100:103], v[116:119]
  ds_read_b64_tr_b16 v[74:75], v14 offset:43008
  v_mfma_f32_16x16x32_bf16 v[104:107], v[88:91], a[36:39], v[104:107]
  ds_read_b64_tr_b16 v[76:77], v15 offset:40960
  v_mfma_f32_16x16x32_bf16 v[120:123], v[88:91], a[100:103], v[120:123]
  ds_read_b64_tr_b16 v[78:79], v15 offset:43008
  v_mfma_f32_16x16x32_bf16 v[108:111], v[92:95], a[36:39], v[108:111]
  ds_read_b32 v56, v21 offset:49152
  v_mfma_f32_16x16x32_bf16 v[124:127], v[92:95], a[100:103], v[124:127]
  ds_read_b32 v57, v21 offset:50176
  ds_read_b32 v58, v21 offset:51200
  ds_read_b32 v59, v21 offset:52224
  s_waitcnt lgkmcnt(0)
  v_mfma_f32_16x16x32_bf16 v[96:99], v[64:67], a[40:43], v[96:99]
  ds_read_b64_tr_b16 v[80:81], v12 offset:45056
  v_mfma_f32_16x16x32_bf16 v[144:147], v[64:67], v[64:67], v[144:147]
  ds_read_b64_tr_b16 v[82:83], v12 offset:47104
  v_mfma_f32_16x16x32_bf16 v[112:115], v[64:67], a[104:107], v[112:115]
  ds_read_b64_tr_b16 v[84:85], v13 offset:45056
  v_max3_u32 v56, v56, v57, v58
  v_mfma_f32_16x16x32_bf16 v[148:151], v[152:155], v[64:67], v[148:151]
  ds_read_b64_tr_b16 v[86:87], v13 offset:47104
  v_mfma_f32_16x16x32_bf16 v[100:103], v[68:71], a[40:43], v[100:103]
  ds_read_b64_tr_b16 v[88:89], v14 offset:45056
  v_max_u32 v56, v56, v59
  v_mfma_f32_16x16x32_bf16 v[116:119], v[68:71], a[104:107], v[116:119]
  ds_read_b64_tr_b16 v[90:91], v14 offset:47104
  v_mfma_f32_16x16x32_bf16 v[104:107], v[72:75], a[40:43], v[104:107]
  ds_read_b64_tr_b16 v[92:93], v15 offset:45056
  v_cmp_eq_u32 vcc, -1, v56
  v_mfma_f32_16x16x32_bf16 v[120:123], v[72:75], a[104:107], v[120:123]
  ds_read_b64_tr_b16 v[94:95], v15 offset:47104
  v_mfma_f32_16x16x32_bf16 v[108:111], v[76:79], a[40:43], v[108:111]
  v_mfma_f32_16x16x32_bf16 v[124:127], v[76:79], a[104:107], v[124:127]
  s_cbranch_vccz L_gok_63
  s_add_u32 s54, s4, 1622016
  s_add_u32 m0, s5, 49152
  s_nop 0
  buffer_load_dwordx4 v19, s[36:39], s54 offen sc1 lds
  s_add_u32 s54, s4, 1655808
  s_add_u32 m0, s5, 50176
  s_nop 0
  buffer_load_dwordx4 v19, s[36:39], s54 offen sc1 lds
  s_add_u32 s54, s4, 1689600
  s_add_u32 m0, s5, 51200
  s_nop 0
  buffer_load_dwordx4 v19, s[36:39], s54 offen sc1 lds
  s_add_u32 s54, s4, 1723392
  s_add_u32 m0, s5, 52224
  s_nop 0
  buffer_load_dwordx4 v19, s[36:39], s54 offen sc1 lds
  s_waitcnt vmcnt(0)
L_gv_64:
  ds_read_b32 v56, v21 offset:49152
  ds_read_b32 v57, v21 offset:50176
  ds_read_b32 v58, v21 offset:51200
  ds_read_b32 v59, v21 offset:52224
  s_waitcnt lgkmcnt(0)
  v_max3_u32 v56, v56, v57, v58
  v_max_u32 v56, v56, v59
  v_cmp_eq_u32 vcc, -1, v56
  s_cbranch_vccz L_gvk_65
  s_sub_u32 s52, s52, 1
  s_cbranch_scc1 L_gvx_66
  s_sleep 8
  s_add_u32 s54, s4, 1622016
  s_add_u32 m0, s5, 49152
  s_nop 0
  buffer_load_dwordx4 v19, s[36:39], s54 offen sc1 lds
  s_add_u32 s54, s4, 1655808
  s_add_u32 m0, s5, 50176
  s_nop 0
  buffer_load_dwordx4 v19, s[36:39], s54 offen sc1 lds
  s_add_u32 s54, s4, 1689600
  s_add_u32 m0, s5, 51200
  s_nop 0
  buffer_load_dwordx4 v19, s[36:39], s54 offen sc1 lds
  s_add_u32 s54, s4, 1723392
  s_add_u32 m0, s5, 52224
  s_nop 0
  buffer_load_dwordx4 v19, s[36:39], s54 offen sc1 lds
  s_waitcnt vmcnt(0)
  s_branch L_gv_64
L_gvx_66:
  s_mov_b32 s52, 0
L_gvk_65:
L_gok_63:
  s_barrier
  s_waitcnt lgkmcnt(0)
  v_mfma_f32_16x16x32_bf16 v[96:99], v[80:83], a[44:47], v[96:99]
  ds_read_b64_tr_b16 v[64:65], v12 offset:49152
  v_mfma_f32_16x16x32_bf16 v[144:147], v[80:83], v[80:83], v[144:147]
  ds_read_b64_tr_b16 v[66:67], v12 offset:51200
  v_mfma_f32_16x16x32_bf16 v[112:115], v[80:83], a[108:111], v[112:115]
  ds_read_b64_tr_b16 v[68:69], v13 offset:49152
  v_mfma_f32_16x16x32_bf16 v[148:151], v[152:155], v[80:83], v[148:151]
  ds_read_b64_tr_b16 v[70:71], v13 offset:51200
  v_mfma_f32_16x16x32_bf16 v[100:103], v[84:87], a[44:47], v[100:103]
  ds_read_b64_tr_b16 v[72:73], v14 offset:49152
  v_mfma_f32_16x16x32_bf16 v[116:119], v[84:87], a[108:111], v[116:119]
  ds_read_b64_tr_b16 v[74:75], v14 offset:51200
  v_mfma_f32_16x16x32_bf16 v[104:107], v[88:91], a[44:47], v[104:107]
  ds_read_b64_tr_b16 v[76:77], v15 offset:49152
  v_mfma_f32_16x16x32_bf16 v[120:123], v[88:91], a[108:111], v[120:123]
  ds_read_b64_tr_b16 v[78:79], v15 offset:51200
  v_mfma_f32_16x16x32_bf16 v[108:111], v[92:95], a[44:47], v[108:111]
  v_mfma_f32_16x16x32_bf16 v[124:127], v[92:95], a[108:111], v[124:127]
  s_waitcnt lgkmcnt(0)
  v_mfma_f32_16x16x32_bf16 v[96:99], v[64:67], a[48:51], v[96:99]
  ds_read_b64_tr_b16 v[80:81], v12 offset:53248
  v_mfma_f32_16x16x32_bf16 v[144:147], v[64:67], v[64:67], v[144:147]
  ds_read_b64_tr_b16 v[82:83], v12 offset:55296
  v_mfma_f32_16x16x32_bf16 v[112:115], v[64:67], a[112:115], v[112:115]
  ds_read_b64_tr_b16 v[84:85], v13 offset:53248
  v_mfma_f32_16x16x32_bf16 v[148:151], v[152:155], v[64:67], v[148:151]
  ds_read_b64_tr_b16 v[86:87], v13 offset:55296
  v_mfma_f32_16x16x32_bf16 v[100:103], v[68:71], a[48:51], v[100:103]
  ds_read_b64_tr_b16 v[88:89], v14 offset:53248
  v_mfma_f32_16x16x32_bf16 v[116:119], v[68:71], a[112:115], v[116:119]
  ds_read_b64_tr_b16 v[90:91], v14 offset:55296
  v_mfma_f32_16x16x32_bf16 v[104:107], v[72:75], a[48:51], v[104:107]
  ds_read_b64_tr_b16 v[92:93], v15 offset:53248
  v_mfma_f32_16x16x32_bf16 v[120:123], v[72:75], a[112:115], v[120:123]
  ds_read_b64_tr_b16 v[94:95], v15 offset:55296
  v_mfma_f32_16x16x32_bf16 v[108:111], v[76:79], a[48:51], v[108:111]
  v_mfma_f32_16x16x32_bf16 v[124:127], v[76:79], a[112:115], v[124:127]
  s_waitcnt lgkmcnt(0)
  v_mfma_f32_16x16x32_bf16 v[96:99], v[80:83], a[52:55], v[96:99]
  ds_read_b64_tr_b16 v[64:65], v12 offset:57344
  v_mfma_f32_16x16x32_bf16 v[144:147], v[80:83], v[80:83], v[144:147]
  ds_read_b64_tr_b16 v[66:67], v12 offset:59392
  v_mfma_f32_16x16x32_bf16 v[112:115], v[80:83], a[116:119], v[112:115]
  ds_read_b64_tr_b16 v[68:69], v13 offset:57344
  v_mfma_f32_16x16x32_bf16 v[148:151], v[152:155], v[80:83], v[148:151]
  ds_read_b64_tr_b16 v[70:71], v13 offset:59392
  v_mfma_f32_16x16x32_bf16 v[100:103], v[84:87], a[52:55], v[100:103]
  ds_read_b64_tr_b16 v[72:73], v14 offset:57344
  v_mfma_f32_16x16x32_bf16 v[116:119], v[84:87], a[116:119], v[116:119]
  ds_read_b64_tr_b16 v[74:75], v14 offset:59392
  v_mfma_f32_16x16x32_bf16 v[104:107], v[88:91], a[52:55], v[104:107]
  ds_read_b64_tr_b16 v[76:77], v15 offset:57344
  v_mfma_f32_16x16x32_bf16 v[120:123], v[88:91], a[116:119], v[120:123]
  ds_read_b64_tr_b16 v[78:79], v15 offset:59392
  v_mfma_f32_16x16x32_bf16 v[108:111], v[92:95], a[52:55], v[108:111]
  v_mfma_f32_16x16x32_bf16 v[124:127], v[92:95], a[116:119], v[124:127]
  s_waitcnt lgkmcnt(0)
  v_mfma_f32_16x16x32_bf16 v[96:99], v[64:67], a[56:59], v[96:99]
  ds_read_b64_tr_b16 v[80:81], v12 offset:61440
  v_mfma_f32_16x16x32_bf16 v[144:147], v[64:67], v[64:67], v[144:147]
  ds_read_b64_tr_b16 v[82:83], v12 offset:63488
  v_mfma_f32_16x16x32_bf16 v[112:115], v[64:67], a[120:123], v[112:115]
  ds_read_b64_tr_b16 v[84:85], v13 offset:61440
  v_mfma_f32_16x16x32_bf16 v[148:151], v[152:155], v[64:67], v[148:151]
  ds_read_b64_tr_b16 v[86:87], v13 offset:63488
  v_mfma_f32_16x16x32_bf16 v[100:103], v[68:71], a[56:59], v[100:103]
  ds_read_b64_tr_b16 v[88:89], v14 offset:61440
  v_mfma_f32_16x16x32_bf16 v[116:119], v[68:71], a[120:123], v[116:119]
  ds_read_b64_tr_b16 v[90:91], v14 offset:63488
  v_mfma_f32_16x16x32_bf16 v[104:107], v[72:75], a[56:59], v[104:107]
  ds_read_b64_tr_b16 v[92:93], v15 offset:61440
  v_mfma_f32_16x16x32_bf16 v[120:123], v[72:75], a[120:123], v[120:123]
  ds_read_b64_tr_b16 v[94:95], v15 offset:63488
  v_mfma_f32_16x16x32_bf16 v[108:111], v[76:79], a[56:59], v[108:111]
  v_mfma_f32_16x16x32_bf16 v[124:127], v[76:79], a[120:123], v[124:127]
  s_waitcnt lgkmcnt(0)
  v_mfma_f32_16x16x32_bf16 v[144:147], v[80:83], v[80:83], v[144:147]
  v_and_b32 v10, 3, v1
  v_cmp_eq_u32 s[72:73], 1, v10
  v_mfma_f32_16x16x32_bf16 v[148:151], v[152:155], v[80:83], v[148:151]
  v_cmp_eq_u32 s[74:75], 2, v10
  v_cmp_eq_u32 vcc, 3, v10
  v_mfma_f32_16x16x32_bf16 v[96:99], v[80:83], a[60:63], v[96:99]
  v_mfma_f32_16x16x32_bf16 v[112:115], v[80:83], a[124:127], v[112:115]
  v_mfma_f32_16x16x32_bf16 v[100:103], v[84:87], a[60:63], v[100:103]
  v_cndmask_b32 v11, v144, v145, s[72:73]
  v_cndmask_b32 v11, v11, v146, s[74:75]
  v_cndmask_b32 v11, v11, v147, vcc
  v_mul_f32 v20, s80, v148
  v_mfma_f32_16x16x32_bf16 v[116:119], v[84:87], a[124:127], v[116:119]
  v_mul_f32 v21, s80, v11
  v_fma_f32 v21, -v20, v20, v21
  v_max_f32 v21, 0, v21
  v_cvt_pk_bf16_f32 v20, v20, v21
  v_mfma_f32_16x16x32_bf16 v[104:107], v[88:91], a[60:63], v[104:107]
  v_and_b32 v21, s76, v20
  v_lshlrev_b32 v16, 16, v20
  v_add_f32 v21, 0x3727c5ac, v21
  v_cvt_pk_bf16_f32 v21, v21, v21
  v_mfma_f32_16x16x32_bf16 v[120:123], v[88:91], a[124:127], v[120:123]
  v_lshlrev_b32 v21, 16, v21
  v_sqrt_f32 v21, v21
  s_nop 0
  v_cvt_pk_bf16_f32 v21, v21, v21
  v_lshlrev_b32 v21, 16, v21
  v_mfma_f32_16x16x32_bf16 v[108:111], v[92:95], a[60:63], v[108:111]
  v_rcp_f32 v17, v21
  s_nop 0
  v_mul_f32 v16, v16, v17
  v_mfma_f32_16x16x32_bf16 v[124:127], v[92:95], a[124:127], v[124:127]
  s_mov_b32 s56, 0x00f0000f
  s_mov_b32 s57, 0xf0000f00
  s_mov_b64 exec, s[56:57]
  ds_write_b32 v158, v17
  ds_write_b32 v158, v16 offset:256
  s_mov_b64 exec, -1
  ds_read_b64_tr_b16 v[184:185], v156 offset:0
  ds_read_b64_tr_b16 v[186:187], v157 offset:512
  ds_read_b64_tr_b16 v[188:189], v156 offset:1024
  ds_read_b64_tr_b16 v[190:191], v157 offset:1536
  s_waitcnt lgkmcnt(0)
  s_barrier
  ds_read_b128 v[24:27], v160
  ds_read_b128 v[40:43], v160 offset:256
  ds_read_b128 v[28:31], v161
  ds_read_b128 v[44:47], v161 offset:256
  ds_read_b128 v[32:35], v162
  ds_read_b128 v[48:51], v162 offset:256
  ds_read_b128 v[36:39], v163
  ds_read_b128 v[52:55], v163 offset:256
  ds_read_b32 v56, v164
  ds_read_b32 v176, v164 offset:256
  ds_read_b32 v58, v165
  ds_read_b32 v178, v165 offset:256
  ds_read_b32 v60, v166
  ds_read_b32 v180, v166 offset:256
  ds_read_b32 v62, v167
  ds_read_b32 v182, v167 offset:256
  s_waitcnt lgkmcnt(14)
  v_pk_mul_f32 v[172:173], v[40:41], v[4:5]
  v_pk_mul_f32 v[174:175], v[42:43], v[4:5]
  v_pk_fma_f32 v[172:173], v[24:25], v[112:113], v[172:173]
  v_pk_fma_f32 v[174:175], v[26:27], v[114:115], v[174:175]
  v_pk_fma_f32 v[88:89], v[40:41], v[2:3], s[66:67]
  v_pk_fma_f32 v[92:93], v[42:43], v[2:3], s[66:67]
  v_pk_fma_f32 v[88:89], v[24:25], v[96:97], v[88:89]
  v_pk_fma_f32 v[92:93], v[26:27], v[98:99], v[92:93]
  v_pk_mul_f32 v[90:91], v[88:89], s[64:65]
  v_pk_mul_f32 v[94:95], v[92:93], s[64:65]
  v_exp_f32 v90, v90 clamp
  v_exp_f32 v91, v91 clamp
  v_exp_f32 v94, v94 clamp
  v_exp_f32 v95, v95 clamp
  v_max_f32 v88, s66, v88
  v_max_f32 v89, s66, v89
  v_max_f32 v92, s66, v92
  v_max_f32 v93, s66, v93
  v_pk_add_f32 v[88:89], v[88:89], v[90:91]
  v_pk_add_f32 v[92:93], v[92:93], v[94:95]
  v_cvt_pk_bf16_f32 v72, v88, v89
  v_cvt_pk_bf16_f32 v73, v92, v93
  v_cvt_pk_bf16_f32 v80, v172, v173
  v_cvt_pk_bf16_f32 v81, v174, v175
  s_waitcnt lgkmcnt(12)
  v_pk_mul_f32 v[172:173], v[44:45], v[4:5]
  v_pk_mul_f32 v[174:175], v[46:47], v[4:5]
  v_pk_fma_f32 v[172:173], v[28:29], v[116:117], v[172:173]
  v_pk_fma_f32 v[174:175], v[30:31], v[118:119], v[174:175]
  v_pk_fma_f32 v[88:89], v[44:45], v[2:3], s[66:67]
  v_pk_fma_f32 v[92:93], v[46:47], v[2:3], s[66:67]
  v_pk_fma_f32 v[88:89], v[28:29], v[100:101], v[88:89]
  v_pk_fma_f32 v[92:93], v[30:31], v[102:103], v[92:93]
  v_pk_mul_f32 v[90:91], v[88:89], s[64:65]
  v_pk_mul_f32 v[94:95], v[92:93], s[64:65]
  v_exp_f32 v90, v90 clamp
  v_exp_f32 v91, v91 clamp
  v_exp_f32 v94, v94 clamp
  v_exp_f32 v95, v95 clamp
  v_max_f32 v88, s66, v88
  v_max_f32 v89, s66, v89
  v_max_f32 v92, s66, v92
  v_max_f32 v93, s66, v93
  v_pk_add_f32 v[88:89], v[88:89], v[90:91]
  v_pk_add_f32 v[92:93], v[92:93], v[94:95]
  v_cvt_pk_bf16_f32 v74, v88, v89
  v_cvt_pk_bf16_f32 v75, v92, v93
  v_cvt_pk_bf16_f32 v82, v172, v173
  v_cvt_pk_bf16_f32 v83, v174, v175
  s_nop 1
  v_mfma_f32_16x16x32_bf16 v[144:147], v[80:83], v[72:75], 0
  v_mfma_f32_16x16x32_bf16 v[148:151], v[152:155], v[72:75], 0
  s_waitcnt lgkmcnt(10)
  v_pk_mul_f32 v[172:173], v[48:49], v[4:5]
  v_pk_mul_f32 v[174:175], v[50:51], v[4:5]
  v_pk_fma_f32 v[172:173], v[32:33], v[120:121], v[172:173]
  v_pk_fma_f32 v[174:175], v[34:35], v[122:123], v[174:175]
  v_pk_fma_f32 v[88:89], v[48:49], v[2:3], s[66:67]
  v_pk_fma_f32 v[92:93], v[50:51], v[2:3], s[66:67]
  v_pk_fma_f32 v[88:89], v[32:33], v[104:105], v[88:89]
  v_pk_fma_f32 v[92:93], v[34:35], v[106:107], v[92:93]
  v_pk_mul_f32 v[90:91], v[88:89], s[64:65]
  v_pk_mul_f32 v[94:95], v[92:93], s[64:65]
  v_exp_f32 v90, v90 clamp
  v_exp_f32 v91, v91 clamp
  v_exp_f32 v94, v94 clamp
  v_exp_f32 v95, v95 clamp
  v_max_f32 v88, s66, v88
  v_max_f32 v89, s66, v89
  v_max_f32 v92, s66, v92
  v_max_f32 v93, s66, v93
  v_pk_add_f32 v[88:89], v[88:89], v[90:91]
  v_pk_add_f32 v[92:93], v[92:93], v[94:95]
  v_cvt_pk_bf16_f32 v76, v88, v89
  v_cvt_pk_bf16_f32 v77, v92, v93
  v_cvt_pk_bf16_f32 v84, v172, v173
  v_cvt_pk_bf16_f32 v85, v174, v175
  s_waitcnt lgkmcnt(8)
  v_pk_mul_f32 v[172:173], v[52:53], v[4:5]
  v_pk_mul_f32 v[174:175], v[54:55], v[4:5]
  v_pk_fma_f32 v[172:173], v[36:37], v[124:125], v[172:173]
  v_pk_fma_f32 v[174:175], v[38:39], v[126:127], v[174:175]
  v_pk_fma_f32 v[88:89], v[52:53], v[2:3], s[66:67]
  v_pk_fma_f32 v[92:93], v[54:55], v[2:3], s[66:67]
  v_pk_fma_f32 v[88:89], v[36:37], v[108:109], v[88:89]
  v_pk_fma_f32 v[92:93], v[38:39], v[110:111], v[92:93]
  v_pk_mul_f32 v[90:91], v[88:89], s[64:65]
  v_pk_mul_f32 v[94:95], v[92:93], s[64:65]
  v_exp_f32 v90, v90 clamp
  v_exp_f32 v91, v91 clamp
  v_exp_f32 v94, v94 clamp
  v_exp_f32 v95, v95 clamp
  v_max_f32 v88, s66, v88
  v_max_f32 v89, s66, v89
  v_max_f32 v92, s66, v92
  v_max_f32 v93, s66, v93
  v_pk_add_f32 v[88:89], v[88:89], v[90:91]
  v_pk_add_f32 v[92:93], v[92:93], v[94:95]
  v_cvt_pk_bf16_f32 v78, v88, v89
  v_cvt_pk_bf16_f32 v79, v92, v93
  v_cvt_pk_bf16_f32 v86, v172, v173
  v_cvt_pk_bf16_f32 v87, v174, v175
  s_nop 1
  v_mfma_f32_16x16x32_bf16 v[144:147], v[84:87], v[76:79], v[144:147]
  v_mfma_f32_16x16x32_bf16 v[148:151], v[152:155], v[76:79], v[148:151]
  s_waitcnt lgkmcnt(0)
  s_nop 5
  buffer_store_dword v144, v169, s[36:39], s6 offen offset:0 sc1
  buffer_store_dword v145, v169, s[36:39], s6 offen offset:64 sc1
  buffer_store_dword v146, v169, s[36:39], s6 offen offset:128 sc1
  buffer_store_dword v147, v169, s[36:39], s6 offen offset:192 sc1
  s_mov_b64 exec, 0xffff
  buffer_store_dword v148, v183, s[36:39], s6 offen offset:1024 sc1
  s_mov_b64 exec, -1
  ds_read_b64_tr_b16 v[64:65], v12 offset:0
  ds_read_b64_tr_b16 v[66:67], v12 offset:2048
  ds_read_b64_tr_b16 v[68:69], v13 offset:0
  ds_read_b64_tr_b16 v[70:71], v13 offset:2048
  ds_read_b64_tr_b16 v[72:73], v14 offset:0
  ds_read_b64_tr_b16 v[74:75], v14 offset:2048
  ds_read_b64_tr_b16 v[76:77], v15 offset:0
  ds_read_b64_tr_b16 v[78:79], v15 offset:2048
  ds_read_b64_tr_b16 v[80:81], v12 offset:4096
  ds_read_b64_tr_b16 v[82:83], v12 offset:6144
  ds_read_b64_tr_b16 v[84:85], v13 offset:4096
  ds_read_b64_tr_b16 v[86:87], v13 offset:6144
  ds_read_b64_tr_b16 v[88:89], v14 offset:4096
  ds_read_b64_tr_b16 v[90:91], v14 offset:6144
  ds_read_b64_tr_b16 v[92:93], v15 offset:4096
  ds_read_b64_tr_b16 v[94:95], v15 offset:6144
  s_waitcnt lgkmcnt(8)
  v_mfma_f32_16x16x32_bf16 v[128:131], a[128:131], v[64:67], 0
  ds_read_b64_tr_b16 v[112:113], v12 offset:8192
  ds_read_b64_tr_b16 v[114:115], v12 offset:10240
  v_mfma_f32_16x16x32_bf16 v[132:135], a[128:131], v[68:71], 0
  ds_read_b64_tr_b16 v[116:117], v13 offset:8192
  ds_read_b64_tr_b16 v[118:119], v13 offset:10240
  v_mfma_f32_16x16x32_bf16 v[136:139], a[128:131], v[72:75], 0
  ds_read_b64_tr_b16 v[120:121], v14 offset:8192
  ds_read_b64_tr_b16 v[122:123], v14 offset:10240
  v_mfma_f32_16x16x32_bf16 v[140:143], a[128:131], v[76:79], 0
  ds_read_b64_tr_b16 v[124:125], v15 offset:8192
  ds_read_b64_tr_b16 v[126:127], v15 offset:10240
  s_waitcnt lgkmcnt(8)
  v_mfma_f32_16x16x32_bf16 v[128:131], a[132:135], v[80:83], v[128:131]
  ds_read_b64_tr_b16 v[64:65], v12 offset:12288
  ds_read_b64_tr_b16 v[66:67], v12 offset:14336
  v_mfma_f32_16x16x32_bf16 v[132:135], a[132:135], v[84:87], v[132:135]
  ds_read_b64_tr_b16 v[68:69], v13 offset:12288
  ds_read_b64_tr_b16 v[70:71], v13 offset:14336
  v_mfma_f32_16x16x32_bf16 v[136:139], a[132:135], v[88:91], v[136:139]
  ds_read_b64_tr_b16 v[72:73], v14 offset:12288
  ds_read_b64_tr_b16 v[74:75], v14 offset:14336
  v_mfma_f32_16x16x32_bf16 v[140:143], a[132:135], v[92:95], v[140:143]
  ds_read_b64_tr_b16 v[76:77], v15 offset:12288
  ds_read_b64_tr_b16 v[78:79], v15 offset:14336
  s_waitcnt lgkmcnt(8)
  v_mfma_f32_16x16x32_bf16 v[128:131], a[136:139], v[112:115], v[128:131]
  ds_read_b64_tr_b16 v[80:81], v12 offset:16384
  ds_read_b64_tr_b16 v[82:83], v12 offset:18432
  v_mfma_f32_16x16x32_bf16 v[132:135], a[136:139], v[116:119], v[132:135]
  ds_read_b64_tr_b16 v[84:85], v13 offset:16384
  ds_read_b64_tr_b16 v[86:87], v13 offset:18432
  v_mfma_f32_16x16x32_bf16 v[136:139], a[136:139], v[120:123], v[136:139]
  ds_read_b64_tr_b16 v[88:89], v14 offset:16384
  ds_read_b64_tr_b16 v[90:91], v14 offset:18432
  v_mfma_f32_16x16x32_bf16 v[140:143], a[136:139], v[124:127], v[140:143]
  ds_read_b64_tr_b16 v[92:93], v15 offset:16384
  ds_read_b64_tr_b16 v[94:95], v15 offset:18432
  s_waitcnt lgkmcnt(8)
  v_mfma_f32_16x16x32_bf16 v[128:131], a[140:143], v[64:67], v[128:131]
  ds_read_b64_tr_b16 v[112:113], v12 offset:20480
  ds_read_b64_tr_b16 v[114:115], v12 offset:22528
  v_mfma_f32_16x16x32_bf16 v[132:135], a[140:143], v[68:71], v[132:135]
  ds_read_b64_tr_b16 v[116:117], v13 offset:20480
  ds_read_b64_tr_b16 v[118:119], v13 offset:22528
  v_mfma_f32_16x16x32_bf16 v[136:139], a[140:143], v[72:75], v[136:139]
  ds_read_b64_tr_b16 v[120:121], v14 offset:20480
  ds_read_b64_tr_b16 v[122:123], v14 offset:22528
  v_mfma_f32_16x16x32_bf16 v[140:143], a[140:143], v[76:79], v[140:143]
  ds_read_b64_tr_b16 v[124:125], v15 offset:20480
  ds_read_b64_tr_b16 v[126:127], v15 offset:22528
  s_waitcnt lgkmcnt(8)
  v_mfma_f32_16x16x32_bf16 v[128:131], a[144:147], v[80:83], v[128:131]
  ds_read_b64_tr_b16 v[64:65], v12 offset:24576
  ds_read_b64_tr_b16 v[66:67], v12 offset:26624
  v_mfma_f32_16x16x32_bf16 v[132:135], a[144:147], v[84:87], v[132:135]
  ds_read_b64_tr_b16 v[68:69], v13 offset:24576
  ds_read_b64_tr_b16 v[70:71], v13 offset:26624
  v_mfma_f32_16x16x32_bf16 v[136:139], a[144:147], v[88:91], v[136:139]
  ds_read_b64_tr_b16 v[72:73], v14 offset:24576
  ds_read_b64_tr_b16 v[74:75], v14 offset:26624
  v_mfma_f32_16x16x32_bf16 v[140:143], a[144:147], v[92:95], v[140:143]
  ds_read_b64_tr_b16 v[76:77], v15 offset:24576
  ds_read_b64_tr_b16 v[78:79], v15 offset:26624
  s_waitcnt lgkmcnt(8)
  v_mfma_f32_16x16x32_bf16 v[128:131], a[148:151], v[112:115], v[128:131]
  ds_read_b64_tr_b16 v[80:81], v12 offset:28672
  ds_read_b64_tr_b16 v[82:83], v12 offset:30720
  v_mfma_f32_16x16x32_bf16 v[132:135], a[148:151], v[116:119], v[132:135]
  ds_read_b64_tr_b16 v[84:85], v13 offset:28672
  ds_read_b64_tr_b16 v[86:87], v13 offset:30720
  v_mfma_f32_16x16x32_bf16 v[136:139], a[148:151], v[120:123], v[136:139]
  ds_read_b64_tr_b16 v[88:89], v14 offset:28672
  ds_read_b64_tr_b16 v[90:91], v14 offset:30720
  v_mfma_f32_16x16x32_bf16 v[140:143], a[148:151], v[124:127], v[140:143]
  ds_read_b64_tr_b16 v[92:93], v15 offset:28672
  ds_read_b64_tr_b16 v[94:95], v15 offset:30720
  s_waitcnt lgkmcnt(8)
  v_mfma_f32_16x16x32_bf16 v[128:131], a[152:155], v[64:67], v[128:131]
  ds_read_b64_tr_b16 v[112:113], v12 offset:32768
  ds_read_b64_tr_b16 v[114:115], v12 offset:34816
  v_mfma_f32_16x16x32_bf16 v[132:135], a[152:155], v[68:71], v[132:135]
  ds_read_b64_tr_b16 v[116:117], v13 offset:32768
  ds_read_b64_tr_b16 v[118:119], v13 offset:34816
  v_mfma_f32_16x16x32_bf16 v[136:139], a[152:155], v[72:75], v[136:139]
  ds_read_b64_tr_b16 v[120:121], v14 offset:32768
  ds_read_b64_tr_b16 v[122:123], v14 offset:34816
  v_mfma_f32_16x16x32_bf16 v[140:143], a[152:155], v[76:79], v[140:143]
  ds_read_b64_tr_b16 v[124:125], v15 offset:32768
  ds_read_b64_tr_b16 v[126:127], v15 offset:34816
  s_waitcnt lgkmcnt(8)
  v_mfma_f32_16x16x32_bf16 v[128:131], a[156:159], v[80:83], v[128:131]
  ds_read_b64_tr_b16 v[64:65], v12 offset:36864
  ds_read_b64_tr_b16 v[66:67], v12 offset:38912
  v_mfma_f32_16x16x32_bf16 v[132:135], a[156:159], v[84:87], v[132:135]
  ds_read_b64_tr_b16 v[68:69], v13 offset:36864
  ds_read_b64_tr_b16 v[70:71], v13 offset:38912
  v_mfma_f32_16x16x32_bf16 v[136:139], a[156:159], v[88:91], v[136:139]
  ds_read_b64_tr_b16 v[72:73], v14 offset:36864
  ds_read_b64_tr_b16 v[74:75], v14 offset:38912
  v_mfma_f32_16x16x32_bf16 v[140:143], a[156:159], v[92:95], v[140:143]
  ds_read_b64_tr_b16 v[76:77], v15 offset:36864
  ds_read_b64_tr_b16 v[78:79], v15 offset:38912
  s_waitcnt lgkmcnt(8)
  v_mfma_f32_16x16x32_bf16 v[128:131], a[160:163], v[112:115], v[128:131]
  ds_read_b64_tr_b16 v[80:81], v12 offset:40960
  ds_read_b64_tr_b16 v[82:83], v12 offset:43008
  v_mfma_f32_16x16x32_bf16 v[132:135], a[160:163], v[116:119], v[132:135]
  ds_read_b64_tr_b16 v[84:85], v13 offset:40960
  ds_read_b64_tr_b16 v[86:87], v13 offset:43008
  v_mfma_f32_16x16x32_bf16 v[136:139], a[160:163], v[120:123], v[136:139]
  ds_read_b64_tr_b16 v[88:89], v14 offset:40960
  ds_read_b64_tr_b16 v[90:91], v14 offset:43008
  v_mfma_f32_16x16x32_bf16 v[140:143], a[160:163], v[124:127], v[140:143]
  ds_read_b64_tr_b16 v[92:93], v15 offset:40960
  ds_read_b64_tr_b16 v[94:95], v15 offset:43008
  s_waitcnt lgkmcnt(8)
  v_mfma_f32_16x16x32_bf16 v[128:131], a[164:167], v[64:67], v[128:131]
  ds_read_b64_tr_b16 v[112:113], v12 offset:45056
  ds_read_b64_tr_b16 v[114:115], v12 offset:47104
  v_mfma_f32_16x16x32_bf16 v[132:135], a[164:167], v[68:71], v[132:135]
  ds_read_b64_tr_b16 v[116:117], v13 offset:45056
  ds_read_b64_tr_b16 v[118:119], v13 offset:47104
  v_mfma_f32_16x16x32_bf16 v[136:139], a[164:167], v[72:75], v[136:139]
  ds_read_b64_tr_b16 v[120:121], v14 offset:45056
  ds_read_b64_tr_b16 v[122:123], v14 offset:47104
  v_mfma_f32_16x16x32_bf16 v[140:143], a[164:167], v[76:79], v[140:143]
  ds_read_b64_tr_b16 v[124:125], v15 offset:45056
  ds_read_b64_tr_b16 v[126:127], v15 offset:47104
  s_waitcnt lgkmcnt(8)
  v_mfma_f32_16x16x32_bf16 v[128:131], a[168:171], v[80:83], v[128:131]
  ds_read_b64_tr_b16 v[64:65], v12 offset:49152
  ds_read_b64_tr_b16 v[66:67], v12 offset:51200
  v_mfma_f32_16x16x32_bf16 v[132:135], a[168:171], v[84:87], v[132:135]
  ds_read_b64_tr_b16 v[68:69], v13 offset:49152
  ds_read_b64_tr_b16 v[70:71], v13 offset:51200
  v_mfma_f32_16x16x32_bf16 v[136:139], a[168:171], v[88:91], v[136:139]
  ds_read_b64_tr_b16 v[72:73], v14 offset:49152
  ds_read_b64_tr_b16 v[74:75], v14 offset:51200
  v_mfma_f32_16x16x32_bf16 v[140:143], a[168:171], v[92:95], v[140:143]
  ds_read_b64_tr_b16 v[76:77], v15 offset:49152
  ds_read_b64_tr_b16 v[78:79], v15 offset:51200
  s_waitcnt lgkmcnt(8)
  s_cmp_eq_u32 s41, 0
  s_cbranch_scc1 L_rl_67
  s_add_u32 s58, s3, 0
  buffer_load_dwordx4 v[24:27], v170, s[36:39], s58 offen sc1
  s_add_u32 s58, s3, 36864
  buffer_load_dwordx4 v[28:31], v170, s[36:39], s58 offen sc1
  s_add_u32 s58, s3, 73728
  buffer_load_dwordx4 v[32:35], v170, s[36:39], s58 offen sc1
  s_add_u32 s58, s3, 110592
  buffer_load_dwordx4 v[36:39], v170, s[36:39], s58 offen sc1
L_rl_67:
  v_mfma_f32_16x16x32_bf16 v[128:131], a[172:175], v[112:115], v[128:131]
  ds_read_b64_tr_b16 v[80:81], v12 offset:53248
  ds_read_b64_tr_b16 v[82:83], v12 offset:55296
  v_mfma_f32_16x16x32_bf16 v[132:135], a[172:175], v[116:119], v[132:135]
  ds_read_b64_tr_b16 v[84:85], v13 offset:53248
  ds_read_b64_tr_b16 v[86:87], v13 offset:55296
  v_mfma_f32_16x16x32_bf16 v[136:139], a[172:175], v[120:123], v[136:139]
  ds_read_b64_tr_b16 v[88:89], v14 offset:53248
  ds_read_b64_tr_b16 v[90:91], v14 offset:55296
  v_mfma_f32_16x16x32_bf16 v[140:143], a[172:175], v[124:127], v[140:143]
  ds_read_b64_tr_b16 v[92:93], v15 offset:53248
  ds_read_b64_tr_b16 v[94:95], v15 offset:55296
  s_waitcnt lgkmcnt(8)
  v_mfma_f32_16x16x32_bf16 v[128:131], a[176:179], v[64:67], v[128:131]
  ds_read_b64_tr_b16 v[112:113], v12 offset:57344
  ds_read_b64_tr_b16 v[114:115], v12 offset:59392
  v_mfma_f32_16x16x32_bf16 v[132:135], a[176:179], v[68:71], v[132:135]
  ds_read_b64_tr_b16 v[116:117], v13 offset:57344
  ds_read_b64_tr_b16 v[118:119], v13 offset:59392
  v_mfma_f32_16x16x32_bf16 v[136:139], a[176:179], v[72:75], v[136:139]
  ds_read_b64_tr_b16 v[120:121], v14 offset:57344
  ds_read_b64_tr_b16 v[122:123], v14 offset:59392
  v_mfma_f32_16x16x32_bf16 v[140:143], a[176:179], v[76:79], v[140:143]
  ds_read_b64_tr_b16 v[124:125], v15 offset:57344
  ds_read_b64_tr_b16 v[126:127], v15 offset:59392
  s_waitcnt lgkmcnt(8)
  v_mfma_f32_16x16x32_bf16 v[128:131], a[180:183], v[80:83], v[128:131]
  ds_read_b64_tr_b16 v[64:65], v12 offset:61440
  ds_read_b64_tr_b16 v[66:67], v12 offset:63488
  v_mfma_f32_16x16x32_bf16 v[132:135], a[180:183], v[84:87], v[132:135]
  ds_read_b64_tr_b16 v[68:69], v13 offset:61440
  ds_read_b64_tr_b16 v[70:71], v13 offset:63488
  v_mfma_f32_16x16x32_bf16 v[136:139], a[180:183], v[88:91], v[136:139]
  ds_read_b64_tr_b16 v[72:73], v14 offset:61440
  ds_read_b64_tr_b16 v[74:75], v14 offset:63488
  v_mfma_f32_16x16x32_bf16 v[140:143], a[180:183], v[92:95], v[140:143]
  ds_read_b64_tr_b16 v[76:77], v15 offset:61440
  ds_read_b64_tr_b16 v[78:79], v15 offset:63488
  s_waitcnt lgkmcnt(8)
  v_mfma_f32_16x16x32_bf16 v[128:131], a[184:187], v[112:115], v[128:131]
  v_mfma_f32_16x16x32_bf16 v[132:135], a[184:187], v[116:119], v[132:135]
  v_mfma_f32_16x16x32_bf16 v[136:139], a[184:187], v[120:123], v[136:139]
  v_mfma_f32_16x16x32_bf16 v[140:143], a[184:187], v[124:127], v[140:143]
  s_waitcnt lgkmcnt(0)
  v_mfma_f32_16x16x32_bf16 v[128:131], a[188:191], v[64:67], v[128:131]
  v_mfma_f32_16x16x32_bf16 v[132:135], a[188:191], v[68:71], v[132:135]
  v_mfma_f32_16x16x32_bf16 v[136:139], a[188:191], v[72:75], v[136:139]
  v_mfma_f32_16x16x32_bf16 v[140:143], a[188:191], v[76:79], v[140:143]
  v_pk_fma_f32 v[64:65], v[176:177], v[6:7], s[66:67] op_sel_hi:[0,1,1]
  v_pk_fma_f32 v[68:69], v[176:177], v[8:9], s[66:67] op_sel_hi:[0,1,1]
  v_pk_fma_f32 v[72:73], v[178:179], v[6:7], s[66:67] op_sel_hi:[0,1,1]
  v_pk_fma_f32 v[76:77], v[178:179], v[8:9], s[66:67] op_sel_hi:[0,1,1]
  s_nop 0
  v_pk_fma_f32 v[64:65], v[56:57], v[128:129], v[64:65] op_sel_hi:[0,1,1]
  v_pk_fma_f32 v[68:69], v[56:57], v[130:131], v[68:69] op_sel_hi:[0,1,1]
  v_pk_fma_f32 v[72:73], v[58:59], v[132:133], v[72:73] op_sel_hi:[0,1,1]
  v_pk_fma_f32 v[76:77], v[58:59], v[134:135], v[76:77] op_sel_hi:[0,1,1]
  v_pk_mul_f32 v[66:67], v[64:65], s[64:65]
  v_pk_mul_f32 v[70:71], v[68:69], s[64:65]
  v_pk_mul_f32 v[74:75], v[72:73], s[64:65]
  v_pk_mul_f32 v[78:79], v[76:77], s[64:65]
  v_exp_f32 v66, v66 clamp
  v_exp_f32 v67, v67 clamp
  v_exp_f32 v70, v70 clamp
  v_exp_f32 v71, v71 clamp
  v_exp_f32 v74, v74 clamp
  v_exp_f32 v75, v75 clamp
  v_exp_f32 v78, v78 clamp
  v_exp_f32 v79, v79 clamp
  v_max_f32 v64, s66, v64
  v_max_f32 v65, s66, v65
  v_max_f32 v68, s66, v68
  v_max_f32 v69, s66, v69
  v_max_f32 v72, s66, v72
  v_max_f32 v73, s66, v73
  v_max_f32 v76, s66, v76
  v_max_f32 v77, s66, v77
  v_pk_add_f32 v[64:65], v[64:65], v[66:67]
  v_pk_add_f32 v[68:69], v[68:69], v[70:71]
  v_pk_add_f32 v[72:73], v[72:73], v[74:75]
  v_pk_add_f32 v[76:77], v[76:77], v[78:79]
  v_cvt_pk_bf16_f32 v96, v64, v65
  v_cvt_pk_bf16_f32 v97, v68, v69
  v_cvt_pk_bf16_f32 v98, v72, v73
  v_cvt_pk_bf16_f32 v99, v76, v77
  v_pk_fma_f32 v[64:65], v[180:181], v[6:7], s[66:67] op_sel_hi:[0,1,1]
  v_pk_fma_f32 v[68:69], v[180:181], v[8:9], s[66:67] op_sel_hi:[0,1,1]
  v_pk_fma_f32 v[72:73], v[182:183], v[6:7], s[66:67] op_sel_hi:[0,1,1]
  v_pk_fma_f32 v[76:77], v[182:183], v[8:9], s[66:67] op_sel_hi:[0,1,1]
  v_pk_fma_f32 v[64:65], v[60:61], v[136:137], v[64:65] op_sel_hi:[0,1,1]
  v_pk_fma_f32 v[68:69], v[60:61], v[138:139], v[68:69] op_sel_hi:[0,1,1]
  v_pk_fma_f32 v[72:73], v[62:63], v[140:141], v[72:73] op_sel_hi:[0,1,1]
  v_pk_fma_f32 v[76:77], v[62:63], v[142:143], v[76:77] op_sel_hi:[0,1,1]
  v_pk_mul_f32 v[66:67], v[64:65], s[64:65]
  v_pk_mul_f32 v[70:71], v[68:69], s[64:65]
  v_pk_mul_f32 v[74:75], v[72:73], s[64:65]
  v_pk_mul_f32 v[78:79], v[76:77], s[64:65]
  v_exp_f32 v66, v66 clamp
  v_exp_f32 v67, v67 clamp
  v_exp_f32 v70, v70 clamp
  v_exp_f32 v71, v71 clamp
  v_exp_f32 v74, v74 clamp
  v_exp_f32 v75, v75 clamp
  v_exp_f32 v78, v78 clamp
  v_exp_f32 v79, v79 clamp
  v_max_f32 v64, s66, v64
  v_max_f32 v65, s66, v65
  v_max_f32 v68, s66, v68
  v_max_f32 v69, s66, v69
  v_max_f32 v72, s66, v72
  v_max_f32 v73, s66, v73
  v_max_f32 v76, s66, v76
  v_max_f32 v77, s66, v77
  v_pk_add_f32 v[64:65], v[64:65], v[66:67]
  v_pk_add_f32 v[68:69], v[68:69], v[70:71]
  v_pk_add_f32 v[72:73], v[72:73], v[74:75]
  v_pk_add_f32 v[76:77], v[76:77], v[78:79]
  v_cvt_pk_bf16_f32 v100, v64, v65
  v_cvt_pk_bf16_f32 v101, v68, v69
  v_cvt_pk_bf16_f32 v102, v72, v73
  v_cvt_pk_bf16_f32 v103, v76, v77
  s_lshl_b32 s56, s68, 2
  s_add_u32 s56, s56, s7
  buffer_store_dwordx2 v[96:97], v168, s[36:39], s56 offen sc1
  s_lshl_b32 s56, s69, 2
  s_add_u32 s56, s56, s7
  buffer_store_dwordx2 v[98:99], v168, s[36:39], s56 offen sc1
  s_lshl_b32 s56, s70, 2
  s_add_u32 s56, s56, s7
  buffer_store_dwordx2 v[100:101], v168, s[36:39], s56 offen sc1
  s_lshl_b32 s56, s71, 2
  s_add_u32 s56, s56, s7
  buffer_store_dwordx2 v[102:103], v168, s[36:39], s56 offen sc1
  s_cmp_eq_u32 s41, 0
  s_cbranch_scc1 L_red_68
  s_waitcnt vmcnt(4)
  s_branch L_r0_71
L_rp_69:
  s_add_u32 s58, s3, 0
  buffer_load_dwordx4 v[24:27], v170, s[36:39], s58 offen sc1
  s_add_u32 s58, s3, 36864
  buffer_load_dwordx4 v[28:31], v170, s[36:39], s58 offen sc1
  s_add_u32 s58, s3, 73728
  buffer_load_dwordx4 v[32:35], v170, s[36:39], s58 offen sc1
  s_add_u32 s58, s3, 110592
  buffer_load_dwordx4 v[36:39], v170, s[36:39], s58 offen sc1
  s_waitcnt vmcnt(0)
L_r0_71:
  v_max3_u32 v56, v24, v28, v32
  v_max_u32 v56, v56, v36
  v_cmp_eq_u32 vcc, -1, v56
  s_cbranch_vccz L_rg_70
  s_sleep 2
  s_sub_u32 s52, s52, 1
  s_cbranch_scc0 L_rp_69
  s_mov_b32 s52, 0
L_rg_70:
  v_pk_add_f32 v[24:25], v[24:25], v[28:29]
  v_pk_add_f32 v[26:27], v[26:27], v[30:31]
  v_pk_add_f32 v[32:33], v[32:33], v[36:37]
  v_pk_add_f32 v[34:35], v[34:35], v[38:39]
  v_pk_add_f32 v[24:25], v[24:25], v[32:33]
  v_pk_add_f32 v[26:27], v[26:27], v[34:35]
  s_nop 0
  v_add_f32_dpp v24, v24, v24 row_ror:8 row_mask:0xf bank_mask:0xf
  v_add_f32_dpp v25, v25, v25 row_ror:8 row_mask:0xf bank_mask:0xf
  v_add_f32_dpp v26, v26, v26 row_ror:8 row_mask:0xf bank_mask:0xf
  v_add_f32_dpp v27, v27, v27 row_ror:8 row_mask:0xf bank_mask:0xf
  v_mov_b32 v28, v24
  v_mov_b32 v29, v25
  v_mov_b32 v30, v26
  v_mov_b32 v31, v27
  v_permlane16_swap_b32 v24, v28
  v_permlane16_swap_b32 v25, v29
  v_permlane16_swap_b32 v26, v30
  v_permlane16_swap_b32 v27, v31
  v_add_f32 v24, v24, v28
  v_add_f32 v25, v25, v29
  v_add_f32 v26, v26, v30
  v_add_f32 v27, v27, v31
  v_mov_b32 v28, v24
  v_mov_b32 v29, v25
  v_mov_b32 v30, v26
  v_mov_b32 v31, v27
  v_permlane32_swap_b32 v24, v28
  v_permlane32_swap_b32 v25, v29
  v_permlane32_swap_b32 v26, v30
  v_permlane32_swap_b32 v27, v31
  v_add_f32 v24, v24, v28
  v_add_f32 v25, v25, v29
  v_add_f32 v26, v26, v30
  v_add_f32 v27, v27, v31
  v_cvt_pk_bf16_f32 v28, v24, v25
  v_cvt_pk_bf16_f32 v29, v26, v27
  s_mov_b64 exec, s[42:43]
  buffer_store_dwordx2 v[28:29], v171, s[36:39], s40 offen sc1
  s_mov_b64 exec, -1
L_red_68:
  v_and_b32 v10, 31, v1
  v_min_u32 v10, 16, v10
  v_lshlrev_b32 v10, 5, v10
  v_lshrrev_b32 v11, 5, v1
  v_lshl_add_u32 v10, v11, 4, v10
  s_lshl_b32 s54, s44, 3
  s_mul_i32 s4, s54, 640
  s_add_u32 s4, s4, 18087936
  s_mul_i32 s55, s45, 20608
  s_add_u32 s4, s4, s55
  v_and_b32 v11, 31, v1
  v_lshlrev_b32 v11, 4, v11
  v_lshrrev_b32 v12, 5, v1
  v_lshl_add_u32 v11, v12, 10, v11
  s_mul_i32 s5, s54, 65792
  s_add_u32 s5, s5, 13697024
  s_lshl_b32 s57, s48, 11
  s_add_u32 s5, s5, s57
  s_and_b32 s57, s50, 1
  s_lshl_b32 s57, s57, 9
  s_add_u32 s5, s5, s57
  s_mul_i32 s3, s44, 5120
  s_add_u32 s3, s3, 99328
  v_add_u32 v10, s3, v10
  v_lshlrev_b32 v19, 4, v1
  s_lshl_b32 s54, s44, 13
  s_add_u32 s54, s54, 66560
  v_lshl_add_u32 v12, v1, 4, s54
  v_lshlrev_b32 v13, 4, v1
  v_add_u32 v13, 66560, v13
  v_and_b32 v14, 31, v1
  v_lshlrev_b32 v14, 10, v14
  v_lshrrev_b32 v15, 5, v1
  v_lshl_add_u32 v14, v15, 5, v14
  s_lshl_b32 s54, s50, 15
  s_lshl_b32 s55, s51, 8
  s_add_u32 s54, s54, s55
  s_lshl_b32 s55, s44, 6
  s_add_u32 s54, s54, s55
  v_add_u32 v14, s54, v14
  s_barrier
  s_add_u32 s57, s5, 0
  buffer_load_dwordx4 v[56:59], v11, s[36:39], s57 offen sc1
  s_add_u32 s57, s5, 65792
  buffer_load_dwordx4 v[60:63], v11, s[36:39], s57 offen sc1
  s_add_u32 s57, s5, 131584
  buffer_load_dwordx4 v[64:67], v11, s[36:39], s57 offen sc1
  s_add_u32 s57, s5, 197376
  buffer_load_dwordx4 v[68:71], v11, s[36:39], s57 offen sc1
  s_add_u32 s57, s5, 263168
  buffer_load_dwordx4 v[72:75], v11, s[36:39], s57 offen sc1
  s_add_u32 s57, s5, 328960
  buffer_load_dwordx4 v[76:79], v11, s[36:39], s57 offen sc1
  s_add_u32 s57, s5, 394752
  buffer_load_dwordx4 v[80:83], v11, s[36:39], s57 offen sc1
  s_add_u32 s57, s5, 460544
  buffer_load_dwordx4 v[84:87], v11, s[36:39], s57 offen sc1
  s_sleep 4
L_of_72:
  s_add_u32 s57, s4, 0
  s_add_u32 m0, s3, 0
  s_nop 0
  buffer_load_dwordx4 v19, s[36:39], s57 offen sc1 lds
  s_add_u32 s57, s4, 1024
  s_add_u32 m0, s3, 1024
  s_nop 0
  buffer_load_dwordx4 v19, s[36:39], s57 offen sc1 lds
  s_add_u32 s57, s4, 2048
  s_add_u32 m0, s3, 2048
  s_nop 0
  buffer_load_dwordx4 v19, s[36:39], s57 offen sc1 lds
  s_add_u32 s57, s4, 3072
  s_add_u32 m0, s3, 3072
  s_nop 0
  buffer_load_dwordx4 v19, s[36:39], s57 offen sc1 lds
  s_add_u32 s57, s4, 4096
  s_add_u32 m0, s3, 4096
  s_nop 0
  buffer_load_dwordx4 v19, s[36:39], s57 offen sc1 lds
  s_waitcnt vmcnt(0)
  ds_read_b128 v[24:27], v10 offset:0
  ds_read_b128 v[28:31], v10 offset:640
  ds_read_b128 v[32:35], v10 offset:1280
  ds_read_b128 v[36:39], v10 offset:1920
  ds_read_b128 v[40:43], v10 offset:2560
  ds_read_b128 v[44:47], v10 offset:3200
  ds_read_b128 v[48:51], v10 offset:3840
  ds_read_b128 v[52:55], v10 offset:4480
  s_waitcnt lgkmcnt(0)
  v_max3_u32 v18, v24, v26, v28
  v_max3_u32 v18, v18, v30, v32
  v_max3_u32 v18, v18, v34, v36
  v_max3_u32 v18, v18, v38, v40
  v_max3_u32 v18, v18, v42, v44
  v_max3_u32 v18, v18, v46, v48
  v_max3_u32 v18, v18, v50, v52
  v_max_u32 v18, v18, v54
  v_cmp_eq_u32 vcc, -1, v18
  s_cbranch_vccz L_ofk_73
  s_sleep 2
  s_sub_u32 s52, s52, 1
  s_cbranch_scc0 L_of_72
  s_mov_b32 s52, 0
L_ofk_73:
L_oq_74:
  v_max3_u32 v18, v56, v58, v60
  v_max3_u32 v18, v18, v62, v64
  v_max3_u32 v18, v18, v66, v68
  v_max3_u32 v18, v18, v70, v72
  v_max3_u32 v18, v18, v74, v76
  v_max3_u32 v18, v18, v78, v80
  v_max3_u32 v18, v18, v82, v84
  v_max_u32 v18, v18, v86
  v_cmp_eq_u32 vcc, -1, v18
  s_cbranch_vccz L_oqk_75
  s_sub_u32 s52, s52, 1
  s_cbranch_scc1 L_oqk_75_x
  s_add_u32 s57, s5, 0
  buffer_load_dwordx4 v[56:59], v11, s[36:39], s57 offen sc1
  s_add_u32 s57, s5, 65792
  buffer_load_dwordx4 v[60:63], v11, s[36:39], s57 offen sc1
  s_add_u32 s57, s5, 131584
  buffer_load_dwordx4 v[64:67], v11, s[36:39], s57 offen sc1
  s_add_u32 s57, s5, 197376
  buffer_load_dwordx4 v[68:71], v11, s[36:39], s57 offen sc1
  s_add_u32 s57, s5, 263168
  buffer_load_dwordx4 v[72:75], v11, s[36:39], s57 offen sc1
  s_add_u32 s57, s5, 328960
  buffer_load_dwordx4 v[76:79], v11, s[36:39], s57 offen sc1
  s_add_u32 s57, s5, 394752
  buffer_load_dwordx4 v[80:83], v11, s[36:39], s57 offen sc1
  s_add_u32 s57, s5, 460544
  buffer_load_dwordx4 v[84:87], v11, s[36:39], s57 offen sc1
  s_waitcnt vmcnt(0)
  s_branch L_oq_74
L_oqk_75_x:
  s_mov_b32 s52, 0
L_oqk_75:
  v_mfma_f32_32x32x16_bf16 v[88:103], v[24:27], v[56:59], 0
  v_mfma_f32_32x32x16_bf16 v[104:119], v[28:31], v[60:63], 0
  v_mfma_f32_32x32x16_bf16 v[120:135], v[32:35], v[64:67], 0
  v_mfma_f32_32x32x16_bf16 v[136:151], v[36:39], v[68:71], 0
  v_mfma_f32_32x32x16_bf16 v[152:167], v[40:43], v[72:75], 0
  v_mfma_f32_32x32x16_bf16 v[168:183], v[44:47], v[76:79], 0
  s_nop 6
  v_add_f32 v96, s66, v96
  v_add_f32 v112, s66, v112
  v_rcp_f32 v96, v96
  v_rcp_f32 v112, v112
  v_pk_mul_f32 v[88:89], v[88:89], v[96:97] op_sel_hi:[1,0]
  v_pk_mul_f32 v[104:105], v[104:105], v[112:113] op_sel_hi:[1,0]
  v_pk_mul_f32 v[90:91], v[90:91], v[96:97] op_sel_hi:[1,0]
  v_pk_mul_f32 v[106:107], v[106:107], v[112:113] op_sel_hi:[1,0]
  v_pk_mul_f32 v[92:93], v[92:93], v[96:97] op_sel_hi:[1,0]
  v_pk_mul_f32 v[108:109], v[108:109], v[112:113] op_sel_hi:[1,0]
  v_pk_mul_f32 v[94:95], v[94:95], v[96:97] op_sel_hi:[1,0]
  v_pk_mul_f32 v[110:111], v[110:111], v[112:113] op_sel_hi:[1,0]
  v_cvt_pk_bf16_f32 v98, v88, v89
  v_cvt_pk_bf16_f32 v99, v90, v91
  v_cvt_pk_bf16_f32 v100, v92, v93
  v_cvt_pk_bf16_f32 v101, v94, v95
  ds_write_b128 v12, v[98:101] offset:0
  v_cvt_pk_bf16_f32 v114, v104, v105
  v_cvt_pk_bf16_f32 v115, v106, v107
  v_cvt_pk_bf16_f32 v116, v108, v109
  v_cvt_pk_bf16_f32 v117, v110, v111
  ds_write_b128 v12, v[114:117] offset:1024
  v_mfma_f32_32x32x16_bf16 v[24:39], v[48:51], v[80:83], 0
  v_mfma_f32_32x32x16_bf16 v[56:71], v[52:55], v[84:87], 0
  v_add_f32 v128, s66, v128
  v_add_f32 v144, s66, v144
  v_rcp_f32 v128, v128
  v_rcp_f32 v144, v144
  v_pk_mul_f32 v[120:121], v[120:121], v[128:129] op_sel_hi:[1,0]
  v_pk_mul_f32 v[136:137], v[136:137], v[144:145] op_sel_hi:[1,0]
  v_pk_mul_f32 v[122:123], v[122:123], v[128:129] op_sel_hi:[1,0]
  v_pk_mul_f32 v[138:139], v[138:139], v[144:145] op_sel_hi:[1,0]
  v_pk_mul_f32 v[124:125], v[124:125], v[128:129] op_sel_hi:[1,0]
  v_pk_mul_f32 v[140:141], v[140:141], v[144:145] op_sel_hi:[1,0]
  v_pk_mul_f32 v[126:127], v[126:127], v[128:129] op_sel_hi:[1,0]
  v_pk_mul_f32 v[142:143], v[142:143], v[144:145] op_sel_hi:[1,0]
  v_cvt_pk_bf16_f32 v130, v120, v121
  v_cvt_pk_bf16_f32 v131, v122, v123
  v_cvt_pk_bf16_f32 v132, v124, v125
  v_cvt_pk_bf16_f32 v133, v126, v127
  ds_write_b128 v12, v[130:133] offset:2048
  v_cvt_pk_bf16_f32 v146, v136, v137
  v_cvt_pk_bf16_f32 v147, v138, v139
  v_cvt_pk_bf16_f32 v148, v140, v141
  v_cvt_pk_bf16_f32 v149, v142, v143
  ds_write_b128 v12, v[146:149] offset:3072
  v_add_f32 v160, s66, v160
  v_add_f32 v176, s66, v176
  v_rcp_f32 v160, v160
  v_rcp_f32 v176, v176
  v_pk_mul_f32 v[152:153], v[152:153], v[160:161] op_sel_hi:[1,0]
  v_pk_mul_f32 v[168:169], v[168:169], v[176:177] op_sel_hi:[1,0]
  v_pk_mul_f32 v[154:155], v[154:155], v[160:161] op_sel_hi:[1,0]
  v_pk_mul_f32 v[170:171], v[170:171], v[176:177] op_sel_hi:[1,0]
  v_pk_mul_f32 v[156:157], v[156:157], v[160:161] op_sel_hi:[1,0]
  v_pk_mul_f32 v[172:173], v[172:173], v[176:177] op_sel_hi:[1,0]
  v_pk_mul_f32 v[158:159], v[158:159], v[160:161] op_sel_hi:[1,0]
  v_pk_mul_f32 v[174:175], v[174:175], v[176:177] op_sel_hi:[1,0]
  v_cvt_pk_bf16_f32 v162, v152, v153
  v_cvt_pk_bf16_f32 v163, v154, v155
  v_cvt_pk_bf16_f32 v164, v156, v157
  v_cvt_pk_bf16_f32 v165, v158, v159
  ds_write_b128 v12, v[162:165] offset:4096
  v_cvt_pk_bf16_f32 v178, v168, v169
  v_cvt_pk_bf16_f32 v179, v170, v171
  v_cvt_pk_bf16_f32 v180, v172, v173
  v_cvt_pk_bf16_f32 v181, v174, v175
  ds_write_b128 v12, v[178:181] offset:5120
  v_add_f32 v32, s66, v32
  v_add_f32 v64, s66, v64
  v_rcp_f32 v32, v32
  v_rcp_f32 v64, v64
  v_pk_mul_f32 v[24:25], v[24:25], v[32:33] op_sel_hi:[1,0]
  v_pk_mul_f32 v[56:57], v[56:57], v[64:65] op_sel_hi:[1,0]
  v_pk_mul_f32 v[26:27], v[26:27], v[32:33] op_sel_hi:[1,0]
  v_pk_mul_f32 v[58:59], v[58:59], v[64:65] op_sel_hi:[1,0]
  v_pk_mul_f32 v[28:29], v[28:29], v[32:33] op_sel_hi:[1,0]
  v_pk_mul_f32 v[60:61], v[60:61], v[64:65] op_sel_hi:[1,0]
  v_pk_mul_f32 v[30:31], v[30:31], v[32:33] op_sel_hi:[1,0]
  v_pk_mul_f32 v[62:63], v[62:63], v[64:65] op_sel_hi:[1,0]
  v_cvt_pk_bf16_f32 v34, v24, v25
  v_cvt_pk_bf16_f32 v35, v26, v27
  v_cvt_pk_bf16_f32 v36, v28, v29
  v_cvt_pk_bf16_f32 v37, v30, v31
  ds_write_b128 v12, v[34:37] offset:6144
  v_cvt_pk_bf16_f32 v66, v56, v57
  v_cvt_pk_bf16_f32 v67, v58, v59
  v_cvt_pk_bf16_f32 v68, v60, v61
  v_cvt_pk_bf16_f32 v69, v62, v63
  ds_write_b128 v12, v[66:69] offset:7168
  s_waitcnt lgkmcnt(0)
  s_barrier
  ds_read_b128 v[56:59], v13 offset:0
  ds_read_b128 v[60:63], v13 offset:1024
  ds_read_b128 v[64:67], v13 offset:2048
  ds_read_b128 v[68:71], v13 offset:3072
  ds_read_b128 v[72:75], v13 offset:4096
  ds_read_b128 v[76:79], v13 offset:5120
  ds_read_b128 v[80:83], v13 offset:6144
  ds_read_b128 v[84:87], v13 offset:7168
  v_lshlrev_b32 v104, 16, v184
  v_and_b32 v105, s76, v184
  v_lshlrev_b32 v106, 16, v185
  v_and_b32 v107, s76, v185
  v_lshlrev_b32 v108, 16, v186
  v_and_b32 v109, s76, v186
  v_lshlrev_b32 v110, 16, v187
  v_and_b32 v111, s76, v187
  v_lshlrev_b32 v112, 16, v188
  v_and_b32 v113, s76, v188
  v_lshlrev_b32 v114, 16, v189
  v_and_b32 v115, s76, v189
  v_lshlrev_b32 v116, 16, v190
  v_and_b32 v117, s76, v190
  v_lshlrev_b32 v118, 16, v191
  v_and_b32 v119, s76, v191
  s_waitcnt lgkmcnt(7)
  v_mfma_f32_32x32x16_bf16 v[24:39], a[192:195], v[56:59], 0
  ds_read_b128 v[56:59], v13 offset:8192
  s_waitcnt lgkmcnt(7)
  v_mfma_f32_32x32x16_bf16 v[24:39], a[196:199], v[60:63], v[24:39]
  ds_read_b128 v[60:63], v13 offset:9216
  s_waitcnt lgkmcnt(7)
  v_mfma_f32_32x32x16_bf16 v[24:39], a[200:203], v[64:67], v[24:39]
  ds_read_b128 v[64:67], v13 offset:10240
  s_waitcnt lgkmcnt(7)
  v_mfma_f32_32x32x16_bf16 v[24:39], a[204:207], v[68:71], v[24:39]
  ds_read_b128 v[68:71], v13 offset:11264
  s_waitcnt lgkmcnt(7)
  v_mfma_f32_32x32x16_bf16 v[24:39], a[208:211], v[72:75], v[24:39]
  ds_read_b128 v[72:75], v13 offset:12288
  s_waitcnt lgkmcnt(7)
  v_mfma_f32_32x32x16_bf16 v[24:39], a[212:215], v[76:79], v[24:39]
  ds_read_b128 v[76:79], v13 offset:13312
  s_waitcnt lgkmcnt(7)
  v_mfma_f32_32x32x16_bf16 v[24:39], a[216:219], v[80:83], v[24:39]
  ds_read_b128 v[80:83], v13 offset:14336
  s_waitcnt lgkmcnt(7)
  v_mfma_f32_32x32x16_bf16 v[24:39], a[220:223], v[84:87], v[24:39]
  ds_read_b128 v[84:87], v13 offset:15360
  s_waitcnt lgkmcnt(7)
  v_mfma_f32_32x32x16_bf16 v[24:39], a[224:227], v[56:59], v[24:39]
  ds_read_b128 v[56:59], v13 offset:16384
  s_waitcnt lgkmcnt(7)
  v_mfma_f32_32x32x16_bf16 v[24:39], a[228:231], v[60:63], v[24:39]
  ds_read_b128 v[60:63], v13 offset:17408
  s_waitcnt lgkmcnt(7)
  v_mfma_f32_32x32x16_bf16 v[24:39], a[232:235], v[64:67], v[24:39]
  ds_read_b128 v[64:67], v13 offset:18432
  s_waitcnt lgkmcnt(7)
  v_mfma_f32_32x32x16_bf16 v[24:39], a[236:239], v[68:71], v[24:39]
  ds_read_b128 v[68:71], v13 offset:19456
  s_waitcnt lgkmcnt(7)
  v_mfma_f32_32x32x16_bf16 v[24:39], a[240:243], v[72:75], v[24:39]
  ds_read_b128 v[72:75], v13 offset:20480
  s_waitcnt lgkmcnt(7)
  v_mfma_f32_32x32x16_bf16 v[24:39], a[244:247], v[76:79], v[24:39]
  ds_read_b128 v[76:79], v13 offset:21504
  s_waitcnt lgkmcnt(7)
  v_mfma_f32_32x32x16_bf16 v[24:39], a[248:251], v[80:83], v[24:39]
  ds_read_b128 v[80:83], v13 offset:22528
  s_waitcnt lgkmcnt(7)
  v_mfma_f32_32x32x16_bf16 v[24:39], a[252:255], v[84:87], v[24:39]
  ds_read_b128 v[84:87], v13 offset:23552
  s_waitcnt lgkmcnt(7)
  v_mfma_f32_32x32x16_bf16 v[24:39], v[192:195], v[56:59], v[24:39]
  ds_read_b128 v[56:59], v13 offset:24576
  s_waitcnt lgkmcnt(7)
  v_mfma_f32_32x32x16_bf16 v[24:39], v[196:199], v[60:63], v[24:39]
  ds_read_b128 v[60:63], v13 offset:25600
  s_waitcnt lgkmcnt(7)
  v_mfma_f32_32x32x16_bf16 v[24:39], v[200:203], v[64:67], v[24:39]
  ds_read_b128 v[64:67], v13 offset:26624
  s_waitcnt lgkmcnt(7)
  v_mfma_f32_32x32x16_bf16 v[24:39], v[204:207], v[68:71], v[24:39]
  ds_read_b128 v[68:71], v13 offset:27648
  s_waitcnt lgkmcnt(7)
  v_mfma_f32_32x32x16_bf16 v[24:39], v[208:211], v[72:75], v[24:39]
  ds_read_b128 v[72:75], v13 offset:28672
  s_waitcnt lgkmcnt(7)
  v_mfma_f32_32x32x16_bf16 v[24:39], v[212:215], v[76:79], v[24:39]
  ds_read_b128 v[76:79], v13 offset:29696
  s_waitcnt lgkmcnt(7)
  v_mfma_f32_32x32x16_bf16 v[24:39], v[216:219], v[80:83], v[24:39]
  ds_read_b128 v[80:83], v13 offset:30720
  s_waitcnt lgkmcnt(7)
  v_mfma_f32_32x32x16_bf16 v[24:39], v[220:223], v[84:87], v[24:39]
  ds_read_b128 v[84:87], v13 offset:31744
  s_waitcnt lgkmcnt(7)
  v_mfma_f32_32x32x16_bf16 v[24:39], v[224:227], v[56:59], v[24:39]
  s_waitcnt lgkmcnt(6)
  v_mfma_f32_32x32x16_bf16 v[24:39], v[228:231], v[60:63], v[24:39]
  s_waitcnt lgkmcnt(5)
  v_mfma_f32_32x32x16_bf16 v[24:39], v[232:235], v[64:67], v[24:39]
  s_waitcnt lgkmcnt(4)
  v_mfma_f32_32x32x16_bf16 v[24:39], v[236:239], v[68:71], v[24:39]
  s_waitcnt lgkmcnt(3)
  v_mfma_f32_32x32x16_bf16 v[24:39], v[240:243], v[72:75], v[24:39]
  s_waitcnt lgkmcnt(2)
  v_mfma_f32_32x32x16_bf16 v[24:39], v[244:247], v[76:79], v[24:39]
  s_waitcnt lgkmcnt(1)
  v_mfma_f32_32x32x16_bf16 v[24:39], v[248:251], v[80:83], v[24:39]
  s_waitcnt lgkmcnt(0)
  v_mfma_f32_32x32x16_bf16 v[24:39], v[252:255], v[84:87], v[24:39]
  s_nop 11
  v_pk_add_f32 v[104:105], v[104:105], v[24:25]
  v_pk_add_f32 v[106:107], v[106:107], v[26:27]
  v_pk_add_f32 v[108:109], v[108:109], v[28:29]
  v_pk_add_f32 v[110:111], v[110:111], v[30:31]
  v_pk_add_f32 v[112:113], v[112:113], v[32:33]
  v_pk_add_f32 v[114:115], v[114:115], v[34:35]
  v_pk_add_f32 v[116:117], v[116:117], v[36:37]
  v_pk_add_f32 v[118:119], v[118:119], v[38:39]
  v_cvt_pk_bf16_f32 v120, v104, v105
  v_cvt_pk_bf16_f32 v121, v106, v107
  v_cvt_pk_bf16_f32 v122, v108, v109
  v_cvt_pk_bf16_f32 v123, v110, v111
  v_cvt_pk_bf16_f32 v124, v112, v113
  v_cvt_pk_bf16_f32 v125, v114, v115
  v_cvt_pk_bf16_f32 v126, v116, v117
  v_cvt_pk_bf16_f32 v127, v118, v119
  global_store_dwordx4 v14, v[120:123], s[28:29]
  global_store_dwordx4 v14, v[124:127], s[28:29] offset:16
L_end:
  s_endpgm
.p2align 6
.type L_idx,@object
L_idx:
  .short 1792, 1792, 1792, 1792, 1788, 1788, 1788, 1788, 1788, 1788, 1788, 1784, 1784, 1784, 1784, 1784
  .short 1784, 1784, 1784, 1784, 1780, 1780, 1780, 1780, 1780, 1780, 1780, 1776, 1776, 1776, 1776, 1776
  .short 1776, 1776, 1776, 1776, 1772, 1772, 1772, 1772, 1772, 1772, 1772, 1768, 1768, 1768, 1768, 1768
  .short 1768, 1768, 1768, 1768, 1764, 1764, 1764, 1764, 1764, 1764, 1764, 1760, 1760, 1760, 1760, 1760
  .short 1760, 1760, 1760, 1760, 1756, 1756, 1756, 1756, 1756, 1756, 1756, 1752, 1752, 1752, 1752, 1752
  .short 1752, 1752, 1752, 1752, 1748, 1748, 1748, 1748, 1748, 1748, 1748, 1744, 1744, 1744, 1744, 1744
  .short 1744, 1744, 1744, 1744, 1740, 1740, 1740, 1740, 1740, 1740, 1740, 1736, 1736, 1736, 1736, 1736
  .short 1736, 1736, 1736, 1736, 1732, 1732, 1732, 1732, 1732, 1732, 1732, 1728, 1728, 1728, 1728, 1728
  .short 1728, 1728, 1728, 1728, 1724, 1724, 1724, 1724, 1724, 1724, 1724, 1720, 1720, 1720, 1720, 1720
  .short 1720, 1720, 1720, 1720, 1716, 1716, 1716, 1716, 1716, 1716, 1716, 1712, 1712, 1712, 1712, 1712
  .short 1712, 1712, 1712, 1712, 1708, 1708, 1708, 1708, 1708, 1708, 1708, 1704, 1704, 1704, 1704, 1704
  .short 1704, 1704, 1704, 1704, 1700, 1700, 1700, 1700, 1700, 1700, 1700, 1696, 1696, 1696, 1696, 1696
  .short 1696, 1696, 1696, 1696, 1692, 1692, 1692, 1692, 1692, 1692, 1692, 1688, 1688, 1688, 1688, 1688
  .short 1688, 1688, 1688, 1688, 1684, 1684, 1684, 1684, 1684, 1684, 1684, 1680, 1680, 1680, 1680, 1680
  .short 1680, 1680, 1680, 1680, 1676, 1676, 1676, 1676, 1676, 1676, 1676, 1672, 1672, 1672, 1672, 1672
  .short 1672, 1672, 1672, 1672, 1668, 1668, 1668, 1668, 1668, 1668, 1668, 1664, 1664, 1664, 1664, 1664
  .short 1664, 1664, 1664, 1664, 1660, 1660, 1660, 1660, 1660, 1660, 1660, 1656, 1656, 1656, 1656, 1656
  .short 1656, 1656, 1656, 1656, 1652, 1652, 1652, 1652, 1652, 1652, 1652, 1648, 1648, 1648, 1648, 1648
  .short 1648, 1648, 1648, 1648, 1644, 1644, 1644, 1644, 1644, 1644, 1644, 1640, 1640, 1640, 1640, 1640
  .short 1640, 1640, 1640, 1640, 1636, 1636, 1636, 1636, 1636, 1636, 1636, 1632, 1632, 1632, 1632, 1632
  .short 1632, 1632, 1632, 1632, 1628, 1628, 1628, 1628, 1628, 1628, 1628, 1624, 1624, 1624, 1624, 1624
  .short 1624, 1624, 1624, 1624, 1620, 1620, 1620, 1620, 1620, 1620, 1620, 1616, 1616, 1616, 1616, 1616
  .short 1616, 1616, 1616, 1616, 1612, 1612, 1612, 1612, 1612, 1612, 1612, 1608, 1608, 1608, 1608, 1608
  .short 1608, 1608, 1608, 1608, 1604, 1604, 1604, 1604, 1604, 1604, 1604, 1600, 1600, 1600, 1600, 1600
  .short 1600, 1600, 1600, 1600, 1596, 1596, 1596, 1596, 1596, 1596, 1596, 1592, 1592, 1592, 1592, 1592
  .short 1592, 1592, 1592, 1592, 1588, 1588, 1588, 1588, 1588, 1588, 1588, 1584, 1584, 1584, 1584, 1584
  .short 1584, 1584, 1584, 1584, 1580, 1580, 1580, 1580, 1580, 1580, 1580, 1576, 1576, 1576, 1576, 1576
  .short 1576, 1576, 1576, 1576, 1572, 1572, 1572, 1572, 1572, 1572, 1572, 1568, 1568, 1568, 1568, 1568
  .short 1568, 1568, 1568, 1568, 1564, 1564, 1564, 1564, 1564, 1564, 1564, 1560, 1560, 1560, 1560, 1560
  .short 1560, 1560, 1560, 1560, 1556, 1556, 1556, 1556, 1556, 1556, 1556, 1552, 1552, 1552, 1552, 1552
  .short 1552, 1552, 1552, 1552, 1548, 1548, 1548, 1548, 1548, 1548, 1548, 1544, 1544, 1544, 1544, 1544
  .short 1544, 1544, 1544, 1544, 1540, 1540, 1540, 1540, 1540, 1540, 1540, 1536, 1536, 1536, 1536, 1536
  .short 1536, 1536, 1536, 1536, 1532, 1532, 1532, 1532, 1532, 1532, 1532, 1528, 1528, 1528, 1528, 1528
  .short 1528, 1528, 1528, 1528, 1524, 1524, 1524, 1524, 1524, 1524, 1524, 1520, 1520, 1520, 1520, 1520
  .short 1520, 1520, 1520, 1520, 1516, 1516, 1516, 1516, 1516, 1516, 1516, 1512, 1512, 1512, 1512, 1512
  .short 1512, 1512, 1512, 1512, 1508, 1508, 1508, 1508, 1508, 1508, 1508, 1504, 1504, 1504, 1504, 1504
  .short 1504, 1504, 1504, 1504, 1500, 1500, 1500, 1500, 1500, 1500, 1500, 1496, 1496, 1496, 1496, 1496
  .short 1496, 1496, 1496, 1496, 1492, 1492, 1492, 1492, 1492, 1492, 1492, 1488, 1488, 1488, 1488, 1488
  .short 1488, 1488, 1488, 1488, 1484, 1484, 1484, 1484, 1484, 1484, 1484, 1480, 1480, 1480, 1480, 1480
  .short 1480, 1480, 1480, 1480, 1476, 1476, 1476, 1476, 1476, 1476, 1476, 1472, 1472, 1472, 1472, 1472
  .short 1472, 1472, 1472, 1472, 1468, 1468, 1468, 1468, 1468, 1468, 1468, 1464, 1464, 1464, 1464, 1464
  .short 1464, 1464, 1464, 1464, 1460, 1460, 1460, 1460, 1460, 1460, 1460, 1456, 1456, 1456, 1456, 1456
  .short 1456, 1456, 1456, 1456, 1452, 1452, 1452, 1452, 1452, 1452, 1452, 1448, 1448, 1448, 1448, 1448
  .short 1448, 1448, 1448, 1448, 1444, 1444, 1444, 1444, 1444, 1444, 1444, 1440, 1440, 1440, 1440, 1440
  .short 1440, 1440, 1440, 1440, 1436, 1436, 1436, 1436, 1436, 1436, 1436, 1432, 1432, 1432, 1432, 1432
  .short 1432, 1432, 1432, 1432, 1428, 1428, 1428, 1428, 1428, 1428, 1428, 1424, 1424, 1424, 1424, 1424
  .short 1424, 1424, 1424, 1424, 1420, 1420, 1420, 1420, 1420, 1420, 1420, 1416, 1416, 1416, 1416, 1416
  .short 1416, 1416, 1416, 1416, 1412, 1412, 1412, 1412, 1412, 1412, 1412, 1408, 1408, 1408, 1408, 1408
  .short 1408, 1408, 1408, 1408, 1404, 1404, 1404, 1404, 1404, 1404, 1404, 1400, 1400, 1400, 1400, 1400
  .short 1400, 1400, 1400, 1400, 1396, 1396, 1396, 1396, 1396, 1396, 1396, 1392, 1392, 1392, 1392, 1392
  .short 1392, 1392, 1392, 1392, 1388, 1388, 1388, 1388, 1388, 1388, 1388, 1384, 1384, 1384, 1384, 1384
  .short 1384, 1384, 1384, 1384, 1380, 1380, 1380, 1380, 1380, 1380, 1380, 1376, 1376, 1376, 1376, 1376
  .short 1376, 1376, 1376, 1376, 1372, 1372, 1372, 1372, 1372, 1372, 1372, 1368, 1368, 1368, 1368, 1368
  .short 1368, 1368, 1368, 1368, 1364, 1364, 1364, 1364, 1364, 1364, 1364, 1360, 1360, 1360, 1360, 1360
  .short 1360, 1360, 1360, 1360, 1356, 1356, 1356, 1356, 1356, 1356, 1356, 1352, 1352, 1352, 1352, 1352
  .short 1352, 1352, 1352, 1352, 1348, 1348, 1348, 1348, 1348, 1348, 1348, 1344, 1344, 1344, 1344, 1344
  .short 1344, 1344, 1344, 1344, 1340, 1340, 1340, 1340, 1340, 1340, 1340, 1336, 1336, 1336, 1336, 1336
  .short 1336, 1336, 1336, 1336, 1332, 1332, 1332, 1332, 1332, 1332, 1332, 1328, 1328, 1328, 1328, 1328
  .short 1328, 1328, 1328, 1328, 1324, 1324, 1324, 1324, 1324, 1324, 1324, 1320, 1320, 1320, 1320, 1320
  .short 1320, 1320, 1320, 1320, 1316, 1316, 1316, 1316, 1316, 1316, 1316, 1312, 1312, 1312, 1312, 1312
  .short 1312, 1312, 1312, 1312, 1308, 1308, 1308, 1308, 1308, 1308, 1308, 1304, 1304, 1304, 1304, 1304
  .short 1304, 1304, 1304, 1304, 1300, 1300, 1300, 1300, 1300, 1300, 1300, 1296, 1296, 1296, 1296, 1296
  .short 1296, 1296, 1296, 1296, 1292, 1292, 1292, 1292, 1292, 1292, 1292, 1288, 1288, 1288, 1288, 1288
  .short 1288, 1288, 1288, 1288, 1284, 1284, 1284, 1284, 1284, 1284, 1284, 1280, 1280, 1280, 1280, 1280
  .short 1280, 1280, 1278, 1278, 1278, 1276, 1276, 1276, 1276, 1276, 1274, 1274, 1274, 1272, 1272, 1272
  .short 1272, 1272, 1270, 1270, 1270, 1268, 1268, 1268, 1268, 1268, 1266, 1266, 1266, 1264, 1264, 1264
  .short 1264, 1264, 1262, 1262, 1262, 1260, 1260, 1260, 1260, 1260, 1258, 1258, 1258, 1256, 1256, 1256
  .short 1256, 1256, 1254, 1254, 1254, 1252, 1252, 1252, 1252, 1252, 1250, 1250, 1250, 1248, 1248, 1248
  .short 1248, 1248, 1246, 1246, 1246, 1244, 1244, 1244, 1244, 1244, 1242, 1242, 1242, 1240, 1240, 1240
  .short 1240, 1240, 1238, 1238, 1238, 1236, 1236, 1236, 1236, 1236, 1234, 1234, 1234, 1232, 1232, 1232
  .short 1232, 1232, 1230, 1230, 1230, 1228, 1228, 1228, 1228, 1228, 1226, 1226, 1226, 1224, 1224, 1224
  .short 1224, 1224, 1222, 1222, 1222, 1220, 1220, 1220, 1220, 1220, 1218, 1218, 1218, 1216, 1216, 1216
  .short 1216, 1216, 1214, 1214, 1214, 1212, 1212, 1212, 1212, 1212, 1210, 1210, 1210, 1208, 1208, 1208
  .short 1208, 1208, 1206, 1206, 1206, 1204, 1204, 1204, 1204, 1204, 1202, 1202, 1202, 1200, 1200, 1200
  .short 1200, 1200, 1198, 1198, 1198, 1196, 1196, 1196, 1196, 1196, 1194, 1194, 1194, 1192, 1192, 1192
  .short 1192, 1192, 1190, 1190, 1190, 1188, 1188, 1188, 1188, 1188, 1186, 1186, 1186, 1184, 1184, 1184
  .short 1184, 1184, 1182, 1182, 1182, 1180, 1180, 1180, 1180, 1180, 1178, 1178, 1178, 1176, 1176, 1176
  .short 1176, 1176, 1174, 1174, 1174, 1172, 1172, 1172, 1172, 1172, 1170, 1170, 1170, 1168, 1168, 1168
  .short 1168, 1168, 1166, 1166, 1166, 1164, 1164, 1164, 1164, 1164, 1162, 1162, 1162, 1160, 1160, 1160
  .short 1160, 1160, 1158, 1158, 1158, 1156, 1156, 1156, 1156, 1156, 1154, 1154, 1154, 1152, 1152, 1152
  .short 1152, 1152, 1150, 1150, 1150, 1148, 1148, 1148, 1148, 1148, 1146, 1146, 1146, 1144, 1144, 1144
  .short 1144, 1144, 1142, 1142, 1142, 1140, 1140, 1140, 1140, 1140, 1138, 1138, 1138, 1136, 1136, 1136
  .short 1136, 1136, 1134, 1134, 1134, 1132, 1132, 1132, 1132, 1132, 1130, 1130, 1130, 1128, 1128, 1128
  .short 1128, 1128, 1126, 1126, 1126, 1124, 1124, 1124, 1124, 1124, 1122, 1122, 1122, 1120, 1120, 1120
  .short 1120, 1120, 1118, 1118, 1118, 1116, 1116, 1116, 1116, 1116, 1114, 1114, 1114, 1112, 1112, 1112
  .short 1112, 1112, 1110, 1110, 1110, 1108, 1108, 1108, 1108, 1108, 1106, 1106, 1106, 1104, 1104, 1104
  .short 1104, 1104, 1102, 1102, 1102, 1100, 1100, 1100, 1100, 1100, 1098, 1098, 1098, 1096, 1096, 1096
  .short 1096, 1096, 1094, 1094, 1094, 1092, 1092, 1092, 1092, 1092, 1090, 1090, 1090, 1088, 1088, 1088
  .short 1088, 1088, 1086, 1086, 1086, 1084, 1084, 1084, 1084, 1084, 1082, 1082, 1082, 1080, 1080, 1080
  .short 1080, 1080, 1078, 1078, 1078, 1076, 1076, 1076, 1076, 1076, 1074, 1074, 1074, 1072, 1072, 1072
  .short 1072, 1072, 1070, 1070, 1070, 1068, 1068, 1068, 1068, 1068, 1066, 1066, 1066, 1064, 1064, 1064
  .short 1064, 1064, 1062, 1062, 1062, 1060, 1060, 1060, 1060, 1060, 1058, 1058, 1058, 1056, 1056, 1056
  .short 1056, 1056, 1054, 1054, 1054, 1052, 1052, 1052, 1052, 1052, 1050, 1050, 1050, 1048, 1048, 1048
  .short 1048, 1048, 1046, 1046, 1046, 1044, 1044, 1044, 1044, 1044, 1042, 1042, 1042, 1040, 1040, 1040
  .short 1040, 1040, 1038, 1038, 1038, 1036, 1036, 1036, 1036, 1036, 1034, 1034, 1034, 1032, 1032, 1032
  .short 1032, 1032, 1030, 1030, 1030, 1028, 1028, 1028, 1028, 1028, 1026, 1026, 1026, 1024, 1024, 1024
  .short 1024, 1020, 1016, 1016, 1016, 1012, 1008, 1008, 1008, 1004, 1000, 1000, 1000, 996, 992, 992
  .short 992, 988, 984, 984, 984, 980, 976, 976, 976, 972, 968, 968, 968, 964, 960, 960
  .short 960, 956, 952, 952, 952, 948, 944, 944, 944, 940, 936, 936, 936, 932, 928, 928
  .short 928, 924, 920, 920, 920, 916, 912, 912, 912, 908, 904, 904, 904, 900, 896, 896
  .short 896, 892, 888, 888, 888, 884, 880, 880, 880, 876, 872, 872, 872, 868, 864, 864
  .short 864, 860, 856, 856, 856, 852, 848, 848, 848, 844, 840, 840, 840, 836, 832, 832
  .short 832, 828, 824, 824, 824, 820, 816, 816, 816, 812, 808, 808, 808, 804, 800, 800
  .short 800, 796, 792, 792, 792, 788, 784, 784, 784, 780, 776, 776, 776, 772, 768, 768
  .short 768, 764, 760, 760, 760, 756, 752, 752, 752, 748, 744, 744, 744, 740, 736, 736
  .short 736, 732, 728, 728, 728, 724, 720, 720, 720, 716, 712, 712, 712, 708, 704, 704
  .short 704, 700, 696, 696, 696, 692, 688, 688, 688, 684, 680, 680, 680, 676, 672, 672
  .short 672, 668, 664, 664, 664, 660, 656, 656, 656, 652, 648, 648, 648, 644, 640, 640
  .short 640, 636, 632, 632, 632, 628, 624, 624, 624, 620, 616, 616, 616, 612, 608, 608
  .short 608, 604, 600, 600, 600, 596, 592, 592, 592, 588, 584, 584, 584, 580, 576, 576
  .short 576, 572, 568, 568, 568, 564, 560, 560, 560, 556, 552, 552, 552, 548, 544, 544
  .short 544, 540, 536, 536, 536, 532, 528, 528, 528, 524, 520, 520, 520, 516, 512, 512
  .short 510, 508, 506, 504, 502, 500, 498, 496, 494, 492, 490, 488, 486, 484, 482, 480
  .short 478, 476, 474, 472, 470, 468, 466, 464, 462, 460, 458, 456, 454, 452, 450, 448
  .short 446, 444, 442, 440, 438, 436, 434, 432, 430, 428, 426, 424, 422, 420, 418, 416
  .short 414, 412, 410, 408, 406, 404, 402, 400, 398, 396, 394, 392, 390, 388, 386, 384
  .short 382, 380, 378, 376, 374, 372, 370, 368, 366, 364, 362, 360, 358, 356, 354, 352
  .short 350, 348, 346, 344, 342, 340, 338, 336, 334, 332, 330, 328, 326, 324, 322, 320
  .short 318, 316, 314, 312, 310, 308, 306, 304, 302, 300, 298, 296, 294, 292, 290, 288
  .short 286, 284, 282, 280, 278, 276, 274, 272, 270, 268, 266, 264, 262, 260, 258, 256
  .short 254, 252, 250, 248, 246, 244, 242, 240, 238, 236, 234, 232, 230, 228, 226, 224
  .short 222, 220, 218, 216, 214, 212, 210, 208, 206, 204, 202, 200, 198, 196, 194, 192
  .short 190, 188, 186, 184, 182, 180, 178, 176, 174, 172, 170, 168, 166, 164, 162, 160
  .short 158, 156, 154, 152, 150, 148, 146, 144, 142, 140, 138, 136, 134, 132, 130, 128
  .short 126, 124, 122, 120, 118, 116, 114, 112, 110, 108, 106, 104, 102, 100, 98, 96
  .short 94, 92, 90, 88, 86, 84, 82, 80, 78, 76, 74, 72, 70, 68, 66, 64
  .short 62, 60, 58, 56, 54, 52, 50, 48, 46, 44, 42, 40, 38, 36, 34, 32
  .short 30, 28, 26, 24, 22, 20, 18, 16, 14, 12, 10, 8, 6, 4, 2, 0
  .short 2048, 2048, 2048, 2048, 2048, 2048, 2048, 2048, 2048, 2048, 2048, 2048, 2048, 2048, 2048, 2048
L_tab_end:
.section .rodata,"a"
.p2align 6
.amdhsa_kernel interleave_layers__ssm_conv_s4d__linear_attn_block__prompt_kernel
  .amdhsa_next_free_vgpr 512
  .amdhsa_next_free_sgpr 102
  .amdhsa_accum_offset 256
  .amdhsa_group_segment_fixed_size 0
  .amdhsa_kernarg_size 104
  .amdhsa_user_sgpr_count 2
  .amdhsa_user_sgpr_kernarg_segment_ptr 1
  .amdhsa_system_sgpr_workgroup_id_x 1
  .amdhsa_float_denorm_mode_32 3
.end_amdhsa_kernel
```
